```python
import torch

def _softmax(x, axis=-1):
    return torch.softmax(x, dim=axis)

def _gelu(x):
    return torch.nn.functional.gelu(x, approximate='tanh')

def _silu(x):
    return torch.nn.functional.silu(x)

def _sigmoid(x):
    return torch.sigmoid(x)

def _layernorm(x, axis=-1, eps=1e-05):
    m = x.mean(dim=axis, keepdim=True)
    v = x.var(dim=axis, keepdim=True, unbiased=False)
    return (x - m) / torch.sqrt(v + eps)

def _scatter_add(tgt, idx, src, axis=0):
    return tgt.clone().index_add_(axis, idx, src)

def _segment_sum(src, seg, n):
    out = torch.zeros((n,) + src.shape[1:], dtype=src.dtype)
    return out.index_add_(0, seg, src)

def _pad(x, pw):
    flat = tuple((v for pair in reversed(pw) for v in pair))
    return torch.nn.functional.pad(x, flat)
kernel_name = 'adaLN_cond__ssm_conv_s4__glu_gated_geglu__prompt'

def setup_inputs():

    _w = lambda a: (lambda t: t.to(torch.bfloat16) if t.is_floating_point() else t)(torch.as_tensor(a))

    def _A_setup():
        B, L, D, N = (1, 2048, 640, 192)
        A_re = -(lambda _x: torch.exp(torch.as_tensor(_x)))((lambda *s: torch.randn(*s, dtype=torch.bfloat16) * 3.2)(D, N))
        A_im = torch.pi * (lambda *s: torch.randn(*s, dtype=torch.bfloat16) * 0.1)(D, N)
        B_re = (lambda *s: torch.randn(*s, dtype=torch.bfloat16) * 0.1)(D, N)
        B_im = (lambda *s: torch.randn(*s, dtype=torch.bfloat16) * 0.1)(D, N)
        C_re = (lambda *s: torch.randn(*s, dtype=torch.bfloat16) * 0.1)(D, N)
        C_im = (lambda *s: torch.randn(*s, dtype=torch.bfloat16) * 0.1)(D, N)
        log_dt = (lambda *s: torch.randn(*s, dtype=torch.bfloat16) * 0.1)(D) * 0.5 - 4.0
        Dskip = (lambda *s: torch.randn(*s, dtype=torch.bfloat16) * 0.1)(D)
        return {'u': _w((lambda *s: torch.randn(*s, dtype=torch.bfloat16) * 0.05)(B, L, D)), 'A_re': _w(A_re), 'A_im': _w(A_im), 'B_re': _w(B_re), 'B_im': _w(B_im), 'C_re': _w(C_re), 'C_im': _w(C_im), 'log_dt': _w(log_dt), 'Dskip': _w(Dskip)}
    _A_in = _A_setup()

    def _B_setup():
        B, S, Dm, Df = (1, 2048, 640, 1536)
        return {'x': _w((lambda *s: torch.randn(*s, dtype=torch.bfloat16) * 0.05)(B, S, Dm)), 'w_gate': _w((lambda *s: torch.randn(*s, dtype=torch.bfloat16) * 1.6)(Dm, Df) * Dm ** (-0.5)), 'w_up': _w((lambda *s: torch.randn(*s, dtype=torch.bfloat16) * 1.6)(Dm, Df) * Dm ** (-0.5)), 'w_down': _w((lambda *s: torch.randn(*s, dtype=torch.bfloat16) * 1.6)(Df, Dm) * Df ** (-0.5))}
    _B_in = _B_setup()
    return {'A_u': _A_in['u'], 'A_A_re': _A_in['A_re'], 'A_A_im': _A_in['A_im'], 'A_B_re': _A_in['B_re'], 'A_B_im': _A_in['B_im'], 'A_C_re': _A_in['C_re'], 'A_C_im': _A_in['C_im'], 'A_log_dt': _A_in['log_dt'], 'A_Dskip': _A_in['Dskip'], 'B_x': _B_in['x'], 'B_w_gate': _B_in['w_gate'], 'B_w_up': _B_in['w_up'], 'B_w_down': _B_in['w_down'], 'c': _w((lambda *s: torch.randn(*s, dtype=torch.bfloat16) * 0.1)(1, 640) * 8.0), 'w_mod': _w((lambda *s: torch.randn(*s, dtype=torch.bfloat16) * 0.1)(640, 6 * 640) * 640 ** (-0.5) * 8.0)}

def reference(A_u, A_A_re, A_A_im, A_B_re, A_B_im, A_C_re, A_C_im, A_log_dt, A_Dskip, B_x, B_w_gate, B_w_up, B_w_down, c, w_mod):

    def _A_ref(u, A_re, A_im, B_re, B_im, C_re, C_im, log_dt, Dskip):
        Bsz, L, D = u.shape
        dt = torch.exp(log_dt)[:, None]
        A = A_re + 1j * A_im
        Bc = B_re + 1j * B_im
        Cc = C_re + 1j * C_im
        logdA = dt * A
        dB = dt * Bc
        l = (lambda x, dt: x.to(dt))(torch.arange(L), A_re.dtype)
        P = torch.exp(logdA[:, :, None] * l[None, None, :])
        K = torch.einsum('dn,dnl,dn->dl', Cc, P, dB).real
        L2 = 2 * L
        Kp = _pad(K, ((0, 0), (0, L)))
        up = (lambda x, *d: x.permute(*d))(u, 0, 2, 1)
        up = _pad(up, ((0, 0), (0, 0), (0, L)))
        Kf = (lambda x, axes=(-2, -1): torch.fft.rfft2(x.float(), dim=axes))(Kp[:, None, :], axes=(-2, -1))
        Uf = (lambda x, axes=(-2, -1): torch.fft.rfft2(x.float(), dim=axes))(up[:, :, None, :], axes=(-2, -1))
        Yf = Uf * Kf[None, :, :, :]
        y = (lambda x, s, axes=(-2, -1): torch.fft.irfft2(x, s=s, dim=axes).to(torch.bfloat16))(Yf, (1, L2), axes=(-2, -1))[:, :, 0, :L]
        y = (lambda x, *d: x.permute(*d))(y, 0, 2, 1) + u * Dskip[None, None, :]
        return y

    def _B_ref(x, w_gate, w_up, w_down):
        g = torch.einsum('bsd,df->bsf', x, w_gate)
        u = torch.einsum('bsd,df->bsf', x, w_up)
        h = _gelu(g) * u
        return torch.einsum('bsf,fd->bsd', h, w_down)
    x = A_u
    mod = (_silu(c) @ w_mod).reshape(c.shape[0], 6, 1, -1)
    sa, ca, ga, sb, cb, gb = (mod[:, 0].clone(), mod[:, 1].clone(), mod[:, 2].clone(), mod[:, 3].clone(), mod[:, 4].clone(), mod[:, 5].clone())
    h = _layernorm(x, axis=-1) * (1 + ca) + sa
    x = x + ga * _A_ref(h, A_A_re, A_A_im, A_B_re, A_B_im, A_C_re, A_C_im, A_log_dt, A_Dskip)
    h = _layernorm(x, axis=-1) * (1 + cb) + sb
    x = x + gb * _B_ref(h, B_w_gate, B_w_up, B_w_down)
    return x
```

```asm
; @launch grid=(256,1,1) block=(256,1,1) lds=163840
.amdgcn_target "amdgcn-amd-amdhsa--gfx950"
.text
.p2align 12
.globl adaLN_cond__ssm_conv_s4__glu_gated_geglu__prompt_kernel
.p2align 8
.type adaLN_cond__ssm_conv_s4__glu_gated_geglu__prompt_kernel,@function
adaLN_cond__ssm_conv_s4__glu_gated_geglu__prompt_kernel:
    s_cmp_ge_u32 s2, 256
    s_cbranch_scc1 L_exit
    s_load_dwordx2 s[8:9], s[0:1], 0
    s_load_dwordx16 s[16:31], s[0:1], 80
    s_load_dwordx16 s[32:47], s[0:1], 8
    v_lshrrev_b32 v1, 6, v0
    s_lshr_b32 s52, s2, 3
    v_and_b32 v2, 63, v0
    v_readfirstlane_b32 s3, v1
    s_lshl_b32 s60, s52, 2
    s_getpc_b64 s[76:77]
    s_add_u32 s60, s60, s3
    s_mul_i32 s60, s60, 384
    s_min_u32 s60, s60, 39680
    s_add_u32 s76, s76, s60
    s_addc_u32 s77, s77, 0
    v_min_u32 v4, 2, v2
    v_lshlrev_b32 v4, 7, v4
    global_load_dword v252, v4, s[76:77]
    v_lshlrev_b32_e64 v3, 4, v2
    s_mov_b32 s10, 2621440
    s_mov_b32 s11, 0x20000
    s_and_b32 s63, s2, 127
    s_mul_i32 s60, s63, 20480
    s_mul_i32 s62, s3, 5120
    s_add_u32 s60, s60, s62
    s_add_u32 s65, s60, 4096
    s_mul_i32 s61, s3, 5152
    s_add_u32 s61, s61, 100864
    s_mov_b32 m0, s61
    s_cmp_lt_u32 s2, 128
    s_cselect_b32 s62, 0, 2130706432
    v_or_b32 v125, s62, v3
    s_and_b32 s51, s2, 7
    s_mul_i32 s57, s51, 20
    s_add_u32 s57, s57, s52
    s_lshl_b32 s56, s57, 2
    s_add_u32 s56, s56, s3
    v_lshrrev_b32_e64 v104, 3, v2
    v_bfe_u32 v105, v2, 4, 1
    v_lshlrev_b32 v105, 1, v105
    v_and_b32 v106, 7, v2
    v_xor_b32 v105, v105, v106
    v_lshlrev_b32 v105, 4, v105
    v_xor_b32 v106, 64, v105
    s_movk_i32 s64, 3072
    v_mad_u32_u24 v107, v104, s64, v105
    v_mad_u32_u24 v108, v104, s64, v106
    s_movk_i32 s64, 7680
    v_mad_u32_u24 v110, v104, s64, v105
    v_mad_u32_u24 v111, v104, s64, v106
    s_lshl_b32 s66, s3, 12
    s_add_u32 s66, s66, 65536
    s_lshr_b32 s71, s56, 1
    s_lshl_b32 s71, s71, 2
    s_min_u32 s71, s71, 1276
    s_mul_i32 s70, s56, 384
    v_mul_u32_u24_e64 v109, 6, v2
    v_and_b32 v109, 0x1fc, v109
    v_add_u32 v109, s70, v109
    s_and_b32 s70, s51, 3
    s_lshl_b32 s70, s70, 2
    s_and_b32 s53, s52, 3
    s_add_u32 s53, s53, s70
    s_lshr_b32 s70, s51, 2
    s_lshl_b32 s70, s70, 3
    s_lshr_b32 s54, s52, 2
    s_add_u32 s54, s54, s70
    s_mov_b32 s55, 40000
    s_cmp_ge_u32 s52, 20
    s_cbranch_scc1 L_sp_pro
    s_waitcnt lgkmcnt(0)
    buffer_load_dwordx4 v125, s[8:11], s60 offen offset:0 nt lds
    buffer_load_dwordx4 v125, s[8:11], s60 offen offset:1024 nt lds
    buffer_load_dwordx4 v125, s[8:11], s60 offen offset:2048 nt lds
    buffer_load_dwordx4 v125, s[8:11], s60 offen offset:3072 nt lds
    s_add_u32 m0, s61, 4096
    s_mov_b64 s[4:5], s[30:31]
    buffer_load_dwordx4 v125, s[8:11], s65 offen nt lds
    s_mov_b32 s0, 0
    s_load_dword s68, s[44:45], s71
    s_load_dword s69, s[46:47], s71
    s_load_dword s67, s[4:5], 0
    global_load_dwordx2 v[206:207], v109, s[32:33] nt
    global_load_dwordx2 v[208:209], v109, s[34:35] nt
    global_load_dwordx2 v[210:211], v109, s[36:37] nt
    global_load_dwordx2 v[212:213], v109, s[38:39] nt
    global_load_dwordx2 v[214:215], v109, s[40:41] nt
    global_load_dwordx2 v[216:217], v109, s[42:43] nt
    s_mov_b64 s[12:13], s[26:27]
    s_mov_b64 s[28:29], s[24:25]
    s_mov_b64 s[48:49], s[22:23]
    s_mov_b64 s[24:25], s[20:21]
    s_mov_b64 s[20:21], s[18:19]
    s_mov_b32 s30, 4915200
    s_mov_b32 s31, s11
    s_mov_b32 s6, 20971520
    s_mov_b32 s7, s11
    s_mov_b32 s14, s10
    s_mov_b32 s15, s11
    s_mov_b32 s18, 1966080
    s_mov_b32 s19, s11
    s_mov_b32 s22, s18
    s_mov_b32 s23, s11
    s_mov_b32 s26, s18
    s_mov_b32 s27, s11
    s_mul_hi_u32 s58, s2, 214748365
    s_mul_i32 s59, s58, 20
    s_sub_u32 s59, s2, s59
    s_lshl_b32 s59, s59, 1
    s_and_b32 s36, s3, 1
    s_add_u32 s59, s59, s36
    s_lshr_b32 s37, s3, 1
    s_mul_i32 s34, s59, 49152
    s_mul_i32 s32, s58, 384
    s_add_u32 s34, s34, s32
    s_lshl_b32 s32, s37, 7
    s_add_u32 s32, s32, s34
    s_add_u32 s33, s32, 24576
    s_mul_i32 s35, s37, 24576
    s_add_u32 s34, s34, s35
    s_add_u32 s34, s34, 256
    s_mul_i32 s58, s58, 480
    s_add_u32 s58, s58, s59
    s_lshl_b32 s58, s58, 10
    s_add_u32 s58, s58, 7340032
    s_mul_i32 s35, s37, 163840
    s_add_u32 s35, s35, s58
    s_lshl_b32 s36, s37, 9
    s_add_u32 s36, s36, s58
    s_add_u32 s36, s36, 327680
    s_add_u32 s37, s66, 75776
    v_lshrrev_b32 v199, 5, v2
    v_mul_u32_u24 v199, 40448, v199
    v_add_u32 v199, v199, v3
    v_and_b32 v194, 1, v2
    v_mul_u32_u24 v194, 0x0202, v194
    v_lshlrev_b32_e64 v194, 16, v194
    v_add_u32 v194, 0x01000c0c, v194
    v_add_u32 v195, 0x02020000, v194
    v_add_u32 v196, 0x02020000, v195
    v_and_b32 v228, 31, v2
    v_min_u32 v227, 23, v228
    s_lshl_b32 s70, s3, 14
    s_nop 0
    s_mul_i32 s71, s3, 4736
    s_add_u32 s71, s71, 81920
    s_mul_i32 s72, s3, 4608
    s_add_u32 s72, s72, 122880
    v_writelane_b32 v227, 4, 8
    v_writelane_b32 v227, 4, 40
    v_writelane_b32 v227, 11, 13
    v_writelane_b32 v227, 11, 45
    v_writelane_b32 v227, 8, 24
    v_writelane_b32 v227, 8, 56
    v_writelane_b32 v227, 13, 28
    v_writelane_b32 v227, 13, 60
    v_lshrrev_b32 v229, 5, v2
    v_lshlrev_b32 v243, 4, v228
    v_lshl_add_u32 v242, v229, 3, v243
    v_sub_u32_e64 v242, s71, v242
    v_lshl_add_u32 v243, v229, 9, v243
    v_sub_u32 v243, s71, v243
    v_lshlrev_b32 v244, 1, v2
    v_sub_u32 v244, s71, v244
    v_mov_b32 v246, s71
    v_lshl_add_u32 v229, v229, 4, s70
    s_movk_i32 s58, 272
    v_add_u32 v227, 32, v227
    v_mad_u32_u24 v227, v227, s58, v229
    v_mad_u32_u24 v228, v228, s58, v229
    v_mov_b32 v72, 0x00003f80
    v_mov_b32 v56, 0
    v_mov_b32 v57, 0
    v_lshl_add_u32 v58, v2, 3, s72
    v_and_b32_e64 v7, 15, v2
    v_lshl_add_u32 v59, v7, 2, s71
    v_lshl_add_u32 v73, v2, 2, s70
    ds_write_b32 v73, v72
    ds_write_b64 v58, v[56:57]
    ds_write_b32 v59, v56
    ds_write_b32 v59, v56 offset:2112
    ds_write_b32 v59, v56 offset:2236
    ds_write_b32 v59, v56 offset:4352
    ds_write_b32 v59, v56 offset:4640
    v_mov_b32 v254, 159744
    v_mov_b32_e64 v255, 1
    ds_write_b64 v254, v[56:57]
    v_bfe_u32 v247, v0, 2, 2
    v_lshlrev_b32_e64 v247, 4, v247
    v_lshl_add_u32 v247, v0, 6, v247
    v_add_u32 v247, 141312, v247
    v_xor_b32 v248, 16, v247
    v_xor_b32 v249, 32, v247
    v_xor_b32 v250, 48, v247
    v_lshlrev_b32 v192, 4, v0
    v_add_u32 v251, 123392, v192
    v_lshrrev_b32 v8, 4, v2
    v_lshlrev_b32 v193, 4, v8
    v_lshlrev_b32_e64 v9, 5, v7
    v_add3_u32 v9, v9, v193, s72
    v_and_b32_e64 v10, 1, v7
    v_mul_u32_u24 v10, 2238, v10
    v_add3_u32 v10, v10, v193, s71
    v_xor_b32 v193, v193, v3
    v_lshlrev_b32 v11, 1, v7
    v_sub_u32_e64 v10, v10, v11
    v_add_u32 v12, 96, v10
    v_add_u32 v10, 1120, v10
    v_lshrrev_b32 v29, 2, v7
    v_lshrrev_b32 v16, 1, v29
    v_and_b32 v16, v16, v29
    v_add_u32 v29, v29, v16
    v_and_b32_e64 v14, 1, v8
    v_mad_u32_u24 v29, v14, 6, v29
    v_mul_u32_u24 v29, 640, v29
    v_and_b32 v16, 3, v7
    s_lshl_b32 s58, s57, 2
    s_add_u32 s58, s58, 16384
    v_add3_u32 v29, v29, v16, s58
    v_lshlrev_b32_e64 v29, 3, v29
    v_bfe_u32 v13, v7, 1, 2
    v_xor_b32 v13, s3, v13
    v_lshlrev_b32 v13, 4, v13
    v_lshl_add_u32 v13, v7, 7, v13
    v_lshl_add_u32 v13, v14, 6, v13
    v_add_u32 v13, 141312, v13
    v_lshlrev_b32 v15, 3, v14
    v_lshrrev_b32 v60, 2, v7
    v_lshl_add_u32 v15, v60, 1, v15
    v_lshrrev_b32 v60, 1, v8
    v_add_u32 v15, v15, v60
    v_mul_u32_u24 v15, 40960, v15
    v_and_b32_e64 v60, 3, v7
    v_lshl_add_u32 v15, v60, 4, v15
    s_lshl_b32 s38, s56, 6
    s_add_u32 s38, s38, 4194304
    v_add_u32 v15, s38, v15
    s_lshr_b32 s58, s3, 1
    s_mul_i32 s58, s58, 3
    s_mul_i32 s59, s53, 6
    s_add_u32 s58, s58, s59
    s_and_b32 s59, s3, 1
    s_lshr_b32 s74, s53, 1
    s_mul_i32 s74, s74, 20
    s_mul_i32 s76, s59, 10
    s_add_u32 s74, s74, s76
    s_and_b32 s76, s51, 1
    s_lshl_b32 s76, s76, 8
    s_add_u32 s74, s74, s76
    v_min_u32 v6, 9, v2
    v_add_u32 v6, s74, v6
    v_mul_u32_u24_e64 v6, 32, v6
    v_add_u32 v6, 20054016, v6
    s_lshl_b32 s74, s59, 7
    v_xor_b32 v5, s74, v3
    s_mul_i32 s58, s58, 40960
    s_mul_i32 s74, s59, 20480
    s_add_u32 s58, s58, s74
    s_add_u32 s58, s58, 7340032
    s_mul_i32 s59, s59, 40960
    s_add_u32 s76, s58, s59
    s_sub_u32 s74, s58, s59
    s_add_u32 s74, s74, 40960
    s_add_u32 s75, s58, 81920
    v_lshrrev_b32 v112, 4, v2
    v_bfe_u32 v113, v2, 2, 2
    v_lshlrev_b32_e64 v114, 10, v112
    v_lshl_add_u32 v114, v113, 7, v114
    v_and_b32 v112, 1, v112
    v_lshrrev_b32 v113, 1, v113
    v_lshl_or_b32 v112, v112, 1, v113
    v_lshl_add_u32 v114, v112, 5, v114
    v_and_b32_e64 v112, 3, v2
    v_lshl_add_u32 v112, v112, 3, v114
    v_add_u32 v112, s66, v112
    v_xor_b32 v113, 32, v112
    v_xor_b32_e64 v114, 64, v112
    v_xor_b32 v115, 96, v112
    s_mul_i32 s65, s2, 32
    s_add_u32 s65, s65, 19922944
    s_and_b32 s58, s51, 1
    s_mul_i32 s58, s58, 8192
    s_add_u32 s58, s58, 19922944
    v_lshrrev_b32 v28, 1, v0
    v_mul_u32_u24 v28, 32, v28
    v_add_u32 v28, s58, v28
    v_lshrrev_b32 v123, 4, v2
    v_mul_u32_u24 v120, 1024, v123
    v_add3_u32 v120, v120, v3, s61
    v_bfe_u32 v121, v2, 2, 2
    v_mul_u32_u24 v121, 1280, v121
    v_lshl_add_u32 v121, v123, 4, v121
    v_and_b32_e64 v122, 1, v2
    v_mul_u32_u24 v122, 10304, v122
    v_and_b32_e64 v123, 2, v2
    v_lshl_add_u32 v121, v123, 2, v121
    s_mul_i32 s58, s3, 320
    s_add_u32 s58, s58, 100864
    v_add3_u32 v121, v121, v122, s58
    v_mul_u32_u24 v124, 16256, v104
    v_add_u32_e64 v124, v124, v125
    v_mov_b32 v126, 2130706432
    s_and_b32 s58, s3, 1
    s_lshl_b32 s58, s58, 13
    s_lshl_b32 s59, s63, 1
    s_lshr_b32 s60, s3, 1
    s_add_u32 s59, s59, s60
    s_lshl_b32 s59, s59, 4
    s_add_u32 s58, s58, s59
    s_add_u32 s58, s58, 4096
    s_or_b32 s58, s58, s62
    s_add_u32 s59, s58, 4096
    v_writelane_b32 v126, s58, 0
    v_writelane_b32 v126, s59, 32
    s_mov_b64 exec, 0
    s_cmp_eq_u32 s3, 0
    s_cbranch_scc1 L_stub0
    s_cmp_eq_u32 s3, 1
    s_cbranch_scc1 L_stub1
    s_cmp_eq_u32 s3, 2
    s_cbranch_scc1 L_stub2
    s_branch L_stub3
L_tdone:
    s_mov_b64 exec, -1
    s_waitcnt lgkmcnt(0)
    s_mul_i32 s50, s67, 1664525
    s_add_u32 s50, s50, 1013904223
    s_lshl_b32 s59, s68, 16
    s_and_b32 s68, s68, 0xffff0000
    s_lshl_b32 s67, s69, 16
    s_and_b32 s69, s69, 0xffff0000
    s_and_b32 s58, s56, 1
    s_cselect_b32 s68, s68, s59
    s_cselect_b32 s69, s69, s67
    v_mov_b32 v226, s68
    v_mul_f32 v226, 0x3fb8aa3b, v226
    v_exp_f32 v226, v226
    v_mov_b32 v245, 0
    v_writelane_b32 v245, s69, 0
    v_cvt_pk_bf16_f32 v226, 0, v226
    v_mul_f32 v220, 0x3fb8aa3b, v226
    v_mul_f32_e64 v223, 0.15915494, v226
    v_mul_f32 v221, 0x41000000, v220
    v_mul_f32 v224, 0x41000000, v223
    v_mul_f32 v222, 0x43800000, v220
    v_mul_f32 v225, 0x43800000, v223
    s_mul_i32 s58, s3, 655360
    s_lshl_b32 s59, s63, 7
    s_add_u32 s58, s58, s59
    s_add_u32 s60, s58, 1048576
    s_mov_b32 s59, 0x3f803f80
    s_waitcnt vmcnt(6)
    ds_read_b128 v[128:131], v120 offset:0
    ds_read_b128 v[132:135], v120 offset:256
    ds_read_b128 v[136:139], v120 offset:512
    ds_read_b128 v[140:143], v120 offset:768
    ds_read_b128 v[144:147], v120 offset:1024
    s_barrier
    ds_read_b64_tr_b16 v[32:33], v121 offset:0
    ds_read_b64_tr_b16 v[34:35], v121 offset:5152
    ds_read_b64_tr_b16 v[36:37], v121 offset:64
    ds_read_b64_tr_b16 v[38:39], v121 offset:5216
    ds_read_b64_tr_b16 v[40:41], v121 offset:128
    ds_read_b64_tr_b16 v[42:43], v121 offset:5280
    ds_read_b64_tr_b16 v[44:45], v121 offset:192
    ds_read_b64_tr_b16 v[46:47], v121 offset:5344
    ds_read_b64_tr_b16 v[48:49], v121 offset:256
    ds_read_b64_tr_b16 v[50:51], v121 offset:5408
    s_waitcnt lgkmcnt(14)
    s_nop 0
    v_dot2_f32_bf16 v116, v128, s59, 0
    v_dot2_f32_bf16 v117, v128, v128, 0
    v_dot2_f32_bf16 v116, v129, s59, v116
    v_dot2_f32_bf16 v117, v129, v129, v117
    v_dot2_f32_bf16 v116, v130, s59, v116
    v_dot2_f32_bf16 v117, v130, v130, v117
    v_dot2_f32_bf16 v116, v131, s59, v116
    v_dot2_f32_bf16 v117, v131, v131, v117
    s_waitcnt lgkmcnt(8)
    s_nop 0
    buffer_store_dwordx4 v[32:35], v124, s[4:7], s60 offen sc1
    s_add_u32 s60, s60, 131072
    v_dot2_f32_bf16 v116, v132, s59, v116
    v_dot2_f32_bf16 v117, v132, v132, v117
    v_dot2_f32_bf16 v116, v133, s59, v116
    v_dot2_f32_bf16 v117, v133, v133, v117
    v_dot2_f32_bf16 v116, v134, s59, v116
    v_dot2_f32_bf16 v117, v134, v134, v117
    v_dot2_f32_bf16 v116, v135, s59, v116
    v_dot2_f32_bf16 v117, v135, v135, v117
    v_dot2_f32_bf16 v116, v136, s59, v116
    v_dot2_f32_bf16 v117, v136, v136, v117
    v_dot2_f32_bf16 v116, v137, s59, v116
    v_dot2_f32_bf16 v117, v137, v137, v117
    v_dot2_f32_bf16 v116, v138, s59, v116
    v_dot2_f32_bf16 v117, v138, v138, v117
    v_dot2_f32_bf16 v116, v139, s59, v116
    v_dot2_f32_bf16 v117, v139, v139, v117
    v_dot2_f32_bf16 v116, v140, s59, v116
    v_dot2_f32_bf16 v117, v140, v140, v117
    v_dot2_f32_bf16 v116, v141, s59, v116
    v_dot2_f32_bf16 v117, v141, v141, v117
    v_dot2_f32_bf16 v116, v142, s59, v116
    v_dot2_f32_bf16 v117, v142, v142, v117
    v_dot2_f32_bf16 v116, v143, s59, v116
    v_dot2_f32_bf16 v117, v143, v143, v117
    v_dot2_f32_bf16 v116, v144, s59, v116
    v_dot2_f32_bf16 v117, v144, v144, v117
    v_dot2_f32_bf16 v116, v145, s59, v116
    v_dot2_f32_bf16 v117, v145, v145, v117
    v_dot2_f32_bf16 v116, v146, s59, v116
    v_dot2_f32_bf16 v117, v146, v146, v117
    v_dot2_f32_bf16 v116, v147, s59, v116
    v_dot2_f32_bf16 v117, v147, v147, v117
    s_waitcnt lgkmcnt(6)
    buffer_store_dwordx4 v[36:39], v124, s[4:7], s60 offen sc1
    s_add_u32 s60, s60, 131072
    v_add_f32_dpp v116, v116, v116 row_ror:8 row_mask:0xf bank_mask:0xf
    v_add_f32_dpp v117, v117, v117 row_ror:8 row_mask:0xf bank_mask:0xf
    s_nop 0
    v_add_f32_dpp v116, v116, v116 row_ror:4 row_mask:0xf bank_mask:0xf
    v_add_f32_dpp v117, v117, v117 row_ror:4 row_mask:0xf bank_mask:0xf
    s_nop 0
    v_add_f32_dpp v116, v116, v116 row_ror:2 row_mask:0xf bank_mask:0xf
    v_add_f32_dpp v117, v117, v117 row_ror:2 row_mask:0xf bank_mask:0xf
    s_nop 0
    v_add_f32_dpp v116, v116, v116 row_ror:1 row_mask:0xf bank_mask:0xf
    v_add_f32_dpp v117, v117, v117 row_ror:1 row_mask:0xf bank_mask:0xf
    v_mul_f32 v116, 0x3acccccd, v116
    v_mul_f32 v117, 0x3acccccd, v117
    v_fma_f32 v117, -v116, v116, v117
    v_max_f32_e64 v117, 0, v117
    v_cvt_pk_bf16_f32 v117, 0, v117
    v_add_f32 v117, 0x3727c5ac, v117
    v_cvt_pk_bf16_f32 v117, 0, v117
    v_sqrt_f32 v117, v117
    s_nop 0
    v_cvt_pk_bf16_f32 v118, v116, v117
    v_and_b32 v116, 0xffff0000, v118
    v_rcp_f32 v116, v116
    v_lshlrev_b32 v118, 16, v118
    v_mul_f32 v118, -v118, v116
    v_permlane16_swap_b32 v116, v117
    s_nop 0
    v_permlane16_swap_b32 v118, v119
    buffer_store_dwordx4 v[116:119], v126, s[4:7], 0 offen sc1
    s_waitcnt lgkmcnt(4)
    buffer_store_dwordx4 v[40:43], v124, s[4:7], s60 offen sc1
    s_add_u32 s60, s60, 131072
    s_branch L_main
L_sp_pro:
    s_mul_i32 s70, s51, 12
    s_add_u32 s70, s70, s52
    s_sub_u32 s70, s70, 20
    v_min_u32 v12, 159, v0
    v_lshlrev_b32 v12, 3, v12
    s_lshr_b32 s58, s70, 1
    s_mul_hi_u32 s59, s58, 429496730
    s_mul_i32 s71, s59, 10
    s_sub_u32 s58, s58, s71
    s_lshl_b32 s59, s59, 2
    s_lshr_b32 s59, 0x534210, s59
    s_and_b32 s59, s59, 15
    s_mul_i32 s71, s59, 640
    s_lshl_b32 s58, s58, 6
    s_add_u32 s71, s71, s58
    s_and_b32 s58, s70, 1
    s_mul_i32 s58, s58, 2457600
    s_mul_i32 s59, s3, 614400
    s_add_u32 s72, s58, s59
    s_lshl_b32 s58, s71, 1
    s_add_u32 s72, s72, s58
    s_mul_i32 s73, s3, 10240
    s_waitcnt lgkmcnt(0)
    s_mov_b64 s[4:5], s[30:31]
    s_mov_b64 s[12:13], s[26:27]
    s_mov_b64 s[28:29], s[24:25]
    s_mov_b64 s[48:49], s[22:23]
    s_mov_b64 s[24:25], s[20:21]
    s_mov_b64 s[20:21], s[18:19]
    s_mov_b32 s30, 4915200
    s_mov_b32 s31, s11
    global_load_dwordx2 v[200:201], v12, s[48:49]
    s_add_u32 m0, s73, 0
    s_nop 0
    buffer_load_dwordx4 v110, s[28:31], s72 offen nt lds
    s_mov_b32 s0, 1
    s_load_dword s67, s[4:5], 0
    s_mov_b32 s6, 20971520
    s_mov_b32 s7, s11
    s_mov_b32 s14, s10
    s_mov_b32 s15, s11
    s_mov_b32 s18, 1966080
    s_mov_b32 s19, s11
    s_mov_b32 s22, s18
    s_mov_b32 s23, s11
    s_mov_b32 s26, s18
    s_mov_b32 s27, s11
    s_branch L_spare
L_tdone2:
    s_mov_b64 exec, -1
    s_cmp_eq_u32 s0, 1
    s_cbranch_scc1 L_sp_t2
    s_branch L_cv_t2
L_exit:
    s_endpgm
.p2align 12
L_main:
L_stub0:
    s_cbranch_execz L_tdone
    s_mov_b32 m0, s70
    s_waitcnt vmcnt(9)
    v_perm_b32 v200, v207, v206, v194
    s_waitcnt vmcnt(8)
    v_perm_b32 v201, v209, v208, v194
    s_waitcnt vmcnt(7)
    v_perm_b32 v202, v211, v210, v194
    s_waitcnt vmcnt(6)
    v_perm_b32 v203, v213, v212, v194
    s_waitcnt vmcnt(5)
    v_perm_b32 v204, v215, v214, v194
    s_waitcnt vmcnt(4)
    v_perm_b32 v205, v217, v216, v194
    v_mul_f32 v66, v200, v220
    v_mul_f32 v61, v201, v223
    v_mul_f32 v67, v200, v221
    v_mul_f32 v63, v201, v224
    v_mul_f32 v68, v200, v222
    v_mul_f32 v65, v201, v225
    v_exp_f32 v66, v66
    v_fract_f32 v61, v61
    v_exp_f32 v67, v67
    v_fract_f32 v63, v63
    v_exp_f32 v68, v68
    v_fract_f32 v65, v65
    v_cos_f32 v60, v61
    v_sin_f32 v61, v61
    v_cos_f32 v62, v63
    v_sin_f32 v63, v63
    v_cos_f32 v64, v65
    v_sin_f32 v65, v65
    v_mul_f32 v60, v60, v66
    v_mul_f32 v61, v61, v66
    v_mul_f32 v62, v62, v67
    v_mul_f32 v63, v63, v67
    v_mul_f32 v64, v64, v68
    v_mul_f32 v65, v65, v68
    v_mul_f32 v202, v202, v226
    v_mul_f32 v203, v203, v226
    s_waitcnt lgkmcnt(2)
    s_nop 0
    buffer_store_dwordx4 v[44:47], v124, s[4:7], s60 offen sc1
    s_add_u32 s60, s60, 131072
    v_pk_mul_f32 v[70:71], v[204:205], v[202:203] op_sel:[0,0] op_sel_hi:[1,0]
    v_pk_fma_f32 v[76:77], v[204:205], v[202:203], v[70:71] op_sel:[1,1,0] op_sel_hi:[0,1,1] neg_lo:[1,0,0]
    v_cvt_pk_bf16_f32 v230, v76, -v77
    v_pk_mul_f32 v[70:71], v[76:77], v[60:61] op_sel:[0,0] op_sel_hi:[1,0]
    v_pk_fma_f32 v[78:79], v[76:77], v[60:61], v[70:71] op_sel:[1,1,0] op_sel_hi:[0,1,1] neg_lo:[1,0,0]
    v_cvt_pk_bf16_f32 v231, v78, -v79
    v_pk_mul_f32 v[70:71], v[78:79], v[60:61] op_sel:[0,0] op_sel_hi:[1,0]
    v_pk_fma_f32 v[80:81], v[78:79], v[60:61], v[70:71] op_sel:[1,1,0] op_sel_hi:[0,1,1] neg_lo:[1,0,0]
    v_cvt_pk_bf16_f32 v232, v80, -v81
    v_pk_mul_f32 v[70:71], v[80:81], v[60:61] op_sel:[0,0] op_sel_hi:[1,0]
    v_pk_fma_f32 v[82:83], v[80:81], v[60:61], v[70:71] op_sel:[1,1,0] op_sel_hi:[0,1,1] neg_lo:[1,0,0]
    v_cvt_pk_bf16_f32 v233, v82, -v83
    v_pk_mul_f32 v[70:71], v[82:83], v[60:61] op_sel:[0,0] op_sel_hi:[1,0]
    v_pk_fma_f32 v[84:85], v[82:83], v[60:61], v[70:71] op_sel:[1,1,0] op_sel_hi:[0,1,1] neg_lo:[1,0,0]
    v_cvt_pk_bf16_f32 v234, v84, -v85
    v_pk_mul_f32 v[70:71], v[84:85], v[60:61] op_sel:[0,0] op_sel_hi:[1,0]
    v_pk_fma_f32 v[86:87], v[84:85], v[60:61], v[70:71] op_sel:[1,1,0] op_sel_hi:[0,1,1] neg_lo:[1,0,0]
    v_cvt_pk_bf16_f32 v235, v86, -v87
    v_pk_mul_f32 v[70:71], v[86:87], v[60:61] op_sel:[0,0] op_sel_hi:[1,0]
    v_pk_fma_f32 v[88:89], v[86:87], v[60:61], v[70:71] op_sel:[1,1,0] op_sel_hi:[0,1,1] neg_lo:[1,0,0]
    v_cvt_pk_bf16_f32 v236, v88, -v89
    v_pk_mul_f32 v[70:71], v[88:89], v[60:61] op_sel:[0,0] op_sel_hi:[1,0]
    v_pk_fma_f32 v[90:91], v[88:89], v[60:61], v[70:71] op_sel:[1,1,0] op_sel_hi:[0,1,1] neg_lo:[1,0,0]
    v_cvt_pk_bf16_f32 v237, v90, -v91
    v_pk_mul_f32 v[70:71], v[90:91], v[60:61] op_sel:[0,0] op_sel_hi:[1,0]
    v_pk_fma_f32 v[92:93], v[90:91], v[60:61], v[70:71] op_sel:[1,1,0] op_sel_hi:[0,1,1] neg_lo:[1,0,0]
    v_cvt_pk_bf16_f32 v238, v92, -v93
    v_pk_mul_f32 v[70:71], v[76:77], v[64:65] op_sel:[0,0] op_sel_hi:[1,0]
    v_pk_fma_f32 v[76:77], v[76:77], v[64:65], v[70:71] op_sel:[1,1,0] op_sel_hi:[0,1,1] neg_lo:[1,0,0]
    v_cvt_pk_bf16_f32 v239, v76, -v77
    v_pk_mul_f32 v[70:71], v[80:81], v[64:65] op_sel:[0,0] op_sel_hi:[1,0]
    v_pk_fma_f32 v[80:81], v[80:81], v[64:65], v[70:71] op_sel:[1,1,0] op_sel_hi:[0,1,1] neg_lo:[1,0,0]
    v_cvt_pk_bf16_f32 v240, v80, -v81
    ds_write_addtid_b32 v230 offset:8704
    ds_write_addtid_b32 v231 offset:8976
    ds_write_addtid_b32 v232 offset:9248
    ds_write_addtid_b32 v233 offset:9520
    ds_write_addtid_b32 v234 offset:9792
    ds_write_addtid_b32 v235 offset:10064
    ds_write_addtid_b32 v236 offset:10336
    ds_write_addtid_b32 v237 offset:10608
    ds_write_addtid_b32 v238 offset:11968
    ds_write_addtid_b32 v239 offset:11152
    ds_write_addtid_b32 v240 offset:11424
    s_waitcnt lgkmcnt(11)
    buffer_store_dwordx4 v[48:51], v124, s[4:7], s60 offen sc1
    s_add_u32 m0, s66, 0
    v_cmp_gt_u32_e64 vcc, 32, v2
    buffer_load_dwordx4 v107, s[16:19], s32 offen nt lds
    s_add_u32 m0, s66, 1024
    v_add_u32 v197, -2048, v113
    buffer_load_dwordx4 v108, s[20:23], s32 offen nt lds
    s_add_u32 m0, s66, 2048
    s_sub_u32 s58, s37, s66
    buffer_load_dwordx4 v107, s[16:19], s33 offen nt lds
    s_add_u32 m0, s66, 3072
    v_cndmask_b32 v197, v197, v112, vcc
    buffer_load_dwordx4 v108, s[20:23], s33 offen nt lds
    s_add_u32 m0, s37, 0
    v_add_u32 v197, s58, v197
    buffer_load_dwordx4 v107, s[16:19], s34 offen nt lds
    s_add_u32 m0, s37, 1024
    v_xor_b32_e64 v198, 64, v197
    buffer_load_dwordx4 v108, s[20:23], s34 offen nt lds
    s_mov_b32 m0, s70
    s_nop 0
    v_pk_mul_f32 v[70:71], v[84:85], v[64:65] op_sel:[0,0] op_sel_hi:[1,0]
    v_pk_fma_f32 v[84:85], v[84:85], v[64:65], v[70:71] op_sel:[1,1,0] op_sel_hi:[0,1,1] neg_lo:[1,0,0]
    v_cvt_pk_bf16_f32 v230, v84, -v85
    v_pk_mul_f32 v[70:71], v[88:89], v[64:65] op_sel:[0,0] op_sel_hi:[1,0]
    v_pk_fma_f32 v[88:89], v[88:89], v[64:65], v[70:71] op_sel:[1,1,0] op_sel_hi:[0,1,1] neg_lo:[1,0,0]
    v_cvt_pk_bf16_f32 v231, v88, -v89
    v_pk_mul_f32 v[70:71], v[92:93], v[64:65] op_sel:[0,0] op_sel_hi:[1,0]
    v_pk_fma_f32 v[92:93], v[92:93], v[64:65], v[70:71] op_sel:[1,1,0] op_sel_hi:[0,1,1] neg_lo:[1,0,0]
    v_cvt_pk_bf16_f32 v232, v92, -v93
    v_pk_mul_f32 v[70:71], v[76:77], v[64:65] op_sel:[0,0] op_sel_hi:[1,0]
    v_pk_fma_f32 v[76:77], v[76:77], v[64:65], v[70:71] op_sel:[1,1,0] op_sel_hi:[0,1,1] neg_lo:[1,0,0]
    v_cvt_pk_bf16_f32 v233, v76, -v77
    v_pk_mul_f32 v[70:71], v[84:85], v[64:65] op_sel:[0,0] op_sel_hi:[1,0]
    v_pk_fma_f32 v[84:85], v[84:85], v[64:65], v[70:71] op_sel:[1,1,0] op_sel_hi:[0,1,1] neg_lo:[1,0,0]
    v_cvt_pk_bf16_f32 v234, v84, -v85
    v_pk_mul_f32 v[70:71], v[92:93], v[64:65] op_sel:[0,0] op_sel_hi:[1,0]
    v_pk_fma_f32 v[92:93], v[92:93], v[64:65], v[70:71] op_sel:[1,1,0] op_sel_hi:[0,1,1] neg_lo:[1,0,0]
    v_cvt_pk_bf16_f32 v235, v92, -v93
    v_pk_mul_f32 v[70:71], v[76:77], v[64:65] op_sel:[0,0] op_sel_hi:[1,0]
    v_pk_fma_f32 v[76:77], v[76:77], v[64:65], v[70:71] op_sel:[1,1,0] op_sel_hi:[0,1,1] neg_lo:[1,0,0]
    v_cvt_pk_bf16_f32 v236, v76, -v77
    v_pk_mul_f32 v[70:71], v[84:85], v[64:65] op_sel:[0,0] op_sel_hi:[1,0]
    v_pk_fma_f32 v[84:85], v[84:85], v[64:65], v[70:71] op_sel:[1,1,0] op_sel_hi:[0,1,1] neg_lo:[1,0,0]
    v_cvt_pk_bf16_f32 v237, v84, -v85
    v_pk_mul_f32 v[70:71], v[92:93], v[64:65] op_sel:[0,0] op_sel_hi:[1,0]
    v_pk_fma_f32 v[92:93], v[92:93], v[64:65], v[70:71] op_sel:[1,1,0] op_sel_hi:[0,1,1] neg_lo:[1,0,0]
    v_cvt_pk_bf16_f32 v238, v92, -v93
    v_pk_mul_f32 v[70:71], v[92:93], v[64:65] op_sel:[0,0] op_sel_hi:[1,0]
    v_pk_fma_f32 v[92:93], v[92:93], v[64:65], v[70:71] op_sel:[1,1,0] op_sel_hi:[0,1,1] neg_lo:[1,0,0]
    v_cvt_pk_bf16_f32 v239, v92, -v93
    v_pk_mul_f32 v[70:71], v[92:93], v[64:65] op_sel:[0,0] op_sel_hi:[1,0]
    v_pk_fma_f32 v[92:93], v[92:93], v[64:65], v[70:71] op_sel:[1,1,0] op_sel_hi:[0,1,1] neg_lo:[1,0,0]
    v_cvt_pk_bf16_f32 v240, v92, -v93
    ds_write_addtid_b32 v230 offset:11696
    ds_write_addtid_b32 v231 offset:12512
    ds_write_addtid_b32 v232 offset:12784
    ds_write_addtid_b32 v233 offset:13056
    ds_write_addtid_b32 v234 offset:13328
    ds_write_addtid_b32 v235 offset:13600
    ds_write_addtid_b32 v236 offset:14144
    ds_write_addtid_b32 v237 offset:14416
    ds_write_addtid_b32 v238 offset:14688
    ds_write_addtid_b32 v239 offset:13872
    ds_write_addtid_b32 v240 offset:14960
    v_pk_mul_f32 v[70:71], v[92:93], v[64:65] op_sel:[0,0] op_sel_hi:[1,0]
    v_pk_fma_f32 v[92:93], v[92:93], v[64:65], v[70:71] op_sel:[1,1,0] op_sel_hi:[0,1,1] neg_lo:[1,0,0]
    v_cvt_pk_bf16_f32 v230, v92, -v93
    v_pk_mul_f32 v[70:71], v[92:93], v[64:65] op_sel:[0,0] op_sel_hi:[1,0]
    v_pk_fma_f32 v[92:93], v[92:93], v[64:65], v[70:71] op_sel:[1,1,0] op_sel_hi:[0,1,1] neg_lo:[1,0,0]
    v_cvt_pk_bf16_f32 v231, v92, -v93
    v_cvt_pk_bf16_f32 v232, v62, v63
    v_pk_mul_f32 v[70:71], v[62:63], v[62:63] op_sel:[0,0] op_sel_hi:[1,0]
    v_pk_fma_f32 v[74:75], v[62:63], v[62:63], v[70:71] op_sel:[1,1,0] op_sel_hi:[0,1,1] neg_lo:[1,0,0]
    v_cvt_pk_bf16_f32 v233, v74, v75
    v_pk_mul_f32 v[70:71], v[74:75], v[62:63] op_sel:[0,0] op_sel_hi:[1,0]
    v_pk_fma_f32 v[74:75], v[74:75], v[62:63], v[70:71] op_sel:[1,1,0] op_sel_hi:[0,1,1] neg_lo:[1,0,0]
    v_cvt_pk_bf16_f32 v234, v74, v75
    v_pk_mul_f32 v[70:71], v[74:75], v[62:63] op_sel:[0,0] op_sel_hi:[1,0]
    v_pk_fma_f32 v[74:75], v[74:75], v[62:63], v[70:71] op_sel:[1,1,0] op_sel_hi:[0,1,1] neg_lo:[1,0,0]
    v_cvt_pk_bf16_f32 v235, v74, v75
    v_pk_mul_f32 v[70:71], v[74:75], v[62:63] op_sel:[0,0] op_sel_hi:[1,0]
    v_pk_fma_f32 v[74:75], v[74:75], v[62:63], v[70:71] op_sel:[1,1,0] op_sel_hi:[0,1,1] neg_lo:[1,0,0]
    v_cvt_pk_bf16_f32 v236, v74, v75
    v_pk_mul_f32 v[70:71], v[74:75], v[62:63] op_sel:[0,0] op_sel_hi:[1,0]
    v_pk_fma_f32 v[74:75], v[74:75], v[62:63], v[70:71] op_sel:[1,1,0] op_sel_hi:[0,1,1] neg_lo:[1,0,0]
    v_cvt_pk_bf16_f32 v237, v74, v75
    v_pk_mul_f32 v[70:71], v[74:75], v[62:63] op_sel:[0,0] op_sel_hi:[1,0]
    v_pk_fma_f32 v[74:75], v[74:75], v[62:63], v[70:71] op_sel:[1,1,0] op_sel_hi:[0,1,1] neg_lo:[1,0,0]
    v_cvt_pk_bf16_f32 v238, v74, v75
    v_pk_mul_f32 v[70:71], v[74:75], v[62:63] op_sel:[0,0] op_sel_hi:[1,0]
    v_pk_fma_f32 v[74:75], v[74:75], v[62:63], v[70:71] op_sel:[1,1,0] op_sel_hi:[0,1,1] neg_lo:[1,0,0]
    v_cvt_pk_bf16_f32 v239, v74, v75
    v_pk_mul_f32 v[70:71], v[74:75], v[62:63] op_sel:[0,0] op_sel_hi:[1,0]
    v_pk_fma_f32 v[74:75], v[74:75], v[62:63], v[70:71] op_sel:[1,1,0] op_sel_hi:[0,1,1] neg_lo:[1,0,0]
    v_cvt_pk_bf16_f32 v240, v74, v75
    ds_write_addtid_b32 v230 offset:10880
    ds_write_addtid_b32 v231 offset:12240
    ds_write_addtid_b32 v232 offset:272
    ds_write_addtid_b32 v233 offset:544
    ds_write_addtid_b32 v234 offset:816
    ds_write_addtid_b32 v235 offset:1088
    ds_write_addtid_b32 v236 offset:1360
    ds_write_addtid_b32 v237 offset:1632
    ds_write_addtid_b32 v238 offset:1904
    ds_write_addtid_b32 v239 offset:2176
    ds_write_addtid_b32 v240 offset:2448
    ds_read_b128 v[128:131], v227 offset:0
    ds_read_b128 v[136:139], v227 offset:32
    ds_read_b128 v[144:147], v227 offset:64
    v_pk_mul_f32 v[70:71], v[74:75], v[62:63] op_sel:[0,0] op_sel_hi:[1,0]
    v_pk_fma_f32 v[74:75], v[74:75], v[62:63], v[70:71] op_sel:[1,1,0] op_sel_hi:[0,1,1] neg_lo:[1,0,0]
    v_cvt_pk_bf16_f32 v230, v74, v75
    v_pk_mul_f32 v[70:71], v[74:75], v[62:63] op_sel:[0,0] op_sel_hi:[1,0]
    v_pk_fma_f32 v[74:75], v[74:75], v[62:63], v[70:71] op_sel:[1,1,0] op_sel_hi:[0,1,1] neg_lo:[1,0,0]
    v_cvt_pk_bf16_f32 v231, v74, v75
    v_pk_mul_f32 v[70:71], v[74:75], v[62:63] op_sel:[0,0] op_sel_hi:[1,0]
    v_pk_fma_f32 v[74:75], v[74:75], v[62:63], v[70:71] op_sel:[1,1,0] op_sel_hi:[0,1,1] neg_lo:[1,0,0]
    v_cvt_pk_bf16_f32 v232, v74, v75
    v_pk_mul_f32 v[70:71], v[74:75], v[62:63] op_sel:[0,0] op_sel_hi:[1,0]
    v_pk_fma_f32 v[74:75], v[74:75], v[62:63], v[70:71] op_sel:[1,1,0] op_sel_hi:[0,1,1] neg_lo:[1,0,0]
    v_cvt_pk_bf16_f32 v233, v74, v75
    v_pk_mul_f32 v[70:71], v[74:75], v[62:63] op_sel:[0,0] op_sel_hi:[1,0]
    v_pk_fma_f32 v[74:75], v[74:75], v[62:63], v[70:71] op_sel:[1,1,0] op_sel_hi:[0,1,1] neg_lo:[1,0,0]
    v_cvt_pk_bf16_f32 v234, v74, v75
    v_pk_mul_f32 v[70:71], v[74:75], v[62:63] op_sel:[0,0] op_sel_hi:[1,0]
    v_pk_fma_f32 v[74:75], v[74:75], v[62:63], v[70:71] op_sel:[1,1,0] op_sel_hi:[0,1,1] neg_lo:[1,0,0]
    v_cvt_pk_bf16_f32 v235, v74, v75
    v_pk_mul_f32 v[70:71], v[74:75], v[62:63] op_sel:[0,0] op_sel_hi:[1,0]
    v_pk_fma_f32 v[74:75], v[74:75], v[62:63], v[70:71] op_sel:[1,1,0] op_sel_hi:[0,1,1] neg_lo:[1,0,0]
    v_cvt_pk_bf16_f32 v236, v74, v75
    v_pk_mul_f32 v[70:71], v[74:75], v[62:63] op_sel:[0,0] op_sel_hi:[1,0]
    v_pk_fma_f32 v[74:75], v[74:75], v[62:63], v[70:71] op_sel:[1,1,0] op_sel_hi:[0,1,1] neg_lo:[1,0,0]
    v_cvt_pk_bf16_f32 v237, v74, v75
    v_pk_mul_f32 v[70:71], v[74:75], v[62:63] op_sel:[0,0] op_sel_hi:[1,0]
    v_pk_fma_f32 v[74:75], v[74:75], v[62:63], v[70:71] op_sel:[1,1,0] op_sel_hi:[0,1,1] neg_lo:[1,0,0]
    v_cvt_pk_bf16_f32 v238, v74, v75
    v_pk_mul_f32 v[70:71], v[74:75], v[62:63] op_sel:[0,0] op_sel_hi:[1,0]
    v_pk_fma_f32 v[74:75], v[74:75], v[62:63], v[70:71] op_sel:[1,1,0] op_sel_hi:[0,1,1] neg_lo:[1,0,0]
    v_cvt_pk_bf16_f32 v239, v74, v75
    v_pk_mul_f32 v[70:71], v[74:75], v[62:63] op_sel:[0,0] op_sel_hi:[1,0]
    v_pk_fma_f32 v[74:75], v[74:75], v[62:63], v[70:71] op_sel:[1,1,0] op_sel_hi:[0,1,1] neg_lo:[1,0,0]
    v_cvt_pk_bf16_f32 v240, v74, v75
    ds_write_addtid_b32 v230 offset:2720
    ds_write_addtid_b32 v231 offset:2992
    ds_write_addtid_b32 v232 offset:3264
    ds_write_addtid_b32 v233 offset:3536
    ds_write_addtid_b32 v234 offset:3808
    ds_write_addtid_b32 v235 offset:4080
    ds_write_addtid_b32 v236 offset:4352
    ds_write_addtid_b32 v237 offset:4624
    ds_write_addtid_b32 v238 offset:4896
    ds_write_addtid_b32 v239 offset:5168
    ds_write_addtid_b32 v240 offset:5440
    ds_read_b128 v[152:155], v227 offset:96
    ds_read_b128 v[160:163], v227 offset:128
    ds_read_b128 v[168:171], v227 offset:160
    ds_read_b128 v[176:179], v227 offset:192
    ds_read_b128 v[184:187], v227 offset:224
    v_pk_mul_f32 v[70:71], v[74:75], v[62:63] op_sel:[0,0] op_sel_hi:[1,0]
    v_pk_fma_f32 v[74:75], v[74:75], v[62:63], v[70:71] op_sel:[1,1,0] op_sel_hi:[0,1,1] neg_lo:[1,0,0]
    v_cvt_pk_bf16_f32 v230, v74, v75
    v_pk_mul_f32 v[70:71], v[74:75], v[62:63] op_sel:[0,0] op_sel_hi:[1,0]
    v_pk_fma_f32 v[74:75], v[74:75], v[62:63], v[70:71] op_sel:[1,1,0] op_sel_hi:[0,1,1] neg_lo:[1,0,0]
    v_cvt_pk_bf16_f32 v231, v74, v75
    v_pk_mul_f32 v[70:71], v[74:75], v[62:63] op_sel:[0,0] op_sel_hi:[1,0]
    v_pk_fma_f32 v[74:75], v[74:75], v[62:63], v[70:71] op_sel:[1,1,0] op_sel_hi:[0,1,1] neg_lo:[1,0,0]
    v_cvt_pk_bf16_f32 v232, v74, v75
    v_pk_mul_f32 v[70:71], v[74:75], v[62:63] op_sel:[0,0] op_sel_hi:[1,0]
    v_pk_fma_f32 v[74:75], v[74:75], v[62:63], v[70:71] op_sel:[1,1,0] op_sel_hi:[0,1,1] neg_lo:[1,0,0]
    v_cvt_pk_bf16_f32 v233, v74, v75
    v_pk_mul_f32 v[70:71], v[74:75], v[62:63] op_sel:[0,0] op_sel_hi:[1,0]
    v_pk_fma_f32 v[74:75], v[74:75], v[62:63], v[70:71] op_sel:[1,1,0] op_sel_hi:[0,1,1] neg_lo:[1,0,0]
    v_cvt_pk_bf16_f32 v234, v74, v75
    v_pk_mul_f32 v[70:71], v[74:75], v[62:63] op_sel:[0,0] op_sel_hi:[1,0]
    v_pk_fma_f32 v[74:75], v[74:75], v[62:63], v[70:71] op_sel:[1,1,0] op_sel_hi:[0,1,1] neg_lo:[1,0,0]
    v_cvt_pk_bf16_f32 v235, v74, v75
    v_pk_mul_f32 v[70:71], v[74:75], v[62:63] op_sel:[0,0] op_sel_hi:[1,0]
    v_pk_fma_f32 v[74:75], v[74:75], v[62:63], v[70:71] op_sel:[1,1,0] op_sel_hi:[0,1,1] neg_lo:[1,0,0]
    v_cvt_pk_bf16_f32 v236, v74, v75
    v_pk_mul_f32 v[70:71], v[74:75], v[62:63] op_sel:[0,0] op_sel_hi:[1,0]
    v_pk_fma_f32 v[74:75], v[74:75], v[62:63], v[70:71] op_sel:[1,1,0] op_sel_hi:[0,1,1] neg_lo:[1,0,0]
    v_cvt_pk_bf16_f32 v237, v74, v75
    v_pk_mul_f32 v[70:71], v[74:75], v[62:63] op_sel:[0,0] op_sel_hi:[1,0]
    v_pk_fma_f32 v[74:75], v[74:75], v[62:63], v[70:71] op_sel:[1,1,0] op_sel_hi:[0,1,1] neg_lo:[1,0,0]
    v_cvt_pk_bf16_f32 v238, v74, v75
    v_pk_mul_f32 v[70:71], v[74:75], v[62:63] op_sel:[0,0] op_sel_hi:[1,0]
    v_pk_fma_f32 v[74:75], v[74:75], v[62:63], v[70:71] op_sel:[1,1,0] op_sel_hi:[0,1,1] neg_lo:[1,0,0]
    v_cvt_pk_bf16_f32 v239, v74, v75
    v_pk_mul_f32 v[70:71], v[74:75], v[62:63] op_sel:[0,0] op_sel_hi:[1,0]
    v_pk_fma_f32 v[74:75], v[74:75], v[62:63], v[70:71] op_sel:[1,1,0] op_sel_hi:[0,1,1] neg_lo:[1,0,0]
    v_cvt_pk_bf16_f32 v240, v74, v75
    ds_write_addtid_b32 v230 offset:5712
    ds_write_addtid_b32 v231 offset:5984
    ds_write_addtid_b32 v232 offset:6256
    ds_write_addtid_b32 v233 offset:6528
    ds_write_addtid_b32 v234 offset:6800
    ds_write_addtid_b32 v235 offset:7072
    ds_write_addtid_b32 v236 offset:7344
    ds_write_addtid_b32 v237 offset:7616
    ds_write_addtid_b32 v238 offset:7888
    ds_write_addtid_b32 v239 offset:8160
    ds_write_addtid_b32 v240 offset:8432
    ds_read_b128 v[132:135], v228 offset:0
    ds_read_b128 v[140:143], v228 offset:32
    ds_read_b128 v[148:151], v228 offset:64
    ds_read_b128 v[156:159], v228 offset:96
    ds_read_b128 v[164:167], v228 offset:128
    ds_read_b128 v[172:175], v228 offset:160
    ds_read_b128 v[180:183], v228 offset:192
    ds_read_b128 v[188:191], v228 offset:224
    v_perm_b32 v200, v207, v206, v195
    v_perm_b32 v201, v209, v208, v195
    v_perm_b32 v202, v211, v210, v195
    v_perm_b32 v203, v213, v212, v195
    v_perm_b32 v204, v215, v214, v195
    v_perm_b32 v205, v217, v216, v195
    v_mul_f32 v66, v200, v220
    v_mul_f32 v61, v201, v223
    v_mul_f32 v67, v200, v221
    v_mul_f32 v63, v201, v224
    v_mul_f32 v68, v200, v222
    v_mul_f32 v65, v201, v225
    s_waitcnt lgkmcnt(7)
    v_mfma_f32_32x32x16_bf16 v[96:111], v[128:131], v[132:135], 0
    s_waitcnt lgkmcnt(6)
    s_mul_i32 s42, s57, 16384
    v_exp_f32 v66, v66
    v_fract_f32 v61, v61
    v_exp_f32 v67, v67
    v_fract_f32 v63, v63
    v_mfma_f32_32x32x16_bf16 v[96:111], v[136:139], v[140:143], v[96:111]
    s_waitcnt lgkmcnt(5)
    s_lshl_b32 s43, s3, 12
    v_exp_f32 v68, v68
    v_fract_f32 v65, v65
    v_cos_f32 v60, v61
    s_add_u32 s42, s42, s43
    v_mfma_f32_32x32x16_bf16 v[96:111], v[144:147], v[148:151], v[96:111]
    s_waitcnt lgkmcnt(4)
    s_add_u32 s42, s42, 1048576
    v_sin_f32 v61, v61
    v_cos_f32 v62, v63
    v_sin_f32 v63, v63
    v_mfma_f32_32x32x16_bf16 v[96:111], v[152:155], v[156:159], v[96:111]
    s_waitcnt lgkmcnt(3)
    s_add_u32 s43, s43, 141312
    v_cos_f32 v64, v65
    v_sin_f32 v65, v65
    v_mul_f32 v60, v60, v66
    v_mul_f32_e64 v61, v61, v66
    v_mfma_f32_32x32x16_bf16 v[96:111], v[160:163], v[164:167], v[96:111]
    s_waitcnt lgkmcnt(2)
    s_movk_i32 s44, 4096
    v_mul_f32 v62, v62, v67
    v_mul_f32 v63, v63, v67
    v_mul_f32 v64, v64, v68
    v_mul_f32 v65, v65, v68
    v_mul_f32 v202, v202, v226
    v_mul_f32 v203, v203, v226
    v_mfma_f32_32x32x16_bf16 v[96:111], v[168:171], v[172:175], v[96:111]
    s_waitcnt lgkmcnt(1)
    s_movk_i32 s45, 8192
    s_movk_i32 s49, 12288
    s_movk_i32 s77, 16384
    v_mfma_f32_32x32x16_bf16 v[96:111], v[176:179], v[180:183], v[96:111]
    s_waitcnt lgkmcnt(0)
    v_mfma_f32_32x32x16_bf16 v[96:111], v[184:187], v[188:191], v[96:111]
    s_mov_b64 exec, 1
    s_waitcnt vmcnt(6)
    ds_add_rtn_u32 v59, v254, v255 offset:0
    s_mov_b64 exec, -1
    v_pk_mul_f32 v[70:71], v[204:205], v[202:203] op_sel:[0,0] op_sel_hi:[1,0]
    v_pk_fma_f32 v[76:77], v[204:205], v[202:203], v[70:71] op_sel:[1,1,0] op_sel_hi:[0,1,1] neg_lo:[1,0,0]
    v_cvt_pk_bf16_f32 v230, v76, -v77
    v_pk_mul_f32 v[70:71], v[76:77], v[60:61] op_sel:[0,0] op_sel_hi:[1,0]
    v_pk_fma_f32 v[78:79], v[76:77], v[60:61], v[70:71] op_sel:[1,1,0] op_sel_hi:[0,1,1] neg_lo:[1,0,0]
    v_cvt_pk_bf16_f32 v231, v78, -v79
    v_pk_mul_f32 v[70:71], v[78:79], v[60:61] op_sel:[0,0] op_sel_hi:[1,0]
    v_pk_fma_f32 v[80:81], v[78:79], v[60:61], v[70:71] op_sel:[1,1,0] op_sel_hi:[0,1,1] neg_lo:[1,0,0]
    v_cvt_pk_bf16_f32 v232, v80, -v81
    v_pk_mul_f32 v[70:71], v[80:81], v[60:61] op_sel:[0,0] op_sel_hi:[1,0]
    v_pk_fma_f32 v[82:83], v[80:81], v[60:61], v[70:71] op_sel:[1,1,0] op_sel_hi:[0,1,1] neg_lo:[1,0,0]
    v_cvt_pk_bf16_f32 v233, v82, -v83
    v_pk_mul_f32 v[70:71], v[82:83], v[60:61] op_sel:[0,0] op_sel_hi:[1,0]
    v_pk_fma_f32 v[84:85], v[82:83], v[60:61], v[70:71] op_sel:[1,1,0] op_sel_hi:[0,1,1] neg_lo:[1,0,0]
    v_cvt_pk_bf16_f32 v234, v84, -v85
    v_pk_mul_f32 v[70:71], v[84:85], v[60:61] op_sel:[0,0] op_sel_hi:[1,0]
    v_pk_fma_f32 v[86:87], v[84:85], v[60:61], v[70:71] op_sel:[1,1,0] op_sel_hi:[0,1,1] neg_lo:[1,0,0]
    v_cvt_pk_bf16_f32 v235, v86, -v87
    v_pk_mul_f32 v[70:71], v[86:87], v[60:61] op_sel:[0,0] op_sel_hi:[1,0]
    v_pk_fma_f32 v[88:89], v[86:87], v[60:61], v[70:71] op_sel:[1,1,0] op_sel_hi:[0,1,1] neg_lo:[1,0,0]
    v_cvt_pk_bf16_f32 v236, v88, -v89
    v_pk_mul_f32 v[70:71], v[88:89], v[60:61] op_sel:[0,0] op_sel_hi:[1,0]
    v_pk_fma_f32 v[90:91], v[88:89], v[60:61], v[70:71] op_sel:[1,1,0] op_sel_hi:[0,1,1] neg_lo:[1,0,0]
    v_cvt_pk_bf16_f32 v237, v90, -v91
    v_pk_mul_f32 v[70:71], v[90:91], v[60:61] op_sel:[0,0] op_sel_hi:[1,0]
    v_pk_fma_f32 v[92:93], v[90:91], v[60:61], v[70:71] op_sel:[1,1,0] op_sel_hi:[0,1,1] neg_lo:[1,0,0]
    v_cvt_pk_bf16_f32 v238, v92, -v93
    v_pk_mul_f32 v[70:71], v[76:77], v[64:65] op_sel:[0,0] op_sel_hi:[1,0]
    v_pk_fma_f32 v[76:77], v[76:77], v[64:65], v[70:71] op_sel:[1,1,0] op_sel_hi:[0,1,1] neg_lo:[1,0,0]
    v_cvt_pk_bf16_f32 v239, v76, -v77
    v_pk_mul_f32 v[70:71], v[80:81], v[64:65] op_sel:[0,0] op_sel_hi:[1,0]
    v_pk_fma_f32 v[80:81], v[80:81], v[64:65], v[70:71] op_sel:[1,1,0] op_sel_hi:[0,1,1] neg_lo:[1,0,0]
    v_cvt_pk_bf16_f32 v240, v80, -v81
    ds_write_addtid_b32 v230 offset:8704
    ds_write_addtid_b32 v231 offset:8976
    ds_write_addtid_b32 v232 offset:9248
    ds_write_addtid_b32 v233 offset:9520
    ds_write_addtid_b32 v234 offset:9792
    ds_write_addtid_b32 v235 offset:10064
    ds_write_addtid_b32 v236 offset:10336
    ds_write_addtid_b32 v237 offset:10608
    ds_write_addtid_b32 v238 offset:11968
    ds_write_addtid_b32 v239 offset:11152
    ds_write_addtid_b32 v240 offset:11424
    s_waitcnt lgkmcnt(11)
    v_readfirstlane_b32 s58, v59
    s_nop 0
    s_cmp_lg_u32 s58, 3
    s_cbranch_scc1 L_nopub0
    s_atomic_swap s50, s[4:5], s65 offset:0
    s_atomic_swap s50, s[4:5], s65 offset:8192
L_nopub0:
    s_waitcnt vmcnt(0)
    ds_read_b64_tr_b16 v[32:33], v112 offset:0
    ds_read_b64_tr_b16 v[34:35], v112 offset:512
    ds_read_b64_tr_b16 v[36:37], v113 offset:0
    ds_read_b64_tr_b16 v[38:39], v113 offset:512
    ds_read_b64_tr_b16 v[40:41], v114 offset:0
    ds_read_b64_tr_b16 v[42:43], v114 offset:512
    ds_read_b64_tr_b16 v[44:45], v115 offset:0
    ds_read_b64_tr_b16 v[46:47], v115 offset:512
    ds_read_b64_tr_b16 v[48:49], v197
    ds_read_b64_tr_b16 v[50:51], v197 offset:512
    ds_read_b64_tr_b16 v[52:53], v198
    ds_read_b64_tr_b16 v[54:55], v198 offset:512
    v_pk_mul_f32 v[70:71], v[84:85], v[64:65] op_sel:[0,0] op_sel_hi:[1,0]
    v_pk_fma_f32 v[84:85], v[84:85], v[64:65], v[70:71] op_sel:[1,1,0] op_sel_hi:[0,1,1] neg_lo:[1,0,0]
    v_cvt_pk_bf16_f32 v230, v84, -v85
    v_pk_mul_f32 v[70:71], v[88:89], v[64:65] op_sel:[0,0] op_sel_hi:[1,0]
    v_pk_fma_f32 v[88:89], v[88:89], v[64:65], v[70:71] op_sel:[1,1,0] op_sel_hi:[0,1,1] neg_lo:[1,0,0]
    v_cvt_pk_bf16_f32 v231, v88, -v89
    v_pk_mul_f32 v[70:71], v[92:93], v[64:65] op_sel:[0,0] op_sel_hi:[1,0]
    v_pk_fma_f32 v[92:93], v[92:93], v[64:65], v[70:71] op_sel:[1,1,0] op_sel_hi:[0,1,1] neg_lo:[1,0,0]
    v_cvt_pk_bf16_f32 v232, v92, -v93
    v_pk_mul_f32 v[70:71], v[76:77], v[64:65] op_sel:[0,0] op_sel_hi:[1,0]
    v_pk_fma_f32 v[76:77], v[76:77], v[64:65], v[70:71] op_sel:[1,1,0] op_sel_hi:[0,1,1] neg_lo:[1,0,0]
    v_cvt_pk_bf16_f32 v233, v76, -v77
    v_pk_mul_f32 v[70:71], v[84:85], v[64:65] op_sel:[0,0] op_sel_hi:[1,0]
    v_pk_fma_f32 v[84:85], v[84:85], v[64:65], v[70:71] op_sel:[1,1,0] op_sel_hi:[0,1,1] neg_lo:[1,0,0]
    v_cvt_pk_bf16_f32 v234, v84, -v85
    v_pk_mul_f32 v[70:71], v[92:93], v[64:65] op_sel:[0,0] op_sel_hi:[1,0]
    v_pk_fma_f32 v[92:93], v[92:93], v[64:65], v[70:71] op_sel:[1,1,0] op_sel_hi:[0,1,1] neg_lo:[1,0,0]
    v_cvt_pk_bf16_f32 v235, v92, -v93
    v_pk_mul_f32 v[70:71], v[76:77], v[64:65] op_sel:[0,0] op_sel_hi:[1,0]
    v_pk_fma_f32 v[76:77], v[76:77], v[64:65], v[70:71] op_sel:[1,1,0] op_sel_hi:[0,1,1] neg_lo:[1,0,0]
    v_cvt_pk_bf16_f32 v236, v76, -v77
    v_pk_mul_f32 v[70:71], v[84:85], v[64:65] op_sel:[0,0] op_sel_hi:[1,0]
    v_pk_fma_f32 v[84:85], v[84:85], v[64:65], v[70:71] op_sel:[1,1,0] op_sel_hi:[0,1,1] neg_lo:[1,0,0]
    v_cvt_pk_bf16_f32 v237, v84, -v85
    v_pk_mul_f32 v[70:71], v[92:93], v[64:65] op_sel:[0,0] op_sel_hi:[1,0]
    v_pk_fma_f32 v[92:93], v[92:93], v[64:65], v[70:71] op_sel:[1,1,0] op_sel_hi:[0,1,1] neg_lo:[1,0,0]
    v_cvt_pk_bf16_f32 v238, v92, -v93
    v_pk_mul_f32 v[70:71], v[92:93], v[64:65] op_sel:[0,0] op_sel_hi:[1,0]
    v_pk_fma_f32 v[92:93], v[92:93], v[64:65], v[70:71] op_sel:[1,1,0] op_sel_hi:[0,1,1] neg_lo:[1,0,0]
    v_cvt_pk_bf16_f32 v239, v92, -v93
    v_pk_mul_f32 v[70:71], v[92:93], v[64:65] op_sel:[0,0] op_sel_hi:[1,0]
    v_pk_fma_f32 v[92:93], v[92:93], v[64:65], v[70:71] op_sel:[1,1,0] op_sel_hi:[0,1,1] neg_lo:[1,0,0]
    v_cvt_pk_bf16_f32 v240, v92, -v93
    ds_write_addtid_b32 v230 offset:11696
    ds_write_addtid_b32 v231 offset:12512
    ds_write_addtid_b32 v232 offset:12784
    ds_write_addtid_b32 v233 offset:13056
    ds_write_addtid_b32 v234 offset:13328
    ds_write_addtid_b32 v235 offset:13600
    ds_write_addtid_b32 v236 offset:14144
    ds_write_addtid_b32 v237 offset:14416
    ds_write_addtid_b32 v238 offset:14688
    ds_write_addtid_b32 v239 offset:13872
    ds_write_addtid_b32 v240 offset:14960
    s_waitcnt lgkmcnt(15)
    s_nop 0
    buffer_store_dwordx4 v[32:35], v3, s[4:7], s35 offen sc1
    s_add_u32 s35, s35, 40960
    buffer_store_dwordx4 v[36:39], v3, s[4:7], s35 offen sc1
    s_add_u32 s35, s35, 40960
    v_pk_mul_f32 v[70:71], v[92:93], v[64:65] op_sel:[0,0] op_sel_hi:[1,0]
    v_pk_fma_f32 v[92:93], v[92:93], v[64:65], v[70:71] op_sel:[1,1,0] op_sel_hi:[0,1,1] neg_lo:[1,0,0]
    v_cvt_pk_bf16_f32 v230, v92, -v93
    v_pk_mul_f32 v[70:71], v[92:93], v[64:65] op_sel:[0,0] op_sel_hi:[1,0]
    v_pk_fma_f32 v[92:93], v[92:93], v[64:65], v[70:71] op_sel:[1,1,0] op_sel_hi:[0,1,1] neg_lo:[1,0,0]
    v_cvt_pk_bf16_f32 v231, v92, -v93
    v_cvt_pk_bf16_f32 v232, v62, v63
    v_pk_mul_f32 v[70:71], v[62:63], v[62:63] op_sel:[0,0] op_sel_hi:[1,0]
    v_pk_fma_f32 v[74:75], v[62:63], v[62:63], v[70:71] op_sel:[1,1,0] op_sel_hi:[0,1,1] neg_lo:[1,0,0]
    v_cvt_pk_bf16_f32 v233, v74, v75
    v_pk_mul_f32 v[70:71], v[74:75], v[62:63] op_sel:[0,0] op_sel_hi:[1,0]
    v_pk_fma_f32 v[74:75], v[74:75], v[62:63], v[70:71] op_sel:[1,1,0] op_sel_hi:[0,1,1] neg_lo:[1,0,0]
    v_cvt_pk_bf16_f32 v234, v74, v75
    v_pk_mul_f32 v[70:71], v[74:75], v[62:63] op_sel:[0,0] op_sel_hi:[1,0]
    v_pk_fma_f32 v[74:75], v[74:75], v[62:63], v[70:71] op_sel:[1,1,0] op_sel_hi:[0,1,1] neg_lo:[1,0,0]
    v_cvt_pk_bf16_f32 v235, v74, v75
    v_pk_mul_f32 v[70:71], v[74:75], v[62:63] op_sel:[0,0] op_sel_hi:[1,0]
    v_pk_fma_f32 v[74:75], v[74:75], v[62:63], v[70:71] op_sel:[1,1,0] op_sel_hi:[0,1,1] neg_lo:[1,0,0]
    v_cvt_pk_bf16_f32 v236, v74, v75
    v_pk_mul_f32 v[70:71], v[74:75], v[62:63] op_sel:[0,0] op_sel_hi:[1,0]
    v_pk_fma_f32 v[74:75], v[74:75], v[62:63], v[70:71] op_sel:[1,1,0] op_sel_hi:[0,1,1] neg_lo:[1,0,0]
    v_cvt_pk_bf16_f32 v237, v74, v75
    v_pk_mul_f32 v[70:71], v[74:75], v[62:63] op_sel:[0,0] op_sel_hi:[1,0]
    v_pk_fma_f32 v[74:75], v[74:75], v[62:63], v[70:71] op_sel:[1,1,0] op_sel_hi:[0,1,1] neg_lo:[1,0,0]
    v_cvt_pk_bf16_f32 v238, v74, v75
    v_pk_mul_f32 v[70:71], v[74:75], v[62:63] op_sel:[0,0] op_sel_hi:[1,0]
    v_pk_fma_f32 v[74:75], v[74:75], v[62:63], v[70:71] op_sel:[1,1,0] op_sel_hi:[0,1,1] neg_lo:[1,0,0]
    v_cvt_pk_bf16_f32 v239, v74, v75
    v_pk_mul_f32 v[70:71], v[74:75], v[62:63] op_sel:[0,0] op_sel_hi:[1,0]
    v_pk_fma_f32 v[74:75], v[74:75], v[62:63], v[70:71] op_sel:[1,1,0] op_sel_hi:[0,1,1] neg_lo:[1,0,0]
    v_cvt_pk_bf16_f32 v240, v74, v75
    ds_write_addtid_b32 v230 offset:10880
    ds_write_addtid_b32 v231 offset:12240
    ds_write_addtid_b32 v232 offset:272
    ds_write_addtid_b32 v233 offset:544
    ds_write_addtid_b32 v234 offset:816
    ds_write_addtid_b32 v235 offset:1088
    ds_write_addtid_b32 v236 offset:1360
    ds_write_addtid_b32 v237 offset:1632
    ds_write_addtid_b32 v238 offset:1904
    ds_write_addtid_b32 v239 offset:2176
    ds_write_addtid_b32 v240 offset:2448
    ds_read_b128 v[128:131], v227 offset:0
    ds_read_b128 v[136:139], v227 offset:32
    ds_read_b128 v[144:147], v227 offset:64
    buffer_store_dwordx4 v[40:43], v3, s[4:7], s35 offen sc1
    s_add_u32 s35, s35, 40960
    buffer_store_dwordx4 v[44:47], v3, s[4:7], s35 offen sc1
    v_pk_mul_f32 v[70:71], v[74:75], v[62:63] op_sel:[0,0] op_sel_hi:[1,0]
    v_pk_fma_f32 v[74:75], v[74:75], v[62:63], v[70:71] op_sel:[1,1,0] op_sel_hi:[0,1,1] neg_lo:[1,0,0]
    v_cvt_pk_bf16_f32 v230, v74, v75
    v_pk_mul_f32 v[70:71], v[74:75], v[62:63] op_sel:[0,0] op_sel_hi:[1,0]
    v_pk_fma_f32 v[74:75], v[74:75], v[62:63], v[70:71] op_sel:[1,1,0] op_sel_hi:[0,1,1] neg_lo:[1,0,0]
    v_cvt_pk_bf16_f32 v231, v74, v75
    v_pk_mul_f32 v[70:71], v[74:75], v[62:63] op_sel:[0,0] op_sel_hi:[1,0]
    v_pk_fma_f32 v[74:75], v[74:75], v[62:63], v[70:71] op_sel:[1,1,0] op_sel_hi:[0,1,1] neg_lo:[1,0,0]
    v_cvt_pk_bf16_f32 v232, v74, v75
    v_pk_mul_f32 v[70:71], v[74:75], v[62:63] op_sel:[0,0] op_sel_hi:[1,0]
    v_pk_fma_f32 v[74:75], v[74:75], v[62:63], v[70:71] op_sel:[1,1,0] op_sel_hi:[0,1,1] neg_lo:[1,0,0]
    v_cvt_pk_bf16_f32 v233, v74, v75
    v_pk_mul_f32 v[70:71], v[74:75], v[62:63] op_sel:[0,0] op_sel_hi:[1,0]
    v_pk_fma_f32 v[74:75], v[74:75], v[62:63], v[70:71] op_sel:[1,1,0] op_sel_hi:[0,1,1] neg_lo:[1,0,0]
    v_cvt_pk_bf16_f32 v234, v74, v75
    v_pk_mul_f32 v[70:71], v[74:75], v[62:63] op_sel:[0,0] op_sel_hi:[1,0]
    v_pk_fma_f32 v[74:75], v[74:75], v[62:63], v[70:71] op_sel:[1,1,0] op_sel_hi:[0,1,1] neg_lo:[1,0,0]
    v_cvt_pk_bf16_f32 v235, v74, v75
    v_pk_mul_f32 v[70:71], v[74:75], v[62:63] op_sel:[0,0] op_sel_hi:[1,0]
    v_pk_fma_f32 v[74:75], v[74:75], v[62:63], v[70:71] op_sel:[1,1,0] op_sel_hi:[0,1,1] neg_lo:[1,0,0]
    v_cvt_pk_bf16_f32 v236, v74, v75
    v_pk_mul_f32 v[70:71], v[74:75], v[62:63] op_sel:[0,0] op_sel_hi:[1,0]
    v_pk_fma_f32 v[74:75], v[74:75], v[62:63], v[70:71] op_sel:[1,1,0] op_sel_hi:[0,1,1] neg_lo:[1,0,0]
    v_cvt_pk_bf16_f32 v237, v74, v75
    v_pk_mul_f32 v[70:71], v[74:75], v[62:63] op_sel:[0,0] op_sel_hi:[1,0]
    v_pk_fma_f32 v[74:75], v[74:75], v[62:63], v[70:71] op_sel:[1,1,0] op_sel_hi:[0,1,1] neg_lo:[1,0,0]
    v_cvt_pk_bf16_f32 v238, v74, v75
    v_pk_mul_f32 v[70:71], v[74:75], v[62:63] op_sel:[0,0] op_sel_hi:[1,0]
    v_pk_fma_f32 v[74:75], v[74:75], v[62:63], v[70:71] op_sel:[1,1,0] op_sel_hi:[0,1,1] neg_lo:[1,0,0]
    v_cvt_pk_bf16_f32 v239, v74, v75
    v_pk_mul_f32 v[70:71], v[74:75], v[62:63] op_sel:[0,0] op_sel_hi:[1,0]
    v_pk_fma_f32 v[74:75], v[74:75], v[62:63], v[70:71] op_sel:[1,1,0] op_sel_hi:[0,1,1] neg_lo:[1,0,0]
    v_cvt_pk_bf16_f32 v240, v74, v75
    ds_write_addtid_b32 v230 offset:2720
    ds_write_addtid_b32 v231 offset:2992
    ds_write_addtid_b32 v232 offset:3264
L_stub1:
    s_cbranch_execz L_tdone
    s_nop 0
    ds_write_addtid_b32 v233 offset:3536
    ds_write_addtid_b32 v234 offset:3808
    ds_write_addtid_b32 v235 offset:4080
    ds_write_addtid_b32 v236 offset:4352
    ds_write_addtid_b32 v237 offset:4624
    ds_write_addtid_b32 v238 offset:4896
    ds_write_addtid_b32 v239 offset:5168
    ds_write_addtid_b32 v240 offset:5440
    ds_read_b128 v[152:155], v227 offset:96
    ds_read_b128 v[160:163], v227 offset:128
    ds_read_b128 v[168:171], v227 offset:160
    ds_read_b128 v[176:179], v227 offset:192
    ds_read_b128 v[184:187], v227 offset:224
    s_waitcnt lgkmcnt(15)
    s_nop 0
    buffer_store_dwordx4 v[48:51], v199, s[4:7], s36 offen sc1
    s_add_u32 s36, s36, 81920
    buffer_store_dwordx4 v[52:55], v199, s[4:7], s36 offen sc1
    v_pk_mul_f32 v[70:71], v[74:75], v[62:63] op_sel:[0,0] op_sel_hi:[1,0]
    v_pk_fma_f32 v[74:75], v[74:75], v[62:63], v[70:71] op_sel:[1,1,0] op_sel_hi:[0,1,1] neg_lo:[1,0,0]
    v_cvt_pk_bf16_f32 v230, v74, v75
    v_pk_mul_f32 v[70:71], v[74:75], v[62:63] op_sel:[0,0] op_sel_hi:[1,0]
    v_pk_fma_f32 v[74:75], v[74:75], v[62:63], v[70:71] op_sel:[1,1,0] op_sel_hi:[0,1,1] neg_lo:[1,0,0]
    v_cvt_pk_bf16_f32 v231, v74, v75
    v_pk_mul_f32 v[70:71], v[74:75], v[62:63] op_sel:[0,0] op_sel_hi:[1,0]
    v_pk_fma_f32 v[74:75], v[74:75], v[62:63], v[70:71] op_sel:[1,1,0] op_sel_hi:[0,1,1] neg_lo:[1,0,0]
    v_cvt_pk_bf16_f32 v232, v74, v75
    v_pk_mul_f32 v[70:71], v[74:75], v[62:63] op_sel:[0,0] op_sel_hi:[1,0]
    v_pk_fma_f32 v[74:75], v[74:75], v[62:63], v[70:71] op_sel:[1,1,0] op_sel_hi:[0,1,1] neg_lo:[1,0,0]
    v_cvt_pk_bf16_f32 v233, v74, v75
    v_pk_mul_f32 v[70:71], v[74:75], v[62:63] op_sel:[0,0] op_sel_hi:[1,0]
    v_pk_fma_f32 v[74:75], v[74:75], v[62:63], v[70:71] op_sel:[1,1,0] op_sel_hi:[0,1,1] neg_lo:[1,0,0]
    v_cvt_pk_bf16_f32 v234, v74, v75
    v_pk_mul_f32 v[70:71], v[74:75], v[62:63] op_sel:[0,0] op_sel_hi:[1,0]
    v_pk_fma_f32 v[74:75], v[74:75], v[62:63], v[70:71] op_sel:[1,1,0] op_sel_hi:[0,1,1] neg_lo:[1,0,0]
    v_cvt_pk_bf16_f32 v235, v74, v75
    v_pk_mul_f32 v[70:71], v[74:75], v[62:63] op_sel:[0,0] op_sel_hi:[1,0]
    v_pk_fma_f32 v[74:75], v[74:75], v[62:63], v[70:71] op_sel:[1,1,0] op_sel_hi:[0,1,1] neg_lo:[1,0,0]
    v_cvt_pk_bf16_f32 v236, v74, v75
    v_pk_mul_f32 v[70:71], v[74:75], v[62:63] op_sel:[0,0] op_sel_hi:[1,0]
    v_pk_fma_f32 v[74:75], v[74:75], v[62:63], v[70:71] op_sel:[1,1,0] op_sel_hi:[0,1,1] neg_lo:[1,0,0]
    v_cvt_pk_bf16_f32 v237, v74, v75
    v_pk_mul_f32 v[70:71], v[74:75], v[62:63] op_sel:[0,0] op_sel_hi:[1,0]
    v_pk_fma_f32 v[74:75], v[74:75], v[62:63], v[70:71] op_sel:[1,1,0] op_sel_hi:[0,1,1] neg_lo:[1,0,0]
    v_cvt_pk_bf16_f32 v238, v74, v75
    v_pk_mul_f32 v[70:71], v[74:75], v[62:63] op_sel:[0,0] op_sel_hi:[1,0]
    v_pk_fma_f32 v[74:75], v[74:75], v[62:63], v[70:71] op_sel:[1,1,0] op_sel_hi:[0,1,1] neg_lo:[1,0,0]
    v_cvt_pk_bf16_f32 v239, v74, v75
    v_pk_mul_f32 v[70:71], v[74:75], v[62:63] op_sel:[0,0] op_sel_hi:[1,0]
    v_pk_fma_f32 v[74:75], v[74:75], v[62:63], v[70:71] op_sel:[1,1,0] op_sel_hi:[0,1,1] neg_lo:[1,0,0]
    v_cvt_pk_bf16_f32 v240, v74, v75
    ds_write_addtid_b32 v230 offset:5712
    ds_write_addtid_b32 v231 offset:5984
    ds_write_addtid_b32 v232 offset:6256
    ds_write_addtid_b32 v233 offset:6528
    ds_write_addtid_b32 v234 offset:6800
    ds_write_addtid_b32 v235 offset:7072
    ds_write_addtid_b32 v236 offset:7344
    ds_write_addtid_b32 v237 offset:7616
    ds_write_addtid_b32 v238 offset:7888
    ds_write_addtid_b32 v239 offset:8160
    ds_write_addtid_b32 v240 offset:8432
    ds_read_b128 v[132:135], v228 offset:0
    ds_read_b128 v[140:143], v228 offset:32
    ds_read_b128 v[148:151], v228 offset:64
    ds_read_b128 v[156:159], v228 offset:96
    ds_read_b128 v[164:167], v228 offset:128
    ds_read_b128 v[172:175], v228 offset:160
    ds_read_b128 v[180:183], v228 offset:192
    ds_read_b128 v[188:191], v228 offset:224
    v_perm_b32 v200, v207, v206, v196
    v_perm_b32 v201, v209, v208, v196
    v_perm_b32 v202, v211, v210, v196
    v_perm_b32 v203, v213, v212, v196
    v_perm_b32 v204, v215, v214, v196
    v_perm_b32 v205, v217, v216, v196
    v_mul_f32 v66, v200, v220
    v_mul_f32 v61, v201, v223
    v_mul_f32 v67, v200, v221
    v_mul_f32 v63, v201, v224
    v_mul_f32 v68, v200, v222
    v_mul_f32 v65, v201, v225
    s_waitcnt lgkmcnt(7)
    v_mfma_f32_32x32x16_bf16 v[96:111], v[128:131], v[132:135], v[96:111]
    s_waitcnt lgkmcnt(6)
    s_lshl_b32 s73, s2, 4
    v_exp_f32 v66, v66
    v_fract_f32 v61, v61
    v_exp_f32 v67, v67
    v_fract_f32_e64 v63, v63
    v_mfma_f32_32x32x16_bf16 v[96:111], v[136:139], v[140:143], v[96:111]
    s_waitcnt lgkmcnt(5)
    s_add_u32 s73, s73, 122880
    v_exp_f32 v68, v68
    v_fract_f32 v65, v65
    v_cos_f32 v60, v61
    s_and_b32 s62, s2, 3
    v_mfma_f32_32x32x16_bf16 v[96:111], v[144:147], v[148:151], v[96:111]
    s_waitcnt lgkmcnt(4)
    v_sin_f32 v61, v61
    v_cos_f32 v62, v63
    v_sin_f32_e64 v63, v63
    v_mfma_f32_32x32x16_bf16 v[96:111], v[152:155], v[156:159], v[96:111]
    s_waitcnt lgkmcnt(3)
    v_cos_f32 v64, v65
    v_sin_f32 v65, v65
    v_mul_f32 v60, v60, v66
    v_mul_f32_e64 v61, v61, v66
    v_mfma_f32_32x32x16_bf16 v[96:111], v[160:163], v[164:167], v[96:111]
    s_waitcnt lgkmcnt(2)
    v_mul_f32 v62, v62, v67
    v_mul_f32 v63, v63, v67
    v_mul_f32 v64, v64, v68
    v_mul_f32 v65, v65, v68
    v_mul_f32 v202, v202, v226
    v_mul_f32_e64 v203, v203, v226
    v_mfma_f32_32x32x16_bf16 v[96:111], v[168:171], v[172:175], v[96:111]
    s_waitcnt lgkmcnt(1)
    v_mfma_f32_32x32x16_bf16 v[96:111], v[176:179], v[180:183], v[96:111]
    s_waitcnt lgkmcnt(0)
    v_mfma_f32_32x32x16_bf16 v[96:111], v[184:187], v[188:191], v[96:111]
    buffer_load_dword v58, v28, s[4:7], 0 offen sc1
    v_pk_mul_f32 v[70:71], v[204:205], v[202:203] op_sel:[0,0] op_sel_hi:[1,0]
    v_pk_fma_f32 v[76:77], v[204:205], v[202:203], v[70:71] op_sel:[1,1,0] op_sel_hi:[0,1,1] neg_lo:[1,0,0]
    v_cvt_pk_bf16_f32 v230, v76, -v77
    v_pk_mul_f32 v[70:71], v[76:77], v[60:61] op_sel:[0,0] op_sel_hi:[1,0]
    v_pk_fma_f32 v[78:79], v[76:77], v[60:61], v[70:71] op_sel:[1,1,0] op_sel_hi:[0,1,1] neg_lo:[1,0,0]
    v_cvt_pk_bf16_f32 v231, v78, -v79
    v_pk_mul_f32 v[70:71], v[78:79], v[60:61] op_sel:[0,0] op_sel_hi:[1,0]
    v_pk_fma_f32 v[80:81], v[78:79], v[60:61], v[70:71] op_sel:[1,1,0] op_sel_hi:[0,1,1] neg_lo:[1,0,0]
    v_cvt_pk_bf16_f32 v232, v80, -v81
    v_pk_mul_f32 v[70:71], v[80:81], v[60:61] op_sel:[0,0] op_sel_hi:[1,0]
    v_pk_fma_f32 v[82:83], v[80:81], v[60:61], v[70:71] op_sel:[1,1,0] op_sel_hi:[0,1,1] neg_lo:[1,0,0]
    v_cvt_pk_bf16_f32 v233, v82, -v83
    v_pk_mul_f32 v[70:71], v[82:83], v[60:61] op_sel:[0,0] op_sel_hi:[1,0]
    v_pk_fma_f32 v[84:85], v[82:83], v[60:61], v[70:71] op_sel:[1,1,0] op_sel_hi:[0,1,1] neg_lo:[1,0,0]
    v_cvt_pk_bf16_f32 v234, v84, -v85
    v_pk_mul_f32 v[70:71], v[84:85], v[60:61] op_sel:[0,0] op_sel_hi:[1,0]
    v_pk_fma_f32 v[86:87], v[84:85], v[60:61], v[70:71] op_sel:[1,1,0] op_sel_hi:[0,1,1] neg_lo:[1,0,0]
    v_cvt_pk_bf16_f32 v235, v86, -v87
    v_pk_mul_f32 v[70:71], v[86:87], v[60:61] op_sel:[0,0] op_sel_hi:[1,0]
    v_pk_fma_f32 v[88:89], v[86:87], v[60:61], v[70:71] op_sel:[1,1,0] op_sel_hi:[0,1,1] neg_lo:[1,0,0]
    v_cvt_pk_bf16_f32 v236, v88, -v89
    v_pk_mul_f32 v[70:71], v[88:89], v[60:61] op_sel:[0,0] op_sel_hi:[1,0]
    v_pk_fma_f32 v[90:91], v[88:89], v[60:61], v[70:71] op_sel:[1,1,0] op_sel_hi:[0,1,1] neg_lo:[1,0,0]
    v_cvt_pk_bf16_f32 v237, v90, -v91
    v_pk_mul_f32 v[70:71], v[90:91], v[60:61] op_sel:[0,0] op_sel_hi:[1,0]
    v_pk_fma_f32 v[92:93], v[90:91], v[60:61], v[70:71] op_sel:[1,1,0] op_sel_hi:[0,1,1] neg_lo:[1,0,0]
    v_cvt_pk_bf16_f32 v238, v92, -v93
    v_pk_mul_f32 v[70:71], v[76:77], v[64:65] op_sel:[0,0] op_sel_hi:[1,0]
    v_pk_fma_f32 v[76:77], v[76:77], v[64:65], v[70:71] op_sel:[1,1,0] op_sel_hi:[0,1,1] neg_lo:[1,0,0]
    v_cvt_pk_bf16_f32 v239, v76, -v77
    v_pk_mul_f32 v[70:71], v[80:81], v[64:65] op_sel:[0,0] op_sel_hi:[1,0]
    v_pk_fma_f32 v[80:81], v[80:81], v[64:65], v[70:71] op_sel:[1,1,0] op_sel_hi:[0,1,1] neg_lo:[1,0,0]
    v_cvt_pk_bf16_f32 v240, v80, -v81
    ds_write_addtid_b32 v230 offset:8704
    ds_write_addtid_b32 v231 offset:8976
    ds_write_addtid_b32 v232 offset:9248
    ds_write_addtid_b32 v233 offset:9520
    ds_write_addtid_b32 v234 offset:9792
    ds_write_addtid_b32 v235 offset:10064
    ds_write_addtid_b32 v236 offset:10336
    ds_write_addtid_b32 v237 offset:10608
    ds_write_addtid_b32 v238 offset:11968
    ds_write_addtid_b32 v239 offset:11152
    ds_write_addtid_b32 v240 offset:11424
    v_pk_mul_f32 v[70:71], v[84:85], v[64:65] op_sel:[0,0] op_sel_hi:[1,0]
    v_pk_fma_f32 v[84:85], v[84:85], v[64:65], v[70:71] op_sel:[1,1,0] op_sel_hi:[0,1,1] neg_lo:[1,0,0]
    v_cvt_pk_bf16_f32 v230, v84, -v85
    v_pk_mul_f32 v[70:71], v[88:89], v[64:65] op_sel:[0,0] op_sel_hi:[1,0]
    v_pk_fma_f32 v[88:89], v[88:89], v[64:65], v[70:71] op_sel:[1,1,0] op_sel_hi:[0,1,1] neg_lo:[1,0,0]
    v_cvt_pk_bf16_f32 v231, v88, -v89
    v_pk_mul_f32 v[70:71], v[92:93], v[64:65] op_sel:[0,0] op_sel_hi:[1,0]
    v_pk_fma_f32 v[92:93], v[92:93], v[64:65], v[70:71] op_sel:[1,1,0] op_sel_hi:[0,1,1] neg_lo:[1,0,0]
    v_cvt_pk_bf16_f32 v232, v92, -v93
    v_pk_mul_f32 v[70:71], v[76:77], v[64:65] op_sel:[0,0] op_sel_hi:[1,0]
    v_pk_fma_f32 v[76:77], v[76:77], v[64:65], v[70:71] op_sel:[1,1,0] op_sel_hi:[0,1,1] neg_lo:[1,0,0]
    v_cvt_pk_bf16_f32 v233, v76, -v77
    v_pk_mul_f32 v[70:71], v[84:85], v[64:65] op_sel:[0,0] op_sel_hi:[1,0]
    v_pk_fma_f32 v[84:85], v[84:85], v[64:65], v[70:71] op_sel:[1,1,0] op_sel_hi:[0,1,1] neg_lo:[1,0,0]
    v_cvt_pk_bf16_f32 v234, v84, -v85
    v_pk_mul_f32 v[70:71], v[92:93], v[64:65] op_sel:[0,0] op_sel_hi:[1,0]
    v_pk_fma_f32 v[92:93], v[92:93], v[64:65], v[70:71] op_sel:[1,1,0] op_sel_hi:[0,1,1] neg_lo:[1,0,0]
    v_cvt_pk_bf16_f32 v235, v92, -v93
    v_pk_mul_f32 v[70:71], v[76:77], v[64:65] op_sel:[0,0] op_sel_hi:[1,0]
    v_pk_fma_f32 v[76:77], v[76:77], v[64:65], v[70:71] op_sel:[1,1,0] op_sel_hi:[0,1,1] neg_lo:[1,0,0]
    v_cvt_pk_bf16_f32 v236, v76, -v77
    v_pk_mul_f32 v[70:71], v[84:85], v[64:65] op_sel:[0,0] op_sel_hi:[1,0]
    v_pk_fma_f32 v[84:85], v[84:85], v[64:65], v[70:71] op_sel:[1,1,0] op_sel_hi:[0,1,1] neg_lo:[1,0,0]
    v_cvt_pk_bf16_f32 v237, v84, -v85
    v_pk_mul_f32 v[70:71], v[92:93], v[64:65] op_sel:[0,0] op_sel_hi:[1,0]
    v_pk_fma_f32 v[92:93], v[92:93], v[64:65], v[70:71] op_sel:[1,1,0] op_sel_hi:[0,1,1] neg_lo:[1,0,0]
    v_cvt_pk_bf16_f32 v238, v92, -v93
    v_pk_mul_f32 v[70:71], v[92:93], v[64:65] op_sel:[0,0] op_sel_hi:[1,0]
    v_pk_fma_f32 v[92:93], v[92:93], v[64:65], v[70:71] op_sel:[1,1,0] op_sel_hi:[0,1,1] neg_lo:[1,0,0]
    v_cvt_pk_bf16_f32 v239, v92, -v93
    v_pk_mul_f32 v[70:71], v[92:93], v[64:65] op_sel:[0,0] op_sel_hi:[1,0]
    v_pk_fma_f32 v[92:93], v[92:93], v[64:65], v[70:71] op_sel:[1,1,0] op_sel_hi:[0,1,1] neg_lo:[1,0,0]
    v_cvt_pk_bf16_f32 v240, v92, -v93
    ds_write_addtid_b32 v230 offset:11696
    ds_write_addtid_b32 v231 offset:12512
    ds_write_addtid_b32 v232 offset:12784
    ds_write_addtid_b32 v233 offset:13056
    ds_write_addtid_b32 v234 offset:13328
    ds_write_addtid_b32 v235 offset:13600
    ds_write_addtid_b32 v236 offset:14144
    ds_write_addtid_b32 v237 offset:14416
    ds_write_addtid_b32 v238 offset:14688
    ds_write_addtid_b32 v239 offset:13872
    ds_write_addtid_b32 v240 offset:14960
    s_mov_b64 exec, 1
    s_waitcnt vmcnt(1)
    ds_add_rtn_u32 v59, v254, v255 offset:4
    s_mov_b64 exec, -1
    s_nop 0
    buffer_load_dwordx2 v[56:57], v29, s[4:7], 0 offen sc1
    v_pk_mul_f32 v[70:71], v[92:93], v[64:65] op_sel:[0,0] op_sel_hi:[1,0]
    v_pk_fma_f32 v[92:93], v[92:93], v[64:65], v[70:71] op_sel:[1,1,0] op_sel_hi:[0,1,1] neg_lo:[1,0,0]
    v_cvt_pk_bf16_f32 v230, v92, -v93
    v_pk_mul_f32 v[70:71], v[92:93], v[64:65] op_sel:[0,0] op_sel_hi:[1,0]
    v_pk_fma_f32 v[92:93], v[92:93], v[64:65], v[70:71] op_sel:[1,1,0] op_sel_hi:[0,1,1] neg_lo:[1,0,0]
    v_cvt_pk_bf16_f32 v231, v92, -v93
    v_cvt_pk_bf16_f32 v232, v62, v63
    v_pk_mul_f32 v[70:71], v[62:63], v[62:63] op_sel:[0,0] op_sel_hi:[1,0]
    v_pk_fma_f32 v[74:75], v[62:63], v[62:63], v[70:71] op_sel:[1,1,0] op_sel_hi:[0,1,1] neg_lo:[1,0,0]
    v_cvt_pk_bf16_f32 v233, v74, v75
    v_pk_mul_f32 v[70:71], v[74:75], v[62:63] op_sel:[0,0] op_sel_hi:[1,0]
    v_pk_fma_f32 v[74:75], v[74:75], v[62:63], v[70:71] op_sel:[1,1,0] op_sel_hi:[0,1,1] neg_lo:[1,0,0]
    v_cvt_pk_bf16_f32 v234, v74, v75
    v_pk_mul_f32 v[70:71], v[74:75], v[62:63] op_sel:[0,0] op_sel_hi:[1,0]
    v_pk_fma_f32 v[74:75], v[74:75], v[62:63], v[70:71] op_sel:[1,1,0] op_sel_hi:[0,1,1] neg_lo:[1,0,0]
    v_cvt_pk_bf16_f32 v235, v74, v75
    v_pk_mul_f32 v[70:71], v[74:75], v[62:63] op_sel:[0,0] op_sel_hi:[1,0]
    v_pk_fma_f32 v[74:75], v[74:75], v[62:63], v[70:71] op_sel:[1,1,0] op_sel_hi:[0,1,1] neg_lo:[1,0,0]
    v_cvt_pk_bf16_f32 v236, v74, v75
    v_pk_mul_f32 v[70:71], v[74:75], v[62:63] op_sel:[0,0] op_sel_hi:[1,0]
    v_pk_fma_f32 v[74:75], v[74:75], v[62:63], v[70:71] op_sel:[1,1,0] op_sel_hi:[0,1,1] neg_lo:[1,0,0]
    v_cvt_pk_bf16_f32 v237, v74, v75
    v_pk_mul_f32 v[70:71], v[74:75], v[62:63] op_sel:[0,0] op_sel_hi:[1,0]
    v_pk_fma_f32 v[74:75], v[74:75], v[62:63], v[70:71] op_sel:[1,1,0] op_sel_hi:[0,1,1] neg_lo:[1,0,0]
    v_cvt_pk_bf16_f32 v238, v74, v75
    v_pk_mul_f32 v[70:71], v[74:75], v[62:63] op_sel:[0,0] op_sel_hi:[1,0]
    v_pk_fma_f32 v[74:75], v[74:75], v[62:63], v[70:71] op_sel:[1,1,0] op_sel_hi:[0,1,1] neg_lo:[1,0,0]
    v_cvt_pk_bf16_f32 v239, v74, v75
    v_pk_mul_f32 v[70:71], v[74:75], v[62:63] op_sel:[0,0] op_sel_hi:[1,0]
    v_pk_fma_f32 v[74:75], v[74:75], v[62:63], v[70:71] op_sel:[1,1,0] op_sel_hi:[0,1,1] neg_lo:[1,0,0]
    v_cvt_pk_bf16_f32 v240, v74, v75
    ds_write_addtid_b32 v230 offset:10880
    ds_write_addtid_b32 v231 offset:12240
    ds_write_addtid_b32 v232 offset:272
    ds_write_addtid_b32 v233 offset:544
    ds_write_addtid_b32 v234 offset:816
    ds_write_addtid_b32 v235 offset:1088
    ds_write_addtid_b32 v236 offset:1360
    ds_write_addtid_b32 v237 offset:1632
    ds_write_addtid_b32 v238 offset:1904
    ds_write_addtid_b32 v239 offset:2176
    ds_write_addtid_b32 v240 offset:2448
    ds_read_b128 v[128:131], v227 offset:0
    ds_read_b128 v[136:139], v227 offset:32
    ds_read_b128 v[144:147], v227 offset:64
    s_mov_b64 exec, 0
    s_cmp_eq_u32 s3, 0
    s_cbranch_scc1 L_gp0
    s_cmp_eq_u32 s3, 1
    s_cbranch_scc1 L_gp1
    s_cmp_eq_u32 s3, 2
    s_cbranch_scc1 L_gp2
    s_branch L_gp3
L_cv_t2:
    s_waitcnt lgkmcnt(14)
    v_readfirstlane_b32 s58, v59
    s_nop 0
    s_cmp_lg_u32 s58, 3
    s_cbranch_scc1 L_nopub1
    s_nop 0
    s_atomic_swap s50, s[4:5], s65 offset:131072
    s_atomic_swap s50, s[4:5], s65 offset:139264
L_nopub1:
    v_pk_mul_f32 v[70:71], v[74:75], v[62:63] op_sel:[0,0] op_sel_hi:[1,0]
    v_pk_fma_f32 v[74:75], v[74:75], v[62:63], v[70:71] op_sel:[1,1,0] op_sel_hi:[0,1,1] neg_lo:[1,0,0]
    v_cvt_pk_bf16_f32 v230, v74, v75
    v_pk_mul_f32 v[70:71], v[74:75], v[62:63] op_sel:[0,0] op_sel_hi:[1,0]
    v_pk_fma_f32 v[74:75], v[74:75], v[62:63], v[70:71] op_sel:[1,1,0] op_sel_hi:[0,1,1] neg_lo:[1,0,0]
    v_cvt_pk_bf16_f32 v231, v74, v75
    v_pk_mul_f32 v[70:71], v[74:75], v[62:63] op_sel:[0,0] op_sel_hi:[1,0]
    v_pk_fma_f32 v[74:75], v[74:75], v[62:63], v[70:71] op_sel:[1,1,0] op_sel_hi:[0,1,1] neg_lo:[1,0,0]
    v_cvt_pk_bf16_f32 v232, v74, v75
    v_pk_mul_f32 v[70:71], v[74:75], v[62:63] op_sel:[0,0] op_sel_hi:[1,0]
    v_pk_fma_f32 v[74:75], v[74:75], v[62:63], v[70:71] op_sel:[1,1,0] op_sel_hi:[0,1,1] neg_lo:[1,0,0]
    v_cvt_pk_bf16_f32 v233, v74, v75
    v_pk_mul_f32 v[70:71], v[74:75], v[62:63] op_sel:[0,0] op_sel_hi:[1,0]
    v_pk_fma_f32 v[74:75], v[74:75], v[62:63], v[70:71] op_sel:[1,1,0] op_sel_hi:[0,1,1] neg_lo:[1,0,0]
    v_cvt_pk_bf16_f32 v234, v74, v75
    v_pk_mul_f32 v[70:71], v[74:75], v[62:63] op_sel:[0,0] op_sel_hi:[1,0]
    v_pk_fma_f32 v[74:75], v[74:75], v[62:63], v[70:71] op_sel:[1,1,0] op_sel_hi:[0,1,1] neg_lo:[1,0,0]
    v_cvt_pk_bf16_f32 v235, v74, v75
    v_pk_mul_f32 v[70:71], v[74:75], v[62:63] op_sel:[0,0] op_sel_hi:[1,0]
    v_pk_fma_f32 v[74:75], v[74:75], v[62:63], v[70:71] op_sel:[1,1,0] op_sel_hi:[0,1,1] neg_lo:[1,0,0]
    v_cvt_pk_bf16_f32 v236, v74, v75
    v_pk_mul_f32 v[70:71], v[74:75], v[62:63] op_sel:[0,0] op_sel_hi:[1,0]
    v_pk_fma_f32 v[74:75], v[74:75], v[62:63], v[70:71] op_sel:[1,1,0] op_sel_hi:[0,1,1] neg_lo:[1,0,0]
    v_cvt_pk_bf16_f32 v237, v74, v75
    v_pk_mul_f32 v[70:71], v[74:75], v[62:63] op_sel:[0,0] op_sel_hi:[1,0]
    v_pk_fma_f32 v[74:75], v[74:75], v[62:63], v[70:71] op_sel:[1,1,0] op_sel_hi:[0,1,1] neg_lo:[1,0,0]
    v_cvt_pk_bf16_f32 v238, v74, v75
    v_pk_mul_f32 v[70:71], v[74:75], v[62:63] op_sel:[0,0] op_sel_hi:[1,0]
    v_pk_fma_f32 v[74:75], v[74:75], v[62:63], v[70:71] op_sel:[1,1,0] op_sel_hi:[0,1,1] neg_lo:[1,0,0]
    v_cvt_pk_bf16_f32 v239, v74, v75
    v_pk_mul_f32 v[70:71], v[74:75], v[62:63] op_sel:[0,0] op_sel_hi:[1,0]
    v_pk_fma_f32 v[74:75], v[74:75], v[62:63], v[70:71] op_sel:[1,1,0] op_sel_hi:[0,1,1] neg_lo:[1,0,0]
    v_cvt_pk_bf16_f32 v240, v74, v75
    ds_write_addtid_b32 v230 offset:2720
    ds_write_addtid_b32 v231 offset:2992
    ds_write_addtid_b32 v232 offset:3264
    ds_write_addtid_b32 v233 offset:3536
    ds_write_addtid_b32 v234 offset:3808
    ds_write_addtid_b32 v235 offset:4080
    ds_write_addtid_b32 v236 offset:4352
    ds_write_addtid_b32 v237 offset:4624
    ds_write_addtid_b32 v238 offset:4896
    ds_write_addtid_b32 v239 offset:5168
    ds_write_addtid_b32 v240 offset:5440
    ds_read_b128 v[152:155], v227 offset:96
    ds_read_b128 v[160:163], v227 offset:128
    ds_read_b128 v[168:171], v227 offset:160
    ds_read_b128 v[176:179], v227 offset:192
    ds_read_b128 v[184:187], v227 offset:224
    s_waitcnt vmcnt(1)
    v_cmp_ne_u32 vcc, s50, v58
    s_cbranch_vccnz L_slow1
L_back1:
    s_mov_b32 m0, s43
    buffer_load_dwordx4 v[32:35], v192, s[4:7], s44 offen sc1
    buffer_load_dwordx4 v[36:39], v192, s[4:7], s45 offen sc1
    buffer_load_dwordx4 v[40:43], v192, s[4:7], s49 offen sc1
    buffer_load_dwordx4 v[44:47], v192, s[4:7], s77 offen sc1
    buffer_load_dwordx4 v193, s[4:7], s42 offen offset:0 sc1 lds
    buffer_load_dwordx4 v193, s[4:7], s42 offen offset:1024 sc1 lds
    buffer_load_dwordx4 v193, s[4:7], s42 offen offset:2048 sc1 lds
    buffer_load_dwordx4 v193, s[4:7], s42 offen offset:3072 sc1 lds
    s_mov_b32 m0, s70
    s_nop 0
    v_pk_mul_f32 v[70:71], v[74:75], v[62:63] op_sel:[0,0] op_sel_hi:[1,0]
    v_pk_fma_f32 v[74:75], v[74:75], v[62:63], v[70:71] op_sel:[1,1,0] op_sel_hi:[0,1,1] neg_lo:[1,0,0]
    v_cvt_pk_bf16_f32 v230, v74, v75
    v_pk_mul_f32 v[70:71], v[74:75], v[62:63] op_sel:[0,0] op_sel_hi:[1,0]
    v_pk_fma_f32 v[74:75], v[74:75], v[62:63], v[70:71] op_sel:[1,1,0] op_sel_hi:[0,1,1] neg_lo:[1,0,0]
    v_cvt_pk_bf16_f32 v231, v74, v75
    v_pk_mul_f32 v[70:71], v[74:75], v[62:63] op_sel:[0,0] op_sel_hi:[1,0]
    v_pk_fma_f32 v[74:75], v[74:75], v[62:63], v[70:71] op_sel:[1,1,0] op_sel_hi:[0,1,1] neg_lo:[1,0,0]
    v_cvt_pk_bf16_f32 v232, v74, v75
    v_pk_mul_f32 v[70:71], v[74:75], v[62:63] op_sel:[0,0] op_sel_hi:[1,0]
    v_pk_fma_f32 v[74:75], v[74:75], v[62:63], v[70:71] op_sel:[1,1,0] op_sel_hi:[0,1,1] neg_lo:[1,0,0]
    v_cvt_pk_bf16_f32 v233, v74, v75
    v_pk_mul_f32 v[70:71], v[74:75], v[62:63] op_sel:[0,0] op_sel_hi:[1,0]
    v_pk_fma_f32 v[74:75], v[74:75], v[62:63], v[70:71] op_sel:[1,1,0] op_sel_hi:[0,1,1] neg_lo:[1,0,0]
    v_cvt_pk_bf16_f32 v234, v74, v75
    v_pk_mul_f32 v[70:71], v[74:75], v[62:63] op_sel:[0,0] op_sel_hi:[1,0]
    v_pk_fma_f32 v[74:75], v[74:75], v[62:63], v[70:71] op_sel:[1,1,0] op_sel_hi:[0,1,1] neg_lo:[1,0,0]
    v_cvt_pk_bf16_f32 v235, v74, v75
    v_pk_mul_f32 v[70:71], v[74:75], v[62:63] op_sel:[0,0] op_sel_hi:[1,0]
    v_pk_fma_f32 v[74:75], v[74:75], v[62:63], v[70:71] op_sel:[1,1,0] op_sel_hi:[0,1,1] neg_lo:[1,0,0]
    v_cvt_pk_bf16_f32 v236, v74, v75
    v_pk_mul_f32 v[70:71], v[74:75], v[62:63] op_sel:[0,0] op_sel_hi:[1,0]
    v_pk_fma_f32 v[74:75], v[74:75], v[62:63], v[70:71] op_sel:[1,1,0] op_sel_hi:[0,1,1] neg_lo:[1,0,0]
    v_cvt_pk_bf16_f32 v237, v74, v75
    v_pk_mul_f32 v[70:71], v[74:75], v[62:63] op_sel:[0,0] op_sel_hi:[1,0]
    v_pk_fma_f32 v[74:75], v[74:75], v[62:63], v[70:71] op_sel:[1,1,0] op_sel_hi:[0,1,1] neg_lo:[1,0,0]
    v_cvt_pk_bf16_f32 v238, v74, v75
    v_pk_mul_f32 v[70:71], v[74:75], v[62:63] op_sel:[0,0] op_sel_hi:[1,0]
    v_pk_fma_f32 v[74:75], v[74:75], v[62:63], v[70:71] op_sel:[1,1,0] op_sel_hi:[0,1,1] neg_lo:[1,0,0]
    v_cvt_pk_bf16_f32 v239, v74, v75
    v_pk_mul_f32 v[70:71], v[74:75], v[62:63] op_sel:[0,0] op_sel_hi:[1,0]
    v_pk_fma_f32 v[74:75], v[74:75], v[62:63], v[70:71] op_sel:[1,1,0] op_sel_hi:[0,1,1] neg_lo:[1,0,0]
    v_cvt_pk_bf16_f32 v240, v74, v75
    ds_write_addtid_b32 v230 offset:5712
    ds_write_addtid_b32 v231 offset:5984
    ds_write_addtid_b32 v232 offset:6256
    ds_write_addtid_b32 v233 offset:6528
    ds_write_addtid_b32 v234 offset:6800
    ds_write_addtid_b32 v235 offset:7072
    ds_write_addtid_b32 v236 offset:7344
    ds_write_addtid_b32 v237 offset:7616
    ds_write_addtid_b32 v238 offset:7888
    ds_write_addtid_b32 v239 offset:8160
    ds_write_addtid_b32 v240 offset:8432
    ds_read_b128 v[132:135], v228 offset:0
    ds_read_b128 v[140:143], v228 offset:32
    ds_read_b128 v[148:151], v228 offset:64
    ds_read_b128 v[156:159], v228 offset:96
    ds_read_b128 v[164:167], v228 offset:128
    ds_read_b128 v[172:175], v228 offset:160
    ds_read_b128 v[180:183], v228 offset:192
    ds_read_b128 v[188:191], v228 offset:224
    s_waitcnt vmcnt(8)
    v_cmp_ne_u32 vcc, s50, v57
    s_cbranch_vccnz L_slow0
L_back0:
    v_mov_b32 v57, v56
    v_bfe_u32 v52, v2, 2, 1
    v_cvt_f32_u32 v52, v52
    v_permlane16_swap_b32 v56, v57
    v_add_f32_e64 v48, v56, v57
    v_cvt_pk_bf16_f32 v48, 0, v48
    v_add_f32_e64 v48, v48, v52
    v_cvt_pk_bf16_f32 v48, 0, v48
    s_add_u32 s58, s3, 8
    s_waitcnt lgkmcnt(7)
    v_mfma_f32_32x32x16_bf16 v[96:111], v[128:131], v[132:135], v[96:111]
    s_waitcnt lgkmcnt(6)
    s_add_u32 s59, s3, 12
    v_readlane_b32 s40, v48, s58
    v_readlane_b32 s41, v48, s59
    v_readlane_b32 s32, v48, 4
    v_readlane_b32 s33, v48, 0
    v_readlane_b32 s34, v48, 5
    v_readlane_b32 s35, v48, 1
    v_mfma_f32_32x32x16_bf16 v[96:111], v[136:139], v[140:143], v[96:111]
    s_waitcnt lgkmcnt(5)
    v_readlane_b32 s36, v48, 6
    v_readlane_b32 s37, v48, 2
    v_readlane_b32 s38, v48, 7
    v_readlane_b32 s39, v48, 3
    s_and_b32 s58, s41, 0x7fffffff
    s_cselect_b32 s41, s41, 0x21800000
    v_mfma_f32_32x32x16_bf16 v[96:111], v[144:147], v[148:151], v[96:111]
    s_waitcnt lgkmcnt(4)
    v_mov_b32 v51, s41
    v_mul_f32 v51, s40, v51
    v_mov_b32 v52, 0x21800000
    v_cmp_eq_f32 vcc, 0, v48
    v_add_u32 v54, -12, v0
    v_xor_b32_e64 v55, s62, v54
    v_mfma_f32_32x32x16_bf16 v[96:111], v[152:155], v[156:159], v[96:111]
    s_waitcnt lgkmcnt(3)
    v_lshl_add_u32 v55, v55, 2, s73
    v_cndmask_b32 v52, v48, v52, vcc
    v_cmp_gt_u32 vcc, 4, v54
    v_rcp_f32 v127, v52
    v_mov_b32 v126, 2130706432
    v_mfma_f32_32x32x16_bf16 v[96:111], v[160:163], v[164:167], v[96:111]
    s_waitcnt lgkmcnt(2)
    v_cndmask_b32 v126, v126, v55, vcc
    v_lshlrev_b32_e64 v53, 4, v2
    v_alignbit_b32 v53, s41, s41, v53
    v_alignbit_b32 v53, v53, v53, 16
    v_lshrrev_b32 v54, 1, v7
    v_lshlrev_b32 v55, 2, v8
    v_mfma_f32_32x32x16_bf16 v[96:111], v[168:171], v[172:175], v[96:111]
    ds_read_b32 v1, v3
    s_waitcnt lgkmcnt(2)
    v_sub_u32 v54, v54, v55
    v_cmp_eq_u32_e64 vcc, 0, v54
    v_cmp_eq_u32 s[58:59], 1, v54
    v_cmp_eq_u32 s[62:63], 2, v54
    v_cmp_eq_u32 s[64:65], 3, v54
    v_cndmask_b32_e64 v16, 0, v53, vcc
    v_mfma_f32_32x32x16_bf16 v[96:111], v[176:179], v[180:183], v[96:111]
    ds_read_b32 v1, v3
    s_waitcnt lgkmcnt(2)
    v_cndmask_b32 v17, 0, v53, s[58:59]
    v_cndmask_b32 v18, 0, v53, s[62:63]
    v_cndmask_b32 v19, 0, v53, s[64:65]
    v_mfma_f32_32x32x16_bf16 v[96:111], v[184:187], v[188:191], v[96:111]
    buffer_load_dword v4, v6, s[4:7], 0 offen sc1
    s_nop 10
    v_add_f32_e64 v96, v96, v245
    v_pk_mul_f32 v[96:97], v[96:97], v[50:51] op_sel:[0,1] op_sel_hi:[1,1]
    v_pk_mul_f32 v[98:99], v[98:99], v[50:51] op_sel:[0,1] op_sel_hi:[1,1]
    v_pk_mul_f32 v[100:101], v[100:101], v[50:51] op_sel:[0,1] op_sel_hi:[1,1]
    v_pk_mul_f32 v[102:103], v[102:103], v[50:51] op_sel:[0,1] op_sel_hi:[1,1]
    v_pk_mul_f32 v[104:105], v[104:105], v[50:51] op_sel:[0,1] op_sel_hi:[1,1]
    v_pk_mul_f32 v[106:107], v[106:107], v[50:51] op_sel:[0,1] op_sel_hi:[1,1]
    v_pk_mul_f32 v[108:109], v[108:109], v[50:51] op_sel:[0,1] op_sel_hi:[1,1]
    v_cvt_pk_bf16_f32 v64, v100, v99
    v_cvt_pk_bf16_f32 v65, v98, v97
    v_cvt_pk_bf16_f32 v66, v99, v98
    v_cvt_pk_bf16_f32 v67, v97, v96
    v_cvt_pk_bf16_f32 v68, v103, v103
    v_cvt_pk_bf16_f32 v69, v102, v101
    v_cvt_pk_bf16_f32 v70, v103, v102
    v_cvt_pk_bf16_f32 v71, v101, v101
    v_cvt_pk_bf16_f32 v72, v106, v106
    v_cvt_pk_bf16_f32 v73, v106, v105
    v_cvt_pk_bf16_f32 v74, v105, v105
    v_cvt_pk_bf16_f32 v75, v104, v104
    v_cvt_pk_bf16_f32 v76, v106, v106
    v_cvt_pk_bf16_f32 v77, v105, v105
    v_cvt_pk_bf16_f32 v78, v105, v104
    v_cvt_pk_bf16_f32 v79, v104, v104
    v_cvt_pk_bf16_f32 v80, v107, v108
    v_cvt_pk_bf16_f32 v82, v106, v106
    v_cvt_pk_bf16_f32 v83, v106, v106
    ds_write_b64 v242, v[64:65] offset:2104
    ds_write_b64 v242, v[66:67] offset:4344
    ds_write_b64 v242, v[68:69] offset:1592
    ds_write_b64 v242, v[70:71] offset:3832
    ds_write_b128 v243, v[72:75] offset:1072
    ds_write_b128 v243, v[76:79] offset:3312
    ds_write_b16 v244, v80 offset:4638
    ds_write_b16_d16_hi v244, v80 offset:4510
    s_mov_b64 exec, 1
    ds_write_b16_d16_hi v246, v67 offset:2112
    s_mov_b32 exec_hi, 0x80000000
    s_mov_b32 exec_lo, 0
    ds_write_b64 v246, v[82:83] offset:56
    ds_write_b16 v246, v82 offset:2294
    ds_write_b64 v246, v[82:83] offset:2296
    s_mov_b64 exec, -1
    s_waitcnt vmcnt(1)
    ds_read_b128 v[64:67], v247
    ds_read_b128 v[68:71], v248
    ds_read_b128 v[72:75], v249
    ds_read_b128 v[76:79], v250
    ds_read2_b32 v[128:129], v10 offset0:240 offset1:241
    ds_read2_b32 v[130:131], v10 offset0:242 offset1:243
    ds_read2_b32 v[132:133], v10 offset0:112 offset1:113
    ds_read2_b32 v[134:135], v10 offset0:114 offset1:115
    ds_read2_b32 v[136:137], v10 offset0:224 offset1:225
    ds_read2_b32 v[138:139], v10 offset0:226 offset1:227
    ds_read2_b32 v[140:141], v10 offset0:96 offset1:97
    ds_read2_b32 v[142:143], v10 offset0:98 offset1:99
    s_waitcnt lgkmcnt(11)
    v_lshlrev_b32 v80, 16, v64
    v_and_b32 v81, 0xffff0000, v64
    v_pk_fma_f32 v[80:81], v[80:81], v[32:33], v[34:35]
    v_pk_fma_f32 v[80:81], v[80:81], s[32:33], s[32:33] op_sel:[0,0,1] op_sel_hi:[1,0,1]
    v_cvt_pk_bf16_f32 v64, v80, v81
    v_lshlrev_b32_e64 v82, 16, v65
    v_and_b32 v83, 0xffff0000, v65
    v_pk_fma_f32 v[82:83], v[82:83], v[36:37], v[38:39]
    v_pk_fma_f32 v[82:83], v[82:83], s[32:33], s[32:33] op_sel:[0,0,1] op_sel_hi:[1,0,1]
    v_cvt_pk_bf16_f32 v65, v82, v83
    v_lshlrev_b32_e64 v80, 16, v66
    v_and_b32 v81, 0xffff0000, v66
    v_pk_fma_f32 v[80:81], v[80:81], v[40:41], v[42:43]
    v_pk_fma_f32 v[80:81], v[80:81], s[32:33], s[32:33] op_sel:[0,0,1] op_sel_hi:[1,0,1]
    v_cvt_pk_bf16_f32 v66, v80, v81
    v_lshlrev_b32_e64 v82, 16, v67
    v_and_b32 v83, 0xffff0000, v67
    v_pk_fma_f32 v[82:83], v[82:83], v[44:45], v[46:47]
    v_pk_fma_f32 v[82:83], v[82:83], s[32:33], s[32:33] op_sel:[0,0,1] op_sel_hi:[1,0,1]
    v_cvt_pk_bf16_f32 v67, v82, v83
    ds_write_b128 v251, v[64:67] offset:0
    ds_read2_b32 v[144:145], v10 offset0:208 offset1:209
    ds_read2_b32 v[146:147], v10 offset0:210 offset1:211
    ds_read2_b32 v[148:149], v10 offset0:80 offset1:81
    ds_read2_b32 v[150:151], v10 offset0:82 offset1:83
    ds_read2_b32 v[152:153], v10 offset0:192 offset1:193
    ds_read2_b32 v[154:155], v10 offset0:194 offset1:195
    ds_read2_b32 v[156:157], v10 offset0:64 offset1:65
    ds_read2_b32 v[158:159], v10 offset0:66 offset1:67
    s_waitcnt lgkmcnt(15)
    v_lshlrev_b32 v80, 16, v68
    v_and_b32 v81, 0xffff0000, v68
    v_pk_fma_f32 v[80:81], v[80:81], v[32:33], v[34:35]
    v_pk_fma_f32 v[80:81], v[80:81], s[34:35], s[34:35] op_sel:[0,0,1] op_sel_hi:[1,0,1]
    v_cvt_pk_bf16_f32 v68, v80, v81
    v_lshlrev_b32_e64 v82, 16, v69
    v_and_b32 v83, 0xffff0000, v69
    v_pk_fma_f32 v[82:83], v[82:83], v[36:37], v[38:39]
L_stub2:
    s_cbranch_execz L_tdone
    v_pk_fma_f32 v[82:83], v[82:83], s[34:35], s[34:35] op_sel:[0,0,1] op_sel_hi:[1,0,1]
    v_cvt_pk_bf16_f32 v69, v82, v83
    v_lshlrev_b32 v80, 16, v70
    v_and_b32 v81, 0xffff0000, v70
    v_pk_fma_f32 v[80:81], v[80:81], v[40:41], v[42:43]
    v_pk_fma_f32 v[80:81], v[80:81], s[34:35], s[34:35] op_sel:[0,0,1] op_sel_hi:[1,0,1]
    v_cvt_pk_bf16_f32 v70, v80, v81
    v_lshlrev_b32_e64 v82, 16, v71
    v_and_b32 v83, 0xffff0000, v71
    v_pk_fma_f32 v[82:83], v[82:83], v[44:45], v[46:47]
    v_pk_fma_f32 v[82:83], v[82:83], s[34:35], s[34:35] op_sel:[0,0,1] op_sel_hi:[1,0,1]
    v_cvt_pk_bf16_f32 v71, v82, v83
    ds_write_b128 v251, v[68:71] offset:4608
    ds_read2_b32 v[160:161], v10 offset0:176 offset1:177
    ds_read2_b32 v[162:163], v10 offset0:178 offset1:179
    ds_read2_b32 v[164:165], v10 offset0:48 offset1:49
    ds_read2_b32 v[166:167], v10 offset0:50 offset1:51
    ds_read2_b32 v[168:169], v10 offset0:160 offset1:161
    ds_read2_b32 v[170:171], v10 offset0:162 offset1:163
    ds_read2_b32 v[172:173], v10 offset0:32 offset1:33
    ds_read2_b32 v[174:175], v10 offset0:34 offset1:35
    s_waitcnt vmcnt(0)
    v_cmp_ne_u32 vcc, s50, v4
    s_cbranch_vccnz L_slow2
L_back2:
    s_add_u32 s67, s74, 0
    buffer_load_dwordx4 a[0:3], v3, s[4:7], s67 offen offset:0 sc1
    s_add_u32 s68, s75, 0
    buffer_load_dwordx4 a[4:7], v5, s[4:7], s68 offen offset:0 sc1
    v_lshlrev_b32 v80, 16, v72
    v_and_b32 v81, 0xffff0000, v72
    v_pk_fma_f32 v[80:81], v[80:81], v[32:33], v[34:35]
    v_pk_fma_f32 v[80:81], v[80:81], s[36:37], s[36:37] op_sel:[0,0,1] op_sel_hi:[1,0,1]
    v_cvt_pk_bf16_f32 v72, v80, v81
    v_lshlrev_b32_e64 v82, 16, v73
    v_and_b32 v83, 0xffff0000, v73
    v_pk_fma_f32 v[82:83], v[82:83], v[36:37], v[38:39]
    v_pk_fma_f32 v[82:83], v[82:83], s[36:37], s[36:37] op_sel:[0,0,1] op_sel_hi:[1,0,1]
    v_cvt_pk_bf16_f32 v73, v82, v83
    v_lshlrev_b32_e64 v80, 16, v74
    v_and_b32 v81, 0xffff0000, v74
    v_pk_fma_f32 v[80:81], v[80:81], v[40:41], v[42:43]
    v_pk_fma_f32 v[80:81], v[80:81], s[36:37], s[36:37] op_sel:[0,0,1] op_sel_hi:[1,0,1]
    v_cvt_pk_bf16_f32 v74, v80, v81
    v_lshlrev_b32_e64 v82, 16, v75
    v_and_b32 v83, 0xffff0000, v75
    v_pk_fma_f32 v[82:83], v[82:83], v[44:45], v[46:47]
    v_pk_fma_f32 v[82:83], v[82:83], s[36:37], s[36:37] op_sel:[0,0,1] op_sel_hi:[1,0,1]
    v_cvt_pk_bf16_f32 v75, v82, v83
    ds_write_b128 v251, v[72:75] offset:9216
    ds_read2_b32 v[176:177], v10 offset0:144 offset1:145
    ds_read2_b32 v[178:179], v10 offset0:146 offset1:147
    ds_read2_b32 v[180:181], v10 offset0:16 offset1:17
    ds_read2_b32 v[182:183], v10 offset0:18 offset1:19
    ds_read2_b32 v[184:185], v10 offset0:128 offset1:129
    ds_read2_b32 v[186:187], v10 offset0:130 offset1:131
    ds_read2_b32 v[188:189], v10 offset0:0 offset1:1
    ds_read2_b32 v[190:191], v10 offset0:2 offset1:3
    s_add_u32 s69, s76, 0
    buffer_load_dwordx4 a[8:11], v3, s[4:7], s69 offen offset:0 sc1
    s_add_u32 s67, s74, 0
    buffer_load_dwordx4 a[12:15], v3, s[4:7], s67 offen offset:1024 sc1
    v_lshlrev_b32_e64 v80, 16, v76
    v_and_b32 v81, 0xffff0000, v76
    v_pk_fma_f32 v[80:81], v[80:81], v[32:33], v[34:35]
    v_pk_fma_f32 v[80:81], v[80:81], s[38:39], s[38:39] op_sel:[0,0,1] op_sel_hi:[1,0,1]
    v_cvt_pk_bf16_f32 v76, v80, v81
    v_lshlrev_b32_e64 v82, 16, v77
    v_and_b32 v83, 0xffff0000, v77
    v_pk_fma_f32 v[82:83], v[82:83], v[36:37], v[38:39]
    v_pk_fma_f32 v[82:83], v[82:83], s[38:39], s[38:39] op_sel:[0,0,1] op_sel_hi:[1,0,1]
    v_cvt_pk_bf16_f32 v77, v82, v83
    v_lshlrev_b32_e64 v80, 16, v78
    v_and_b32 v81, 0xffff0000, v78
    v_pk_fma_f32 v[80:81], v[80:81], v[40:41], v[42:43]
    v_pk_fma_f32 v[80:81], v[80:81], s[38:39], s[38:39] op_sel:[0,0,1] op_sel_hi:[1,0,1]
    v_cvt_pk_bf16_f32 v78, v80, v81
    v_lshlrev_b32_e64 v82, 16, v79
    v_and_b32 v83, 0xffff0000, v79
    v_pk_fma_f32 v[82:83], v[82:83], v[44:45], v[46:47]
    v_pk_fma_f32 v[82:83], v[82:83], s[38:39], s[38:39] op_sel:[0,0,1] op_sel_hi:[1,0,1]
    v_cvt_pk_bf16_f32 v79, v82, v83
    ds_write_b128 v251, v[76:79] offset:13824
    s_add_u32 s68, s75, 0
    buffer_load_dwordx4 a[16:19], v5, s[4:7], s68 offen offset:1024 sc1
    s_add_u32 s69, s76, 0
    buffer_load_dwordx4 a[20:23], v3, s[4:7], s69 offen offset:1024 sc1
    s_waitcnt lgkmcnt(0)
    s_barrier
    ds_read_b128 v[56:59], v9 offset:480
    ds_read_b128 v[60:63], v9 offset:992
    ds_read_b128 v[64:67], v9 offset:416
    ds_read_b128 v[68:71], v9 offset:928
    ds_read_b128 v[72:75], v9 offset:352
    ds_read_b128 v[76:79], v9 offset:864
    s_waitcnt lgkmcnt(5)
    v_mfma_f32_16x16x32_bf16 v[96:99], v[128:131], v[56:59], 0
    s_waitcnt lgkmcnt(4)
    s_add_u32 s67, s74, 0
    ds_read2_b32 v[192:193], v12 offset0:240 offset1:241
    buffer_load_dwordx4 a[24:27], v3, s[4:7], s67 offen offset:2048 sc1
    s_add_u32 s68, s75, 0
    v_mfma_f32_16x16x32_bf16 v[100:103], v[128:131], v[60:63], 0
    ds_read_b128 v[80:83], v9 offset:288
    buffer_load_dwordx4 a[28:31], v5, s[4:7], s68 offen offset:2048 sc1
    s_add_u32 s69, s76, 0
    v_mfma_f32_16x16x32_bf16 v[100:103], v[132:135], v[56:59], v[100:103]
    s_waitcnt lgkmcnt(5)
    ds_read_b128 v[84:87], v9 offset:800
    buffer_load_dwordx4 a[32:35], v3, s[4:7], s69 offen offset:2048 sc1
    v_mfma_f32_16x16x32_bf16 v[96:99], v[136:139], v[64:67], v[96:99]
    s_waitcnt lgkmcnt(5)
    ds_read2_b32 v[194:195], v12 offset0:242 offset1:243
    buffer_load_dwordx4 a[36:39], v3, s[4:7], s67 offen offset:3072 sc1
    v_mfma_f32_16x16x32_bf16 v[100:103], v[136:139], v[68:71], v[100:103]
    ds_read_b128 v[88:91], v9 offset:224
    buffer_load_dwordx4 a[40:43], v5, s[4:7], s68 offen offset:3072 sc1
    v_mfma_f32_16x16x32_bf16 v[100:103], v[140:143], v[64:67], v[100:103]
    s_waitcnt lgkmcnt(6)
    ds_read_b128 v[92:95], v9 offset:736
    ds_read2_b32 v[196:197], v12 offset0:112 offset1:113
    buffer_load_dwordx4 a[44:47], v3, s[4:7], s69 offen offset:3072 sc1
    v_mfma_f32_16x16x32_bf16 v[96:99], v[144:147], v[72:75], v[96:99]
    s_waitcnt lgkmcnt(7)
    s_add_u32 s67, s74, 4096
    buffer_load_dwordx4 a[48:51], v3, s[4:7], s67 offen offset:0 sc1
    v_mfma_f32_16x16x32_bf16 v[100:103], v[144:147], v[76:79], v[100:103]
    s_add_u32 s68, s75, 4096
    ds_read_b128 v[60:63], v9 offset:160
    ds_read2_b32 v[198:199], v12 offset0:114 offset1:115
    v_mfma_f32_16x16x32_bf16 v[100:103], v[148:151], v[72:75], v[100:103]
    s_waitcnt lgkmcnt(7)
    ds_read_b128 v[56:59], v9 offset:672
    v_mfma_f32_16x16x32_bf16 v[96:99], v[152:155], v[80:83], v[96:99]
    s_waitcnt lgkmcnt(7)
    buffer_load_dwordx4 a[52:55], v5, s[4:7], s68 offen offset:0 sc1
    v_mfma_f32_16x16x32_bf16 v[100:103], v[152:155], v[84:87], v[100:103]
    ds_read_b128 v[68:71], v9 offset:96
    ds_read2_b32 v[200:201], v12 offset0:224 offset1:225
    v_mfma_f32_16x16x32_bf16 v[100:103], v[156:159], v[80:83], v[100:103]
    s_waitcnt lgkmcnt(7)
    ds_read_b128 v[64:67], v9 offset:608
    s_add_u32 s69, s76, 4096
    v_mfma_f32_16x16x32_bf16 v[96:99], v[160:163], v[88:91], v[96:99]
    s_waitcnt lgkmcnt(7)
    ds_read2_b32 v[202:203], v12 offset0:226 offset1:227
    v_mfma_f32_16x16x32_bf16 v[100:103], v[160:163], v[92:95], v[100:103]
    ds_read_b128 v[76:79], v13 offset:0
    v_mfma_f32_16x16x32_bf16 v[100:103], v[164:167], v[88:91], v[100:103]
    s_waitcnt lgkmcnt(7)
    ds_read_b128 v[72:75], v9 offset:32
    ds_read2_b32 v[204:205], v12 offset0:96 offset1:97
    v_mfma_f32_16x16x32_bf16 v[96:99], v[168:171], v[60:63], v[96:99]
    s_waitcnt lgkmcnt(7)
    ds_read_b128 v[84:87], v13 offset:2048
    buffer_load_dwordx4 a[56:59], v3, s[4:7], s69 offen offset:0 sc1
    v_mfma_f32_16x16x32_bf16 v[100:103], v[168:171], v[56:59], v[100:103]
    ds_read_b128 v[80:83], v9 offset:544
    ds_read2_b32 v[206:207], v12 offset0:98 offset1:99
    v_mfma_f32_16x16x32_bf16 v[100:103], v[172:175], v[60:63], v[100:103]
    s_waitcnt lgkmcnt(9)
    buffer_load_dwordx4 a[60:63], v3, s[4:7], s67 offen offset:1024 sc1
    v_mfma_f32_16x16x32_bf16 v[96:99], v[176:179], v[68:71], v[96:99]
    s_waitcnt lgkmcnt(7)
    ds_read_b128 v[92:95], v9 offset:1504
    s_movk_i32 s33, 0x1ff0
    v_mfma_f32_16x16x32_bf16 v[100:103], v[176:179], v[64:67], v[100:103]
    ds_read_b128 v[88:91], v9 offset:992
    ds_read2_b32 v[208:209], v12 offset0:208 offset1:209
    v_mfma_f32_16x16x32_bf16 v[100:103], v[180:183], v[68:71], v[100:103]
    s_waitcnt lgkmcnt(8)
    ds_read_b128 v[56:59], v9 offset:480
    v_lshlrev_b32 v28, 3, v8
    v_mfma_f32_16x16x32_bf16 v[96:99], v[16:19], v[76:79], v[96:99]
    s_waitcnt lgkmcnt(8)
    ds_read_b128 v[60:63], v9 offset:2016
    ds_read2_b32 v[210:211], v12 offset0:210 offset1:211
    v_lshlrev_b32 v29, v7, s33
    v_mfma_f32_16x16x32_bf16 v[96:99], v[184:187], v[72:75], v[96:99]
    s_waitcnt lgkmcnt(8)
    s_movk_i32 s33, 0x0fe0
    v_lshrrev_b32 v29, v28, v29
    v_mfma_f32_16x16x32_bf16 v[100:103], v[16:19], v[84:87], v[100:103]
    s_waitcnt lgkmcnt(7)
    ds_read2_b32 v[212:213], v12 offset0:80 offset1:81
    buffer_load_dwordx4 a[64:67], v5, s[4:7], s68 offen offset:1024 sc1
    v_lshlrev_b32 v30, v7, s33
    v_mfma_f32_16x16x32_bf16 v[100:103], v[184:187], v[80:83], v[100:103]
    s_mov_b32 s33, 0x8001
    v_lshrrev_b32 v30, v28, v30
    v_mfma_f32_16x16x32_bf16 v[100:103], v[188:191], v[72:75], v[100:103]
    s_waitcnt lgkmcnt(6)
    ds_read_b128 v[64:67], v9 offset:1440
    ds_read2_b32 v[214:215], v12 offset0:82 offset1:83
    v_mfma_f32_16x16x32_bf16 v[104:107], v[128:131], v[92:95], 0
    s_waitcnt lgkmcnt(7)
    ds_read_b128 v[68:71], v9 offset:928
    buffer_load_dwordx4 a[68:71], v3, s[4:7], s69 offen offset:1024 sc1
    s_mov_b32 s34, 0x10001
    v_mfma_f32_16x16x32_bf16 v[104:107], v[132:135], v[88:91], v[104:107]
    s_waitcnt lgkmcnt(6)
    ds_read_b128 v[76:79], v9 offset:416
    v_bfe_u32 v20, v29, 0, 2
    v_mul_u32_u24 v20, s33, v20
    v_mfma_f32_16x16x32_bf16 v[104:107], v[192:195], v[56:59], v[104:107]
    s_waitcnt lgkmcnt(6)
    ds_read_b128 v[84:87], v9 offset:1952
    ds_read2_b32 v[216:217], v12 offset0:192 offset1:193
    v_and_b32 v20, s34, v20
    v_mfma_f32_16x16x32_bf16 v[108:111], v[128:131], v[60:63], 0
    buffer_load_dwordx4 a[72:75], v3, s[4:7], s67 offen offset:2048 sc1
    v_mul_u32_u24 v20, 0x3f80, v20
    v_cvt_pk_bf16_f32 v32, v96, v97
    v_mfma_f32_16x16x32_bf16 v[108:111], v[132:135], v[92:95], v[108:111]
    ds_read2_b32 v[218:219], v12 offset0:194 offset1:195
    v_bfe_u32 v21, v29, 2, 2
    v_mul_u32_u24_e64 v21, s33, v21
    v_mfma_f32_16x16x32_bf16 v[108:111], v[192:195], v[88:91], v[108:111]
    v_and_b32_e64 v21, s34, v21
    v_cvt_pk_bf16_f32 v34, v100, v101
    v_mfma_f32_16x16x32_bf16 v[108:111], v[196:199], v[56:59], v[108:111]
    s_waitcnt lgkmcnt(6)
    ds_read_b128 v[80:83], v9 offset:1376
    ds_read2_b32 v[220:221], v12 offset0:64 offset1:65
    v_mul_u32_u24 v21, 0x3f80, v21
    v_mfma_f32_16x16x32_bf16 v[104:107], v[136:139], v[64:67], v[104:107]
    s_waitcnt lgkmcnt(6)
    ds_read_b128 v[72:75], v9 offset:864
    buffer_load_dwordx4 a[76:79], v5, s[4:7], s68 offen offset:2048 sc1
    v_bfe_u32 v22, v29, 4, 2
    v_mfma_f32_16x16x32_bf16 v[104:107], v[140:143], v[68:71], v[104:107]
    s_waitcnt lgkmcnt(6)
    ds_read_b128 v[60:63], v9 offset:352
    ds_read2_b32 v[222:223], v12 offset0:66 offset1:67
    v_cvt_pk_bf16_f32 v33, v98, v99
    v_cvt_pk_bf16_f32 v35, v102, v103
    v_mul_u32_u24 v22, s33, v22
    v_and_b32_e64 v22, s34, v22
    v_mfma_f32_16x16x32_bf16 v[104:107], v[200:203], v[76:79], v[104:107]
    s_waitcnt lgkmcnt(7)
    ds_read_b128 v[92:95], v9 offset:1888
    v_permlane16_swap_b32 v32, v34
    v_mul_u32_u24 v22, 0x3f80, v22
    v_mfma_f32_16x16x32_bf16 v[108:111], v[136:139], v[84:87], v[108:111]
    v_permlane16_swap_b32 v33, v35
    v_bfe_u32 v23, v29, 6, 2
    buffer_store_dwordx4 v[32:35], v15, s[4:7], 0 offen sc1
    v_mfma_f32_16x16x32_bf16 v[108:111], v[140:143], v[64:67], v[108:111]
    ds_read2_b32 v[224:225], v12 offset0:176 offset1:177
    v_mul_u32_u24 v23, s33, v23
    v_and_b32_e64 v23, s34, v23
    v_mfma_f32_16x16x32_bf16 v[108:111], v[200:203], v[68:71], v[108:111]
    v_mul_u32_u24 v23, 0x3f80, v23
    v_bfe_u32 v24, v30, 0, 2
    v_mfma_f32_16x16x32_bf16 v[108:111], v[204:207], v[76:79], v[108:111]
    s_waitcnt lgkmcnt(6)
    ds_read_b128 v[88:91], v9 offset:1312
    ds_read2_b32 v[226:227], v12 offset0:178 offset1:179
    buffer_store_dword v127, v126, s[4:7], 0 offen sc1
    v_mfma_f32_16x16x32_bf16 v[104:107], v[144:147], v[80:83], v[104:107]
    s_waitcnt lgkmcnt(6)
    ds_read_b128 v[56:59], v9 offset:800
    v_mul_u32_u24_e64 v24, s33, v24
    v_mfma_f32_16x16x32_bf16 v[104:107], v[148:151], v[72:75], v[104:107]
    s_waitcnt lgkmcnt(6)
    ds_read_b128 v[84:87], v9 offset:288
    ds_read2_b32 v[228:229], v12 offset0:48 offset1:49
    v_and_b32 v24, s34, v24
    v_mul_u32_u24 v24, 0x3f80, v24
    v_mfma_f32_16x16x32_bf16 v[104:107], v[208:211], v[60:63], v[104:107]
    s_waitcnt lgkmcnt(6)
    ds_read_b128 v[64:67], v9 offset:1824
    v_bfe_u32 v25, v30, 2, 2
    v_mfma_f32_16x16x32_bf16 v[108:111], v[144:147], v[92:95], v[108:111]
    ds_read2_b32 v[230:231], v12 offset0:50 offset1:51
    v_mul_u32_u24 v25, s33, v25
    v_mfma_f32_16x16x32_bf16 v[108:111], v[148:151], v[80:83], v[108:111]
    v_and_b32_e64 v25, s34, v25
    v_mul_u32_u24 v25, 0x3f80, v25
    v_mfma_f32_16x16x32_bf16 v[108:111], v[208:211], v[72:75], v[108:111]
    v_bfe_u32 v26, v30, 4, 2
    v_mul_u32_u24_e64 v26, s33, v26
    v_mfma_f32_16x16x32_bf16 v[108:111], v[212:215], v[60:63], v[108:111]
    s_waitcnt lgkmcnt(6)
    ds_read_b128 v[68:71], v9 offset:464
    ds_read2_b32 v[232:233], v12 offset0:160 offset1:161
    v_mfma_f32_16x16x32_bf16 v[104:107], v[152:155], v[88:91], v[104:107]
    s_waitcnt lgkmcnt(6)
    ds_read_b128 v[76:79], v9 offset:480
    v_and_b32_e64 v26, s34, v26
    v_mfma_f32_16x16x32_bf16 v[104:107], v[156:159], v[56:59], v[104:107]
    s_waitcnt lgkmcnt(6)
    ds_read_b128 v[92:95], v9 offset:976
    ds_read2_b32 v[234:235], v12 offset0:162 offset1:163
    v_mul_u32_u24 v26, 0x3f80, v26
    v_bfe_u32 v27, v30, 6, 2
    v_mfma_f32_16x16x32_bf16 v[104:107], v[216:219], v[84:87], v[104:107]
    s_waitcnt lgkmcnt(6)
    ds_read_b128 v[80:83], v9 offset:992
    v_mul_u32_u24_e64 v27, s33, v27
    v_mfma_f32_16x16x32_bf16 v[108:111], v[152:155], v[64:67], v[108:111]
    ds_read_b128 v[72:75], v9 offset:1248
    ds_read2_b32 v[236:237], v12 offset0:32 offset1:33
    v_and_b32_e64 v27, s34, v27
    v_mfma_f32_16x16x32_bf16 v[108:111], v[156:159], v[88:91], v[108:111]
    ds_read_b128 v[60:63], v9 offset:736
    v_mul_u32_u24 v27, 0x3f80, v27
    v_add_u32 v11, -1088, v10
    v_mfma_f32_16x16x32_bf16 v[108:111], v[216:219], v[56:59], v[108:111]
    ds_read_b128 v[64:67], v9 offset:224
    ds_read2_b32 v[238:239], v12 offset0:34 offset1:35
    buffer_load_dwordx4 a[80:83], v3, s[4:7], s69 offen offset:2048 sc1
    v_mfma_f32_16x16x32_bf16 v[108:111], v[220:223], v[84:87], v[108:111]
    s_waitcnt lgkmcnt(10)
    ds_read_b128 v[88:91], v9 offset:1760
    v_lshlrev_b32 v14, 2, v8
    v_mfma_f32_16x16x32_bf16 v[112:115], v[68:71], v[20:23], 0
    s_waitcnt lgkmcnt(9)
    v_sub_u32 v14, v14, v7
    v_mfma_f32_16x16x32_bf16 v[116:119], v[76:79], v[24:27], 0
    s_waitcnt lgkmcnt(8)
    ds_read2_b32 v[240:241], v12 offset0:144 offset1:145
    v_mfma_f32_16x16x32_bf16 v[120:123], v[92:95], v[20:23], 0
    s_waitcnt lgkmcnt(7)
    buffer_load_dwordx4 a[84:87], v3, s[4:7], s67 offen offset:3072 sc1
    v_lshl_add_u32 v14, v14, 2, s71
    v_mfma_f32_16x16x32_bf16 v[124:127], v[80:83], v[24:27], 0
    s_waitcnt lgkmcnt(6)
    ds_read_b128 v[56:59], v9 offset:1184
    ds_read2_b32 v[242:243], v12 offset0:146 offset1:147
    v_mfma_f32_16x16x32_bf16 v[104:107], v[160:163], v[72:75], v[104:107]
    s_waitcnt lgkmcnt(6)
    ds_read_b128 v[84:87], v9 offset:672
    v_add_u32 v14, 4444, v14
    v_mfma_f32_16x16x32_bf16 v[104:107], v[164:167], v[60:63], v[104:107]
    s_waitcnt lgkmcnt(6)
    ds_read_b128 v[68:71], v9 offset:160
    ds_read2_b32 v[244:245], v12 offset0:16 offset1:17
    buffer_load_dwordx4 a[88:91], v5, s[4:7], s68 offen offset:3072 sc1
    v_mfma_f32_16x16x32_bf16 v[104:107], v[224:227], v[64:67], v[104:107]
    s_waitcnt lgkmcnt(6)
    ds_read_b128 v[76:79], v9 offset:1696
    s_mul_i32 s66, s3, 5120
    v_mfma_f32_16x16x32_bf16 v[108:111], v[160:163], v[88:91], v[108:111]
    s_mul_i32 s33, s57, 32
    ds_read2_b32 v[246:247], v12 offset0:18 offset1:19
    v_mfma_f32_16x16x32_bf16 v[108:111], v[164:167], v[72:75], v[108:111]
    v_cvt_pk_bf16_f32 v40, v112, v116
    v_mfma_f32_16x16x32_bf16 v[108:111], v[224:227], v[60:63], v[108:111]
    s_add_u32 s66, s66, s33
    buffer_load_dwordx4 a[92:95], v3, s[4:7], s69 offen offset:3072 sc1
    v_cvt_pk_bf16_f32 v41, v113, v117
    v_mfma_f32_16x16x32_bf16 v[108:111], v[228:231], v[64:67], v[108:111]
    s_waitcnt lgkmcnt(6)
    ds_read_b128 v[92:95], v9 offset:1488
    ds_read2_b32 v[248:249], v12 offset0:128 offset1:129
    v_cvt_pk_bf16_f32 v42, v114, v118
    v_mfma_f32_16x16x32_bf16 v[104:107], v[168:171], v[56:59], v[104:107]
    s_waitcnt lgkmcnt(6)
    ds_read_b128 v[80:83], v9 offset:1504
    v_cvt_pk_bf16_f32 v43, v115, v119
    v_mfma_f32_16x16x32_bf16 v[104:107], v[172:175], v[84:87], v[104:107]
    s_waitcnt lgkmcnt(6)
    ds_read_b128 v[88:91], v9 offset:2000
    ds_read2_b32 v[250:251], v12 offset0:130 offset1:131
    v_cvt_pk_bf16_f32 v44, v120, v124
    s_add_u32 s66, s66, 20185088
    v_mfma_f32_16x16x32_bf16 v[104:107], v[232:235], v[68:71], v[104:107]
    s_waitcnt lgkmcnt(6)
    ds_read_b128 v[72:75], v9 offset:2016
    v_cvt_pk_bf16_f32 v45, v121, v125
    s_add_u32 s67, s74, 8192
    v_mfma_f32_16x16x32_bf16 v[108:111], v[168:171], v[76:79], v[108:111]
    ds_read_b128 v[60:63], v9 offset:1120
    ds_read2_b32 v[252:253], v12 offset0:0 offset1:1
    v_cvt_pk_bf16_f32 v46, v122, v126
    v_mfma_f32_16x16x32_bf16 v[108:111], v[172:175], v[56:59], v[108:111]
    s_mov_b32 s46, 655360
    ds_read_b128 v[64:67], v9 offset:608
    buffer_load_dwordx4 a[96:99], v3, s[4:7], s67 offen offset:0 sc1
    v_cvt_pk_bf16_f32 v47, v123, v127
    v_mfma_f32_16x16x32_bf16 v[108:111], v[232:235], v[84:87], v[108:111]
    s_add_u32 s68, s75, 8192
    ds_read_b128 v[76:79], v9 offset:96
    ds_read2_b32 v[254:255], v12 offset0:2 offset1:3
    buffer_load_dwordx4 a[100:103], v5, s[4:7], s68 offen offset:0 sc1
    v_mfma_f32_16x16x32_bf16 v[108:111], v[236:239], v[68:71], v[108:111]
    s_waitcnt lgkmcnt(10)
    ds_read_b128 v[56:59], v9 offset:1632
    s_add_u32 s69, s76, 8192
    v_mfma_f32_16x16x32_bf16 v[112:115], v[92:95], v[20:23], 0
    s_waitcnt lgkmcnt(9)
    buffer_load_dwordx4 a[104:107], v3, s[4:7], s69 offen offset:0 sc1
    s_mov_b32 s47, 1310720
    s_mov_b32 s48, 1966080
    v_mfma_f32_16x16x32_bf16 v[116:119], v[80:83], v[24:27], 0
    s_waitcnt lgkmcnt(8)
    buffer_load_dwordx4 a[108:111], v3, s[4:7], s67 offen offset:1024 sc1
    v_mfma_f32_16x16x32_bf16 v[120:123], v[88:91], v[20:23], 0
    s_waitcnt lgkmcnt(6)
    v_bfe_u32 v4, v2, 3, 1
    v_lshrrev_b32_e64 v6, 5, v2
    v_mfma_f32_16x16x32_bf16 v[124:127], v[72:75], v[24:27], 0
    s_waitcnt lgkmcnt(5)
    ds_read_b128 v[84:87], v13 offset:4096
    v_lshl_or_b32 v4, v6, 1, v4
    v_mfma_f32_16x16x32_bf16 v[104:107], v[176:179], v[60:63], v[104:107]
    s_waitcnt lgkmcnt(4)
    ds_read_b128 v[68:71], v9 offset:1056
    v_lshlrev_b32_e64 v4, 4, v4
    v_mfma_f32_16x16x32_bf16 v[104:107], v[180:183], v[64:67], v[104:107]
    s_waitcnt lgkmcnt(4)
    ds_read_b128 v[92:95], v9 offset:544
    v_xor_b32 v6, v4, v3
    v_mfma_f32_16x16x32_bf16 v[104:107], v[240:243], v[76:79], v[104:107]
    s_waitcnt lgkmcnt(3)
    ds_read_b128 v[80:83], v9 offset:32
    s_mul_i32 s58, s3, 40
    v_mfma_f32_16x16x32_bf16 v[108:111], v[176:179], v[56:59], v[108:111]
    s_and_b32 s59, s51, 3
    ds_read_b128 v[88:91], v13 offset:6144
    buffer_load_dwordx4 a[112:115], v5, s[4:7], s68 offen offset:1024 sc1
    s_mul_i32 s59, s59, 160
    v_mfma_f32_16x16x32_bf16 v[108:111], v[180:183], v[60:63], v[108:111]
    s_add_u32 s58, s58, s59
    ds_read_b128 v[72:75], v9 offset:1568
    v_cvt_pk_bf16_f32 v48, v112, v116
    v_mfma_f32_16x16x32_bf16 v[108:111], v[240:243], v[64:67], v[108:111]
    v_cvt_pk_bf16_f32 v49, v113, v117
    v_min_u32_e64 v4, 39, v2
    v_mfma_f32_16x16x32_bf16 v[108:111], v[244:247], v[76:79], v[108:111]
    s_waitcnt vmcnt(9) lgkmcnt(5)
    ds_read_b128 v[60:63], v9 offset:480
    v_cvt_pk_bf16_f32 v50, v114, v118
    s_barrier
    s_atomic_swap s50, s[4:5], s66 offset:0
    v_add_u32_e64 v4, s58, v4
    v_mfma_f32_16x16x32_bf16 v[104:107], v[16:19], v[84:87], v[104:107]
    s_waitcnt lgkmcnt(5)
    ds_read2_b32 v[58:59], v11 offset0:2 offset1:3
    buffer_load_dwordx4 a[116:119], v3, s[4:7], s69 offen offset:1024 sc1
    v_cvt_pk_bf16_f32 v51, v115, v119
    v_mul_u32_u24 v4, 32, v4
    v_mfma_f32_16x16x32_bf16 v[104:107], v[184:187], v[68:71], v[104:107]
    s_waitcnt lgkmcnt(5)
    ds_read2_b32 v[56:57], v11 offset0:0 offset1:1
    buffer_load_dwordx4 a[120:123], v3, s[4:7], s67 offen offset:2048 sc1
    v_cvt_pk_bf16_f32 v52, v120, v124
    v_add_u32 v4, 20185088, v4
    v_mfma_f32_16x16x32_bf16 v[104:107], v[188:191], v[92:95], v[104:107]
    s_waitcnt lgkmcnt(5)
    ds_read_b128 v[64:67], v9 offset:2528
    v_cvt_pk_bf16_f32 v53, v121, v125
    s_mul_i32 s61, s3, 10240
    v_mfma_f32_16x16x32_bf16 v[104:107], v[248:251], v[80:83], v[104:107]
    s_waitcnt lgkmcnt(5)
    ds_read_b128 v[76:79], v9 offset:2016
    v_cvt_pk_bf16_f32 v54, v122, v126
    s_mul_i32 s60, s54, 40960
    v_mfma_f32_16x16x32_bf16 v[108:111], v[16:19], v[88:91], v[108:111]
    s_waitcnt lgkmcnt(5)
    ds_read_b128 v[84:87], v9 offset:1504
    buffer_load_dwordx4 a[124:127], v5, s[4:7], s68 offen offset:2048 sc1
    v_cvt_pk_bf16_f32 v55, v123, v127
    s_add_u32 s60, s60, s61
    s_add_u32 s60, s60, 4194304
    v_mfma_f32_16x16x32_bf16 v[108:111], v[184:187], v[72:75], v[108:111]
    s_and_b32 s33, s3, 1
    ds_read_b128 v[88:91], v9 offset:992
    ds_read2_b32 a[240:241], v14 offset0:48 offset1:49
    v_mfma_f32_16x16x32_bf16 v[108:111], v[188:191], v[68:71], v[108:111]
    s_lshr_b32 s32, s3, 1
    buffer_load_dwordx4 a[128:131], v3, s[4:7], s69 offen offset:2048 sc1
    v_mfma_f32_16x16x32_bf16 v[108:111], v[248:251], v[92:95], v[108:111]
    s_lshl_b32 s37, s54, 14
    ds_read_b128 v[72:75], v9 offset:3040
    s_add_u32 s37, s37, 20709376
    v_mfma_f32_16x16x32_bf16 v[108:111], v[252:255], v[80:83], v[108:111]
    s_waitcnt lgkmcnt(6)
    ds_read2_b32 a[242:243], v14 offset0:50 offset1:51
    s_and_b32 s58, s53, 3
    v_mfma_f32_16x16x32_bf16 v[112:115], v[56:59], v[60:63], 0
    s_waitcnt lgkmcnt(6)
    s_lshl_b32 s41, s58, 2
    s_lshl_b32 s58, s58, 8
    v_mfma_f32_16x16x32_bf16 v[112:115], v[128:131], v[64:67], v[112:115]
    s_waitcnt lgkmcnt(5)
    buffer_load_dwordx4 a[132:135], v3, s[4:7], s67 offen offset:3072 sc1
    v_mfma_f32_16x16x32_bf16 v[112:115], v[132:135], v[76:79], v[112:115]
    s_waitcnt lgkmcnt(4)
    ds_read_b128 v[68:71], v9 offset:2464
    ds_read2_b32 a[244:245], v14 offset0:32 offset1:33
    s_lshl_b32 s59, s33, 7
    v_mfma_f32_16x16x32_bf16 v[112:115], v[192:195], v[84:87], v[112:115]
    s_waitcnt lgkmcnt(5)
    ds_read_b128 v[92:95], v9 offset:1952
    s_add_u32 s38, s58, s59
    v_mfma_f32_16x16x32_bf16 v[112:115], v[196:199], v[88:91], v[112:115]
    ds_read_b128 v[80:83], v9 offset:1440
    ds_read2_b32 a[246:247], v14 offset0:34 offset1:35
    s_lshr_b32 s58, s53, 2
    v_mfma_f32_16x16x32_bf16 v[116:119], v[56:59], v[88:91], 0
    s_waitcnt lgkmcnt(6)
    ds_read_b128 v[60:63], v9 offset:928
    buffer_load_dwordx4 a[136:139], v5, s[4:7], s68 offen offset:3072 sc1
    s_lshl_b32 s59, s58, 7
    s_add_u32 s41, s41, s59
    v_mfma_f32_16x16x32_bf16 v[116:119], v[128:131], v[72:75], v[116:119]
    s_lshl_b32 s58, s58, 5
    v_cvt_pk_bf16_f32 v36, v104, v105
    v_cvt_pk_bf16_f32 v38, v108, v109
    v_mfma_f32_16x16x32_bf16 v[116:119], v[132:135], v[64:67], v[116:119]
    s_add_u32 s38, s38, s58
    ds_read_b128 v[56:59], v9 offset:2976
    v_cvt_pk_bf16_f32 v37, v106, v107
    v_mfma_f32_16x16x32_bf16 v[116:119], v[192:195], v[76:79], v[116:119]
    s_add_u32 s38, s38, s37
    buffer_load_dwordx4 a[140:143], v3, s[4:7], s69 offen offset:3072 sc1
    v_cvt_pk_bf16_f32 v39, v110, v111
    v_permlane16_swap_b32 v36, v38
    v_mfma_f32_16x16x32_bf16 v[116:119], v[196:199], v[84:87], v[116:119]
    s_waitcnt lgkmcnt(6)
    s_lshl_b32 s58, s54, 9
    v_permlane16_swap_b32 v37, v39
    v_mfma_f32_16x16x32_bf16 v[112:115], v[136:139], v[68:71], v[112:115]
    s_waitcnt lgkmcnt(4)
    s_add_u32 s41, s41, s58
    s_add_u32 s41, s41, 393216
    v_mfma_f32_16x16x32_bf16 v[112:115], v[140:143], v[92:95], v[112:115]
    s_waitcnt lgkmcnt(3)
    s_mul_i32 s40, s54, 98304
    s_add_u32 s67, s74, 12288
    v_mfma_f32_16x16x32_bf16 v[112:115], v[200:203], v[80:83], v[112:115]
    s_waitcnt lgkmcnt(1)
    buffer_load_dwordx4 a[144:147], v3, s[4:7], s67 offen offset:0 sc1
    s_mul_i32 s58, s53, 3072
    s_add_u32 s40, s40, s58
    v_mfma_f32_16x16x32_bf16 v[112:115], v[204:207], v[60:63], v[112:115]
    s_add_u32 s68, s75, 12288
    ds_read_b128 v[88:91], v13 offset:8192
    buffer_store_dwordx4 v[36:39], v15, s[4:7], s46 offen sc1
    s_add_u32 s40, s40, 13631488
    v_mfma_f32_16x16x32_bf16 v[112:115], v[40:43], a[240:243], v[112:115]
    s_waitcnt lgkmcnt(1)
    ds_read_b128 v[72:75], v9 offset:2400
    s_mov_b32 s42, 0x01000100
    v_mfma_f32_16x16x32_bf16 v[116:119], v[136:139], v[56:59], v[116:119]
    s_mov_b32 s43, 0x03020302
    ds_read_b128 v[64:67], v9 offset:1888
    s_lshr_b32 s34, s53, 3
    v_mfma_f32_16x16x32_bf16 v[116:119], v[140:143], v[68:71], v[116:119]
    s_lshl_b32 s34, s34, 2
    ds_read_b128 v[76:79], v9 offset:1376
    s_and_b32 s58, s53, 3
    v_mfma_f32_16x16x32_bf16 v[116:119], v[200:203], v[92:95], v[116:119]
    s_add_u32 s34, s34, s58
    ds_read_b128 v[84:87], v9 offset:864
    s_mov_b32 s35, s54
    v_mfma_f32_16x16x32_bf16 v[116:119], v[204:207], v[80:83], v[116:119]
    s_bfe_u32 s36, s53, 0x10002
    ds_read_b128 v[60:63], v13 offset:10240
    s_lshl_b32 s39, s35, 2
    v_mfma_f32_16x16x32_bf16 v[116:119], v[40:43], a[244:247], v[116:119]
    s_add_u32 s39, s39, s3
    ds_read_b128 v[56:59], v9 offset:2912
    s_lshl_b32 s39, s39, 7
    v_mfma_f32_16x16x32_bf16 v[116:119], v[44:47], a[240:243], v[116:119]
    s_waitcnt lgkmcnt(6)
    buffer_load_dwordx4 a[148:151], v5, s[4:7], s68 offen offset:0 sc1
    v_mfma_f32_16x16x32_bf16 v[112:115], v[16:19], v[88:91], v[112:115]
    s_waitcnt lgkmcnt(5)
    s_add_u32 s69, s76, 12288
    s_add_u32 s39, s39, 393216
    v_mfma_f32_16x16x32_bf16 v[112:115], v[144:147], v[72:75], v[112:115]
    s_waitcnt lgkmcnt(4)
    buffer_load_dwordx4 a[152:155], v3, s[4:7], s69 offen offset:0 sc1
    v_mfma_f32_16x16x32_bf16 v[112:115], v[148:151], v[64:67], v[112:115]
    s_waitcnt lgkmcnt(3)
    ds_read_b128 v[68:71], v9 offset:2336
    s_mul_i32 s44, s34, 245760
    v_mfma_f32_16x16x32_bf16 v[112:115], v[208:211], v[76:79], v[112:115]
    s_waitcnt lgkmcnt(3)
    ds_read_b128 v[92:95], v9 offset:1824
    s_mul_i32 s58, s3, 12288
L_stub3:
    s_cbranch_execz L_tdone
    v_mfma_f32_16x16x32_bf16 v[112:115], v[212:215], v[84:87], v[112:115]
    s_waitcnt lgkmcnt(3)
    ds_read_b128 v[80:83], v9 offset:1312
    s_add_u32 s44, s44, s58
    v_mfma_f32_16x16x32_bf16 v[116:119], v[16:19], v[60:63], v[116:119]
    s_waitcnt lgkmcnt(3)
    ds_read_b128 v[88:91], v9 offset:800
    s_add_u32 s44, s44, 11665408
    v_mfma_f32_16x16x32_bf16 v[116:119], v[144:147], v[56:59], v[116:119]
    s_lshl_b32 s45, s35, 1
    ds_read_b128 v[84:87], v9 offset:2848
    s_add_u32 s45, s45, s36
    v_mfma_f32_16x16x32_bf16 v[116:119], v[148:151], v[72:75], v[116:119]
    s_mul_i32 s45, s45, 49152
    buffer_load_dwordx4 a[156:159], v3, s[4:7], s67 offen offset:1024 sc1
    v_mfma_f32_16x16x32_bf16 v[116:119], v[208:211], v[64:67], v[116:119]
    s_add_u32 s45, s45, s58
    buffer_load_dwordx4 a[160:163], v5, s[4:7], s68 offen offset:1024 sc1
    v_mfma_f32_16x16x32_bf16 v[116:119], v[212:215], v[76:79], v[116:119]
    s_waitcnt lgkmcnt(4)
    ds_read2_b32 a[248:249], v14 offset0:16 offset1:17
    s_add_u32 s45, s45, 13631488
    v_mfma_f32_16x16x32_bf16 v[112:115], v[152:155], v[68:71], v[112:115]
    s_waitcnt lgkmcnt(4)
    ds_read_b128 v[60:63], v9 offset:2272
    s_mul_i32 s58, s32, 3
    v_mfma_f32_16x16x32_bf16 v[112:115], v[156:159], v[92:95], v[112:115]
    s_waitcnt lgkmcnt(4)
    ds_read_b128 v[56:59], v9 offset:1760
    s_mul_i32 s59, s53, 6
    v_mfma_f32_16x16x32_bf16 v[112:115], v[216:219], v[80:83], v[112:115]
    s_waitcnt lgkmcnt(4)
    ds_read_b128 v[72:75], v9 offset:1248
    s_add_u32 s58, s58, s59
    v_mfma_f32_16x16x32_bf16 v[112:115], v[220:223], v[88:91], v[112:115]
    s_waitcnt lgkmcnt(4)
    ds_read_b128 v[64:67], v9 offset:736
    s_lshl_b32 s58, s58, 10
    v_mfma_f32_16x16x32_bf16 v[116:119], v[152:155], v[84:87], v[116:119]
    s_add_u32 s49, s58, 264192
    ds_read_b128 v[76:79], v9 offset:2784
    s_lshl_b32 s59, s33, 10
    v_mfma_f32_16x16x32_bf16 v[116:119], v[156:159], v[68:71], v[116:119]
    s_add_u32 s77, s58, s59
    buffer_load_dwordx4 a[164:167], v3, s[4:7], s69 offen offset:1024 sc1
    v_mfma_f32_16x16x32_bf16 v[116:119], v[216:219], v[92:95], v[116:119]
    s_add_u32 s77, s77, 262144
    ds_read2_b32 a[250:251], v14 offset0:18 offset1:19
    s_mov_b32 s8, s50
    v_mfma_f32_16x16x32_bf16 v[116:119], v[220:223], v[80:83], v[116:119]
    s_waitcnt lgkmcnt(5)
    s_mov_b32 s63, 0
    buffer_load_dword v31, v4, s[4:7], s63 offen sc1
    v_mfma_f32_16x16x32_bf16 v[112:115], v[160:163], v[60:63], v[112:115]
    s_waitcnt lgkmcnt(4)
    ds_read_b128 v[88:91], v9 offset:2208
    s_mov_b32 s9, s50
    v_mfma_f32_16x16x32_bf16 v[112:115], v[164:167], v[56:59], v[112:115]
    s_waitcnt lgkmcnt(4)
    ds_read_b128 v[84:87], v9 offset:1696
    v_bfe_u32 v12, v2, 2, 2
    v_mfma_f32_16x16x32_bf16 v[112:115], v[224:227], v[72:75], v[112:115]
    s_waitcnt lgkmcnt(4)
    ds_read_b128 v[68:71], v9 offset:1184
    v_lshrrev_b32 v7, 5, v2
    v_mfma_f32_16x16x32_bf16 v[112:115], v[228:231], v[64:67], v[112:115]
    s_waitcnt lgkmcnt(4)
    ds_read_b128 v[92:95], v9 offset:672
    v_lshl_add_u32 v8, v7, 3, v12
    v_mfma_f32_16x16x32_bf16 v[116:119], v[160:163], v[76:79], v[116:119]
    ds_read_b128 v[80:83], v9 offset:2720
    v_lshrrev_b32 v12, 1, v12
    v_mfma_f32_16x16x32_bf16 v[116:119], v[164:167], v[60:63], v[116:119]
    ds_read2_b32 a[252:253], v14 offset0:0 offset1:1
    v_lshl_or_b32 v12, v7, 1, v12
    v_mfma_f32_16x16x32_bf16 v[116:119], v[224:227], v[56:59], v[116:119]
    v_bfe_u32 v7, v2, 4, 1
    v_bfe_u32 v10, v2, 1, 1
    v_mfma_f32_16x16x32_bf16 v[116:119], v[228:231], v[72:75], v[116:119]
    s_waitcnt lgkmcnt(5)
    v_lshl_or_b32 v10, v7, 1, v10
    v_xor_b32 v12, v12, v10
    v_mfma_f32_16x16x32_bf16 v[112:115], v[168:171], v[88:91], v[112:115]
    s_waitcnt lgkmcnt(4)
    ds_read_b128 v[64:67], v9 offset:2144
    v_lshlrev_b32 v12, 4, v12
    v_mfma_f32_16x16x32_bf16 v[112:115], v[172:175], v[84:87], v[112:115]
    s_waitcnt lgkmcnt(4)
    ds_read_b128 v[76:79], v9 offset:1632
    v_lshl_add_u32 v12, v8, 6, v12
    v_mfma_f32_16x16x32_bf16 v[112:115], v[232:235], v[68:71], v[112:115]
    s_waitcnt lgkmcnt(4)
    ds_read_b128 v[60:63], v9 offset:1120
    v_and_b32_e64 v10, 1, v2
    v_mfma_f32_16x16x32_bf16 v[112:115], v[236:239], v[92:95], v[112:115]
    s_waitcnt lgkmcnt(4)
    ds_read_b128 v[56:59], v9 offset:608
    ds_read2_b32 a[254:255], v14 offset0:2 offset1:3
    v_mfma_f32_16x16x32_bf16 v[116:119], v[168:171], v[80:83], v[116:119]
    ds_read_b128 v[72:75], v9 offset:2656
    v_lshl_add_u32 v12, v10, 3, v12
    s_mul_i32 s58, s33, 20480
    v_mfma_f32_16x16x32_bf16 v[116:119], v[172:175], v[88:91], v[116:119]
    buffer_load_dwordx4 a[168:171], v3, s[4:7], s67 offen offset:2048 sc1
    v_add_u32 v12, s58, v12
    v_and_b32_e64 v0, 7, v2
    v_mfma_f32_16x16x32_bf16 v[116:119], v[232:235], v[84:87], v[116:119]
    buffer_load_dwordx4 a[172:175], v5, s[4:7], s68 offen offset:2048 sc1
    v_mfma_f32_16x16x32_bf16 v[116:119], v[236:239], v[68:71], v[116:119]
    s_waitcnt lgkmcnt(5)
    v_mul_u32_u24 v0, 20, v0
    v_lshrrev_b32_e64 v10, 3, v2
    v_mfma_f32_16x16x32_bf16 v[112:115], v[176:179], v[64:67], v[112:115]
    s_waitcnt lgkmcnt(4)
    ds_read_b128 v[92:95], v9 offset:2080
    v_add_lshl_u32 v0, v0, v10, 2
    v_mfma_f32_16x16x32_bf16 v[112:115], v[180:183], v[76:79], v[112:115]
    s_waitcnt lgkmcnt(4)
    ds_read_b128 v[80:83], v9 offset:1568
    v_and_or_b32 v0, v2, 3, v0
    v_mfma_f32_16x16x32_bf16 v[112:115], v[240:243], v[60:63], v[112:115]
    s_waitcnt lgkmcnt(4)
    ds_read_b128 v[88:91], v9 offset:1056
    v_bfe_u32 v30, v2, 1, 3
    v_mfma_f32_16x16x32_bf16 v[112:115], v[244:247], v[56:59], v[112:115]
    s_waitcnt lgkmcnt(3)
    ds_read_b128 v[84:87], v9 offset:544
    v_mul_u32_u24_e64 v8, 20, v30
    v_mfma_f32_16x16x32_bf16 v[116:119], v[176:179], v[72:75], v[116:119]
    ds_read_b128 v[68:71], v9 offset:2592
    buffer_load_dwordx4 a[176:179], v3, s[4:7], s69 offen offset:2048 sc1
    v_lshrrev_b32_e64 v10, 4, v2
    v_mfma_f32_16x16x32_bf16 v[116:119], v[180:183], v[64:67], v[116:119]
    v_add_lshl_u32 v8, v8, v10, 2
    v_lshlrev_b32_e64 v10, 1, v2
    v_mfma_f32_16x16x32_bf16 v[116:119], v[240:243], v[76:79], v[116:119]
    ds_read_b128 v[72:75], v9 offset:1504
    v_xor_b32_e64 v30, v30, v10
    v_mfma_f32_16x16x32_bf16 v[116:119], v[244:247], v[60:63], v[116:119]
    s_waitcnt lgkmcnt(5)
    ds_read2_b32 v[58:59], v11 offset0:2 offset1:3
    v_and_or_b32 v30, v30, 3, v8
    v_mfma_f32_16x16x32_bf16 v[112:115], v[184:187], v[92:95], v[112:115]
    s_waitcnt lgkmcnt(5)
    ds_read2_b32 v[56:57], v11 offset0:0 offset1:1
    buffer_load_dwordx4 a[180:183], v3, s[4:7], s67 offen offset:3072 sc1
    s_lshl_b32 s58, s53, 1
    v_mfma_f32_16x16x32_bf16 v[112:115], v[188:191], v[80:83], v[112:115]
    s_waitcnt lgkmcnt(5)
    ds_read_b128 v[64:67], v9 offset:3552
    s_add_u32 s58, s58, s33
    v_mfma_f32_16x16x32_bf16 v[112:115], v[248:251], v[88:91], v[112:115]
    s_waitcnt lgkmcnt(5)
    ds_read_b128 v[76:79], v9 offset:3040
    s_lshr_b32 s59, s58, 3
    v_mfma_f32_16x16x32_bf16 v[112:115], v[252:255], v[84:87], v[112:115]
    s_waitcnt lgkmcnt(5)
    ds_read_b128 v[60:63], v9 offset:2528
    buffer_load_dwordx4 a[184:187], v5, s[4:7], s68 offen offset:3072 sc1
    s_and_b32 s58, s58, 7
    s_lshl_b32 s58, s58, 1
    v_mfma_f32_16x16x32_bf16 v[116:119], v[184:187], v[68:71], v[116:119]
    ds_read_b128 v[84:87], v9 offset:2016
    v_bfe_u32 v10, v0, 1, 1
    v_mfma_f32_16x16x32_bf16 v[116:119], v[188:191], v[92:95], v[116:119]
    s_waitcnt vmcnt(11)
    v_lshrrev_b32 v8, 2, v0
    s_barrier
    s_atomic_swap s50, s[4:5], s66 offset:20480
    v_mfma_f32_16x16x32_bf16 v[116:119], v[248:251], v[80:83], v[116:119]
    ds_read_b128 v[68:71], v9 offset:4064
    buffer_load_dwordx4 a[188:191], v3, s[4:7], s69 offen offset:3072 sc1
    v_and_or_b32 v10, v8, 2, v10
    v_mfma_f32_16x16x32_bf16 v[116:119], v[252:255], v[88:91], v[116:119]
    s_waitcnt lgkmcnt(5)
    v_xor_b32_e64 v10, s59, v10
    s_add_u32 s67, s74, 16384
    v_mfma_f32_16x16x32_bf16 v[120:123], v[56:59], v[72:75], 0
    s_waitcnt lgkmcnt(4)
    v_lshl_add_u32 v10, v10, 4, s58
    v_lshl_add_u32 v0, v0, 6, v10
    v_mfma_f32_16x16x32_bf16 v[120:123], v[128:131], v[64:67], v[120:123]
    s_waitcnt lgkmcnt(3)
    buffer_load_dwordx4 a[192:195], v3, s[4:7], s67 offen offset:0 sc1
    v_bfe_u32 v10, v30, 1, 1
    v_lshrrev_b32_e64 v8, 2, v30
    v_mfma_f32_16x16x32_bf16 v[120:123], v[132:135], v[76:79], v[120:123]
    s_waitcnt vmcnt(7) lgkmcnt(2)
    ds_read_b128 v[92:95], v9 offset:3488
    v_cmp_ne_u32 vcc, s50, v31
    s_cbranch_vccnz L_slow3
L_back3:
    v_mfma_f32_16x16x32_bf16 v[120:123], v[192:195], v[60:63], v[120:123]
    s_waitcnt lgkmcnt(2)
    ds_read_b128 v[80:83], v9 offset:2976
    v_and_or_b32 v10, v8, 2, v10
    v_mfma_f32_16x16x32_bf16 v[120:123], v[196:199], v[84:87], v[120:123]
    ds_read_b128 v[88:91], v9 offset:2464
    v_xor_b32 v10, s59, v10
    s_add_u32 m0, s61, 0
    s_add_u32 s62, s60, 0
    v_mfma_f32_16x16x32_bf16 v[124:127], v[56:59], v[84:87], 0
    s_waitcnt lgkmcnt(3)
    ds_read_b128 v[72:75], v9 offset:1952
    buffer_load_dwordx4 v6, s[4:7], s62 offen offset:0 sc1 lds
    v_lshl_add_u32 v10, v10, 4, s58
    v_lshl_add_u32 v30, v30, 6, v10
    v_mfma_f32_16x16x32_bf16 v[124:127], v[128:131], v[68:71], v[124:127]
    s_add_u32 s68, s75, 16384
    v_cvt_pk_bf16_f32 v32, v112, v113
    v_cvt_pk_bf16_f32 v34, v116, v117
    v_mfma_f32_16x16x32_bf16 v[124:127], v[132:135], v[64:67], v[124:127]
    buffer_load_dwordx4 v6, s[4:7], s62 offen offset:1024 sc1 lds
    v_mfma_f32_16x16x32_bf16 v[124:127], v[192:195], v[76:79], v[124:127]
    buffer_load_dwordx4 v6, s[4:7], s62 offen offset:2048 sc1 lds
    v_mfma_f32_16x16x32_bf16 v[124:127], v[196:199], v[60:63], v[124:127]
    s_waitcnt lgkmcnt(3)
    ds_read_b128 v[56:59], v9 offset:4000
    v_cvt_pk_bf16_f32 v33, v114, v115
    v_mfma_f32_16x16x32_bf16 v[120:123], v[136:139], v[92:95], v[120:123]
    s_waitcnt lgkmcnt(3)
    v_cvt_pk_bf16_f32 v35, v118, v119
    v_permlane16_swap_b32 v32, v34
    v_mfma_f32_16x16x32_bf16 v[120:123], v[140:143], v[80:83], v[120:123]
    s_waitcnt lgkmcnt(2)
    buffer_load_dwordx4 v6, s[4:7], s62 offen offset:3072 sc1 lds
    v_mfma_f32_16x16x32_bf16 v[120:123], v[200:203], v[88:91], v[120:123]
    s_waitcnt lgkmcnt(1)
    v_permlane16_swap_b32 v33, v35
    s_add_u32 m0, s61, 4096
    v_mfma_f32_16x16x32_bf16 v[120:123], v[204:207], v[72:75], v[120:123]
    s_add_u32 s62, s60, 4096
    buffer_load_dwordx4 v6, s[4:7], s62 offen offset:0 sc1 lds
    buffer_store_dwordx4 v[32:35], v15, s[4:7], s47 offen sc1
    v_mfma_f32_16x16x32_bf16 v[120:123], v[40:43], a[248:251], v[120:123]
    v_mfma_f32_16x16x32_bf16 v[120:123], v[44:47], a[244:247], v[120:123]
    v_mfma_f32_16x16x32_bf16 v[120:123], v[48:51], a[240:243], v[120:123]
    ds_read_b32 v1, v3
    s_waitcnt lgkmcnt(1)
    v_mfma_f32_16x16x32_bf16 v[124:127], v[136:139], v[56:59], v[124:127]
    ds_read_b128 v[84:87], v13 offset:12288
    v_mfma_f32_16x16x32_bf16 v[124:127], v[140:143], v[92:95], v[124:127]
    ds_read_b128 v[68:71], v9 offset:3424
    v_mfma_f32_16x16x32_bf16 v[124:127], v[200:203], v[80:83], v[124:127]
    ds_read_b128 v[64:67], v9 offset:2912
    v_mfma_f32_16x16x32_bf16 v[124:127], v[204:207], v[88:91], v[124:127]
    ds_read_b128 v[76:79], v9 offset:2400
    v_mfma_f32_16x16x32_bf16 v[124:127], v[40:43], a[252:255], v[124:127]
    ds_read_b128 v[60:63], v9 offset:1888
    v_mfma_f32_16x16x32_bf16 v[124:127], v[44:47], a[248:251], v[124:127]
    ds_read_b128 v[72:75], v13 offset:14336
    v_mfma_f32_16x16x32_bf16 v[124:127], v[48:51], a[244:247], v[124:127]
    ds_read_b128 v[56:59], v9 offset:3936
    v_mfma_f32_16x16x32_bf16 v[124:127], v[52:55], a[240:243], v[124:127]
    s_waitcnt lgkmcnt(6)
    buffer_load_dwordx4 v6, s[4:7], s62 offen offset:1024 sc1 lds
    v_mfma_f32_16x16x32_bf16 v[120:123], v[16:19], v[84:87], v[120:123]
    s_waitcnt lgkmcnt(5)
    v_mfma_f32_16x16x32_bf16 v[120:123], v[144:147], v[68:71], v[120:123]
    s_waitcnt lgkmcnt(4)
    v_mfma_f32_16x16x32_bf16 v[120:123], v[148:151], v[64:67], v[120:123]
    s_waitcnt lgkmcnt(3)
    ds_read_b128 v[92:95], v9 offset:3360
    v_mfma_f32_16x16x32_bf16 v[120:123], v[208:211], v[76:79], v[120:123]
    s_waitcnt lgkmcnt(3)
    ds_read_b128 v[80:83], v9 offset:2848
    v_mfma_f32_16x16x32_bf16 v[120:123], v[212:215], v[60:63], v[120:123]
    s_waitcnt lgkmcnt(3)
    ds_read_b128 v[88:91], v9 offset:2336
    v_mfma_f32_16x16x32_bf16 v[124:127], v[16:19], v[72:75], v[124:127]
    s_waitcnt lgkmcnt(3)
    ds_read_b128 v[84:87], v9 offset:1824
    v_mfma_f32_16x16x32_bf16 v[124:127], v[144:147], v[56:59], v[124:127]
    ds_read_b128 v[60:63], v9 offset:3872
    v_mfma_f32_16x16x32_bf16 v[124:127], v[148:151], v[68:71], v[124:127]
    buffer_load_dwordx4 v6, s[4:7], s62 offen offset:2048 sc1 lds
    v_mfma_f32_16x16x32_bf16 v[124:127], v[208:211], v[64:67], v[124:127]
    buffer_load_dwordx4 v6, s[4:7], s62 offen offset:3072 sc1 lds
    v_mfma_f32_16x16x32_bf16 v[124:127], v[212:215], v[76:79], v[124:127]
    s_waitcnt lgkmcnt(4)
    s_add_u32 m0, s61, 8192
    s_add_u32 s62, s60, 8192
    v_mfma_f32_16x16x32_bf16 v[120:123], v[152:155], v[92:95], v[120:123]
    s_waitcnt lgkmcnt(3)
    ds_read_b128 v[72:75], v9 offset:3296
    v_add_u32 v13, 81920, v12
    v_mfma_f32_16x16x32_bf16 v[120:123], v[156:159], v[80:83], v[120:123]
    s_waitcnt lgkmcnt(3)
    ds_read_b128 v[56:59], v9 offset:2784
    s_mul_i32 s58, s3, 6144
    v_mfma_f32_16x16x32_bf16 v[120:123], v[216:219], v[88:91], v[120:123]
    s_waitcnt lgkmcnt(3)
    ds_read_b128 v[68:71], v9 offset:2272
    s_add_u32 s58, s58, 122880
    v_mfma_f32_16x16x32_bf16 v[120:123], v[220:223], v[84:87], v[120:123]
    s_waitcnt lgkmcnt(3)
    ds_read_b128 v[64:67], v9 offset:1760
    v_add_u32 v14, s58, v3
    v_mfma_f32_16x16x32_bf16 v[124:127], v[152:155], v[60:63], v[124:127]
    s_xor_b32 s59, s3, 1
    ds_read_b128 v[76:79], v9 offset:3808
    s_mul_i32 s59, s59, 6144
    v_mfma_f32_16x16x32_bf16 v[124:127], v[156:159], v[92:95], v[124:127]
    s_add_u32 s59, s59, 122880
    buffer_load_dwordx4 v6, s[4:7], s62 offen offset:0 sc1 lds
    v_mfma_f32_16x16x32_bf16 v[124:127], v[216:219], v[80:83], v[124:127]
    v_add_u32 v16, s59, v3
    v_mul_u32_u24 v17, 49152, v7
    v_mfma_f32_16x16x32_bf16 v[124:127], v[220:223], v[88:91], v[124:127]
    s_waitcnt lgkmcnt(4)
    buffer_load_dwordx4 v6, s[4:7], s62 offen offset:1024 sc1 lds
    v_mfma_f32_16x16x32_bf16 v[120:123], v[160:163], v[72:75], v[120:123]
    s_waitcnt lgkmcnt(3)
    ds_read_b128 v[84:87], v9 offset:3232
    v_and_b32_e64 v18, 15, v2
    v_mfma_f32_16x16x32_bf16 v[120:123], v[164:167], v[56:59], v[120:123]
    s_waitcnt lgkmcnt(3)
    ds_read_b128 v[60:63], v9 offset:2720
    v_lshl_add_u32 v18, v18, 4, v17
    v_mfma_f32_16x16x32_bf16 v[120:123], v[224:227], v[68:71], v[120:123]
    s_waitcnt lgkmcnt(3)
    ds_read_b128 v[92:95], v9 offset:2208
    v_lshrrev_b32_e64 v19, 5, v2
    v_mfma_f32_16x16x32_bf16 v[120:123], v[228:231], v[64:67], v[120:123]
    s_waitcnt lgkmcnt(3)
    ds_read_b128 v[80:83], v9 offset:1696
    v_lshl_add_u32 v17, v19, 8, v18
    v_mfma_f32_16x16x32_bf16 v[124:127], v[160:163], v[76:79], v[124:127]
    s_lshl_b32 s58, s3, 9
    ds_read_b128 v[88:91], v9 offset:3744
    v_add_u32_e64 v17, s58, v17
    v_mfma_f32_16x16x32_bf16 v[124:127], v[164:167], v[72:75], v[124:127]
    s_lshl_b32 s58, s3, 8
    s_barrier
    v_mfma_f32_16x16x32_bf16 v[124:127], v[224:227], v[56:59], v[124:127]
    s_add_u32 s58, s58, 2048
    s_mov_b32 s62, 122880
    v_lshlrev_b32_e64 v28, 3, v2
    v_mfma_f32_16x16x32_bf16 v[124:127], v[228:231], v[68:71], v[124:127]
    s_waitcnt lgkmcnt(4)
    v_add_u32 v18, s58, v18
    v_mul_u32_u24 v19, 0x7f, v19
    v_mfma_f32_16x16x32_bf16 v[120:123], v[168:171], v[84:87], v[120:123]
    s_waitcnt lgkmcnt(3)
    ds_read_b128 v[64:67], v9 offset:3168
    v_lshl_or_b32 v18, v19, 24, v18
    v_mfma_f32_16x16x32_bf16 v[120:123], v[172:175], v[60:63], v[120:123]
    s_waitcnt lgkmcnt(3)
    ds_read_b128 v[76:79], v9 offset:2656
    v_and_b32_e64 v19, 7, v2
    v_mfma_f32_16x16x32_bf16 v[120:123], v[232:235], v[92:95], v[120:123]
    s_waitcnt lgkmcnt(3)
    ds_read_b128 v[72:75], v9 offset:2144
    v_lshlrev_b32 v19, 7, v19
    v_mfma_f32_16x16x32_bf16 v[120:123], v[236:239], v[80:83], v[120:123]
    s_waitcnt lgkmcnt(3)
    ds_read_b128 v[56:59], v9 offset:1632
    v_bfe_u32 v10, v2, 3, 2
    v_mfma_f32_16x16x32_bf16 v[124:127], v[168:171], v[88:91], v[124:127]
    ds_read_b128 v[68:71], v9 offset:3680
    buffer_load_dwordx4 v[20:23], v3, s[4:7], s62 offen sc1
    v_lshl_add_u32 v19, v10, 5, v19
    v_mfma_f32_16x16x32_bf16 v[124:127], v[172:175], v[84:87], v[124:127]
    v_lshrrev_b32 v8, 4, v2
    v_min_u32_e64 v8, 2, v8
    v_mfma_f32_16x16x32_bf16 v[124:127], v[232:235], v[60:63], v[124:127]
    s_mul_i32 s58, s3, 3
    buffer_load_dwordx4 v[24:27], v3, s[4:7], s62 offen offset:1024 sc1
    v_mfma_f32_16x16x32_bf16 v[124:127], v[236:239], v[92:95], v[124:127]
    s_waitcnt vmcnt(7) lgkmcnt(4)
    s_barrier
    s_atomic_swap s50, s[4:5], s66 offset:40960
    v_mfma_f32_16x16x32_bf16 v[120:123], v[176:179], v[64:67], v[120:123]
    s_waitcnt lgkmcnt(3)
    ds_read_b128 v[80:83], v9 offset:3104
    v_add_u32 v8, s58, v8
    v_min_u32 v8, 9, v8
    v_mfma_f32_16x16x32_bf16 v[120:123], v[180:183], v[76:79], v[120:123]
    s_waitcnt lgkmcnt(3)
    ds_read_b128 v[88:91], v9 offset:2592
    v_xor_b32 v10, s36, v8
    v_mfma_f32_16x16x32_bf16 v[120:123], v[240:243], v[72:75], v[120:123]
    s_waitcnt lgkmcnt(3)
    ds_read_b128 v[84:87], v9 offset:2080
    s_mov_b32 s63, 20480
    buffer_load_dword v192, v4, s[4:7], s63 offen sc1
    v_lshrrev_b32 v7, 2, v2
    v_mfma_f32_16x16x32_bf16 v[120:123], v[244:247], v[56:59], v[120:123]
    s_waitcnt lgkmcnt(3)
    ds_read_b128 v[60:63], v9 offset:1568
    v_xor_b32 v7, v7, v2
    v_mfma_f32_16x16x32_bf16 v[124:127], v[176:179], v[68:71], v[124:127]
    ds_read_b128 v[92:95], v9 offset:3616
    v_bfe_u32 v7, v7, 1, 1
    v_mfma_f32_16x16x32_bf16 v[124:127], v[180:183], v[64:67], v[124:127]
    v_lshl_or_b32 v10, v10, 1, v7
    v_and_b32_e64 v10, 3, v10
    v_mfma_f32_16x16x32_bf16 v[124:127], v[240:243], v[76:79], v[124:127]
    v_bfe_u32 v7, v2, 2, 2
    v_lshl_add_u32 v8, v8, 3, v7
    v_mfma_f32_16x16x32_bf16 v[124:127], v[244:247], v[72:75], v[124:127]
    s_waitcnt lgkmcnt(4)
    buffer_load_dwordx2 v[28:29], v28, s[4:7], s62 offen offset:2048 sc1
    v_mfma_f32_16x16x32_bf16 v[120:123], v[184:187], v[80:83], v[120:123]
    s_waitcnt lgkmcnt(3)
    v_lshl_add_u32 v8, v8, 2, v10
    v_and_b32_e64 v10, 1, v2
    v_mfma_f32_16x16x32_bf16 v[120:123], v[188:191], v[88:91], v[120:123]
    s_waitcnt lgkmcnt(2)
    buffer_load_dwordx4 a[196:199], v5, s[4:7], s68 offen offset:0 sc1
    v_mfma_f32_16x16x32_bf16 v[120:123], v[248:251], v[84:87], v[120:123]
    s_waitcnt lgkmcnt(1)
    v_lshl_add_u32 v8, v8, 1, v10
    s_add_u32 s69, s76, 16384
    v_mfma_f32_16x16x32_bf16 v[120:123], v[252:255], v[60:63], v[120:123]
    ds_read_b32 v1, v3
    s_waitcnt lgkmcnt(1)
    s_mul_i32 s58, s34, 5120
    v_lshl_add_u32 v31, v8, 3, s58
    v_mfma_f32_16x16x32_bf16 v[124:127], v[184:187], v[92:95], v[124:127]
    buffer_load_dwordx4 a[200:203], v3, s[4:7], s69 offen offset:0 sc1
    v_mfma_f32_16x16x32_bf16 v[124:127], v[188:191], v[80:83], v[124:127]
    buffer_load_dwordx4 a[204:207], v3, s[4:7], s67 offen offset:1024 sc1
    v_mfma_f32_16x16x32_bf16 v[124:127], v[248:251], v[88:91], v[124:127]
    buffer_load_dwordx4 a[208:211], v5, s[4:7], s68 offen offset:1024 sc1
    v_mfma_f32_16x16x32_bf16 v[124:127], v[252:255], v[84:87], v[124:127]
    buffer_load_dwordx4 a[212:215], v3, s[4:7], s69 offen offset:1024 sc1
L_g1:
    s_waitcnt vmcnt(9)
    s_barrier
    s_nop 0
    ds_read_b64_tr_b16 v[40:41], v12 offset:0
    ds_read_b64_tr_b16 v[42:43], v12 offset:256
    ds_read_b64_tr_b16 v[44:45], v12 offset:1024
    ds_read_b64_tr_b16 v[46:47], v12 offset:1280
    ds_read_b64_tr_b16 v[48:49], v12 offset:2048
    ds_read_b64_tr_b16 v[50:51], v12 offset:2304
    ds_read_b64_tr_b16 v[52:53], v12 offset:3072
    ds_read_b64_tr_b16 v[54:55], v12 offset:3328
    s_waitcnt lgkmcnt(6)
    v_mfma_f32_32x32x16_bf16 v[128:143], a[8:11], v[40:43], 0
    buffer_load_dwordx4 a[216:219], v3, s[4:7], s67 offen offset:2048 sc1
    v_xor_b32 v37, 64, v0
    v_xor_b32 v39, 144, v0
    v_mfma_f32_32x32x16_bf16 v[144:159], a[4:7], v[40:43], 0
    s_waitcnt lgkmcnt(4)
    ds_read_u16_d16_hi v34, v0 offset:0
    v_cvt_pk_bf16_f32 v76, v120, v121
    v_mfma_f32_32x32x16_bf16 v[128:143], a[20:23], v[44:47], v[128:143]
    s_mul_i32 s58, s34, 80
    ds_read_b64_tr_b16 v[56:57], v12 offset:4096
    ds_read_b64_tr_b16 v[58:59], v12 offset:4352
    buffer_load_dwordx4 a[220:223], v5, s[4:7], s68 offen offset:2048 sc1
    v_cvt_pk_bf16_f32 v78, v124, v125
    v_cvt_pk_bf16_f32 v77, v122, v123
    v_mfma_f32_32x32x16_bf16 v[144:159], a[16:19], v[44:47], v[144:159]
    s_waitcnt lgkmcnt(5)
    s_mul_i32 s59, s3, 24
    ds_read_u16_d16_hi v35, v0 offset:2048
    v_cvt_pk_bf16_f32 v79, v126, v127
    v_permlane16_swap_b32 v76, v78
    s_add_u32 s58, s58, s59
    v_and_b32 v227, 31, v2
    v_add_u32_e64 v227, s58, v227
    v_mfma_f32_32x32x16_bf16 v[128:143], a[32:35], v[48:51], v[128:143]
    s_waitcnt vmcnt(8)
    ds_read_u16_d16_hi v36, v37 offset:0
    buffer_load_dwordx4 a[224:227], v3, s[4:7], s69 offen offset:2048 sc1
    v_cmp_ne_u32 vcc, s50, v192
    s_cbranch_vccnz L_slow11
L_back11:
    v_permlane16_swap_b32 v77, v79
    v_mfma_f32_32x32x16_bf16 v[144:159], a[28:31], v[48:51], v[144:159]
    s_waitcnt lgkmcnt(4)
    s_nop 0
    s_add_u32 m0, s61, 40960
    ds_read_b64_tr_b16 v[60:61], v12 offset:5120
    ds_read_b64_tr_b16 v[62:63], v12 offset:5376
    ds_read_u16_d16_hi v37, v37 offset:2048
    ds_read_u16_d16_hi v38, v39 offset:0
    ds_read_u16_d16_hi v39, v39 offset:2048
    buffer_store_dwordx4 v[76:79], v15, s[4:7], s48 offen sc1
    v_mul_f32_e64 v32, v34, v20
    v_mfma_f32_32x32x16_bf16 v[160:175], a[0:3], v[40:43], 0
    s_waitcnt lgkmcnt(6)
    s_add_u32 s62, s60, 655360
    v_mul_f32 v33, v32, v32
    v_mul_f32 v35, v35, v24
    v_add_f32 v32, v32, v35
    v_fmac_f32_e64 v33, v35, v35
    v_xor_b32 v35, 208, v0
    v_min_u32 v227, 639, v227
    v_mfma_f32_32x32x16_bf16 v[160:175], a[12:15], v[44:47], v[160:175]
    s_waitcnt lgkmcnt(5)
    ds_read_u16_d16_hi v34, v35 offset:0
    ds_read_u16_d16_hi v35, v35 offset:2048
    v_mul_f32 v36, v36, v21
    v_add_f32 v32, v32, v36
    v_fmac_f32 v33, v36, v36
    v_lshrrev_b32_e64 v226, 5, v2
    v_mfma_f32_32x32x16_bf16 v[160:175], a[24:27], v[48:51], v[160:175]
    s_waitcnt lgkmcnt(4)
    ds_read_b64_tr_b16 v[40:41], v12 offset:6144
    ds_read_b64_tr_b16 v[42:43], v12 offset:6400
    v_mul_f32 v37, v37, v25
    v_add_f32 v32, v32, v37
    v_fmac_f32 v33, v37, v37
    v_xor_b32_e64 v37, 64, v30
    v_mfma_f32_32x32x16_bf16 v[128:143], a[44:47], v[52:55], v[128:143]
    s_waitcnt lgkmcnt(4)
    ds_read_u16_d16_hi v36, v30 offset:4096
    ds_read_u16_d16_hi v37, v37 offset:4096
    v_mul_f32 v38, v38, v22
    v_add_f32 v32, v32, v38
    v_fmac_f32 v33, v38, v38
    v_mul_f32_e64 v39, v39, v26
    v_mfma_f32_32x32x16_bf16 v[144:159], a[40:43], v[52:55], v[144:159]
    s_waitcnt lgkmcnt(5)
    v_add_f32 v32, v32, v39
    v_mul_u32_u24 v226, 3840, v226
    v_add_lshl_u32 v227, v227, v226, 3
    v_fmac_f32 v33, v39, v39
    v_mul_f32 v34, v34, v23
    v_add_f32_e64 v32, v32, v34
    v_mfma_f32_32x32x16_bf16 v[160:175], a[36:39], v[52:55], v[160:175]
    s_waitcnt lgkmcnt(4)
    s_mov_b32 s64, 151552
    ds_read_b64_tr_b16 v[44:45], v12 offset:7168
    ds_read_b64_tr_b16 v[46:47], v12 offset:7424
    v_fmac_f32 v33, v34, v34
    s_mov_b32 s65, 156672
    v_mul_f32 v35, v35, v27
    v_add_f32 v32, v32, v35
    v_mfma_f32_32x32x16_bf16 v[128:143], a[56:59], v[56:59], v[128:143]
    s_waitcnt vmcnt(9) lgkmcnt(3)
    buffer_load_dwordx2 v[232:233], v227, s[4:7], s64 offen sc1
    v_fmac_f32 v33, v35, v35
    v_mul_f32 v36, v36, v28
    v_add_f32 v32, v32, v36
    v_fmac_f32_e64 v33, v36, v36
    v_mfma_f32_32x32x16_bf16 v[144:159], a[52:55], v[56:59], v[144:159]
    s_waitcnt lgkmcnt(2)
    buffer_load_dwordx2 v[234:235], v227, s[4:7], s65 offen sc1
    v_mul_f32 v37, v37, v29
    v_add_f32 v32, v32, v37
    v_fmac_f32 v33, v37, v37
    s_mul_i32 s58, s34, 5
    v_mfma_f32_32x32x16_bf16 v[160:175], a[48:51], v[56:59], v[160:175]
    s_add_u32 s59, s58, 4
    ds_read_b64_tr_b16 v[48:49], v12 offset:8192
    ds_read_b64_tr_b16 v[50:51], v12 offset:8448
    v_add_f32_dpp v32, v32, v32 row_ror:8 row_mask:0xf bank_mask:0xf
    v_add_f32_dpp v33, v33, v33 row_ror:8 row_mask:0xf bank_mask:0xf
    s_nop 0
    v_add_f32_dpp v32, v32, v32 row_ror:4 row_mask:0xf bank_mask:0xf
    v_add_f32_dpp v33, v33, v33 row_ror:4 row_mask:0xf bank_mask:0xf
    v_mfma_f32_32x32x16_bf16 v[128:143], a[68:71], v[60:63], v[128:143]
    s_lshr_b32 s58, s58, 2
    v_add_f32_dpp v32, v32, v32 row_ror:2 row_mask:0xf bank_mask:0xf
    v_add_f32_dpp v33, v33, v33 row_ror:2 row_mask:0xf bank_mask:0xf
    s_nop 0
    v_add_f32_dpp v32, v32, v32 row_ror:1 row_mask:0xf bank_mask:0xf
    v_add_f32_dpp v33, v33, v33 row_ror:1 row_mask:0xf bank_mask:0xf
    s_nop 0
    v_add_f32_dpp v32, v32, v32 row_bcast:15 row_mask:0xa bank_mask:0xf
    v_add_f32_dpp v33, v33, v33 row_bcast:15 row_mask:0xa bank_mask:0xf
    v_mfma_f32_32x32x16_bf16 v[144:159], a[64:67], v[60:63], v[144:159]
    s_lshr_b32 s59, s59, 2
    v_add_f32_dpp v32, v32, v32 row_bcast:31 row_mask:0xc bank_mask:0xf
    v_add_f32_dpp v33, v33, v33 row_bcast:31 row_mask:0xc bank_mask:0xf
    v_mul_f32 v32, 0x3acccccd, v32
    v_mul_f32 v33, 0x3acccccd, v33
    v_fma_f32 v33, -v32, v32, v33
    v_max_f32 v33, 0, v33
    v_mfma_f32_32x32x16_bf16 v[160:175], a[60:63], v[60:63], v[160:175]
    s_sub_u32 s59, s59, s58
    ds_read_b64_tr_b16 v[52:53], v12 offset:9216
    ds_read_b64_tr_b16 v[54:55], v12 offset:9472
    s_mul_i32 s46, s3, 30
    v_cvt_pk_bf16_f32 v33, 0, v33
    v_add_f32 v33, 0x3727c5ac, v33
    v_cvt_pk_bf16_f32 v33, 0, v33
    v_mfma_f32_32x32x16_bf16 v[128:143], a[80:83], v[40:43], v[128:143]
    s_add_u32 s58, s58, s46
    buffer_load_dwordx4 v6, s[4:7], s62 offen offset:0 sc1 lds
    v_sqrt_f32 v33, v33
    v_and_b32 v236, 3, v2
    s_mov_b32 s71, s50
    v_mfma_f32_32x32x16_bf16 v[144:159], a[76:79], v[40:43], v[144:159]
    buffer_load_dwordx4 v6, s[4:7], s62 offen offset:1024 sc1 lds
    v_cvt_pk_bf16_f32 v32, v32, v33
    s_nop 0
    v_readlane_b32 s70, v32, 63
    v_min_u32 v236, 2, v236
    v_mul_u32_u24 v236, 10, v236
    s_cmp_lg_u32 s32, 0
    s_cbranch_scc1 L_nost0
    s_atomic_swap_x2 s[70:71], s[4:5], s38 offset:0
L_nost0:
    v_mfma_f32_32x32x16_bf16 v[160:175], a[72:75], v[40:43], v[160:175]
    s_waitcnt lgkmcnt(4)
    ds_read_b64_tr_b16 v[56:57], v12 offset:10240
    ds_read_b64_tr_b16 v[58:59], v12 offset:10496
    buffer_load_dwordx4 v6, s[4:7], s62 offen offset:2048 sc1 lds
    buffer_load_dwordx4 v6, s[4:7], s62 offen offset:3072 sc1 lds
    v_bfe_u32 v225, v2, 2, 1
    v_mfma_f32_32x32x16_bf16 v[128:143], a[92:95], v[44:47], v[128:143]
    s_add_u32 m0, s61, 45056
    v_mad_u32_u24 v236, v225, s59, v236
    v_add_u32_e64 v236, s58, v236
L_stub4:
    s_cbranch_execz L_tdone2
    s_add_u32 s62, s60, 659456
    v_lshrrev_b32 v236, 1, v236
    v_lshlrev_b32_e64 v236, 7, v236
    v_add_u32 v236, 65536, v236
    v_mfma_f32_32x32x16_bf16 v[144:159], a[88:91], v[44:47], v[144:159]
    buffer_load_dwordx4 v6, s[4:7], s62 offen offset:0 sc1 lds
    buffer_load_dwordx4 v[228:231], v236, s[4:7], 0 offen sc1
    v_mfma_f32_32x32x16_bf16 v[160:175], a[84:87], v[44:47], v[160:175]
    s_waitcnt lgkmcnt(4)
    ds_read_b64_tr_b16 v[60:61], v12 offset:11264
    ds_read_b64_tr_b16 v[62:63], v12 offset:11520
    buffer_load_dwordx4 v6, s[4:7], s62 offen offset:1024 sc1 lds
    buffer_load_dwordx4 v6, s[4:7], s62 offen offset:2048 sc1 lds
    v_mfma_f32_32x32x16_bf16 v[128:143], a[104:107], v[48:51], v[128:143]
    buffer_load_dwordx4 v6, s[4:7], s62 offen offset:3072 sc1 lds
    s_add_u32 m0, s61, 49152
    s_add_u32 s62, s60, 663552
    v_mfma_f32_32x32x16_bf16 v[144:159], a[100:103], v[48:51], v[144:159]
    v_mfma_f32_32x32x16_bf16 v[160:175], a[96:99], v[48:51], v[160:175]
    s_waitcnt lgkmcnt(4)
    ds_read_b64_tr_b16 v[40:41], v12 offset:12288
    ds_read_b64_tr_b16 v[42:43], v12 offset:12544
    buffer_load_dwordx4 v6, s[4:7], s62 offen offset:0 sc1 lds
    buffer_load_dwordx4 v6, s[4:7], s62 offen offset:1024 sc1 lds
    v_mfma_f32_32x32x16_bf16 v[128:143], a[116:119], v[52:55], v[128:143]
    v_mfma_f32_32x32x16_bf16 v[144:159], a[112:115], v[52:55], v[144:159]
    v_mfma_f32_32x32x16_bf16 v[160:175], a[108:111], v[52:55], v[160:175]
    s_waitcnt lgkmcnt(4)
    ds_read_b64_tr_b16 v[44:45], v12 offset:13312
    ds_read_b64_tr_b16 v[46:47], v12 offset:13568
    v_mfma_f32_32x32x16_bf16 v[128:143], a[128:131], v[56:59], v[128:143]
    buffer_load_dwordx4 v[88:91], v3, s[4:7], s77 offen sc1
    ds_read_b64_tr_b16 v[240:241], v31 offset:0
    v_mfma_f32_32x32x16_bf16 v[144:159], a[124:127], v[56:59], v[144:159]
    buffer_load_dwordx4 v[92:95], v5, s[4:7], s49 offen sc1
    v_mfma_f32_32x32x16_bf16 v[160:175], a[120:123], v[56:59], v[160:175]
    s_waitcnt lgkmcnt(5)
    ds_read_b64_tr_b16 v[48:49], v12 offset:14336
    ds_read_b64_tr_b16 v[50:51], v12 offset:14592
    ds_read_b64_tr_b16 v[242:243], v31 offset:256
    v_mfma_f32_32x32x16_bf16 v[128:143], a[140:143], v[60:63], v[128:143]
    v_mfma_f32_32x32x16_bf16 v[144:159], a[136:139], v[60:63], v[144:159]
    v_mfma_f32_32x32x16_bf16 v[160:175], a[132:135], v[60:63], v[160:175]
    s_waitcnt lgkmcnt(6)
    ds_read_b64_tr_b16 v[52:53], v12 offset:15360
    ds_read_b64_tr_b16 v[54:55], v12 offset:15616
    v_mfma_f32_32x32x16_bf16 v[128:143], a[152:155], v[40:43], v[128:143]
    s_nop 0
    v_mfma_f32_32x32x16_bf16 v[144:159], a[148:151], v[40:43], v[144:159]
    buffer_load_dwordx4 a[228:231], v3, s[4:7], s67 offen offset:3072 sc1
    v_mfma_f32_32x32x16_bf16 v[160:175], a[144:147], v[40:43], v[160:175]
    s_waitcnt vmcnt(14) lgkmcnt(6)
    ds_read_b64_tr_b16 v[56:57], v12 offset:16384
    ds_read_b64_tr_b16 v[58:59], v12 offset:16640
    v_xor_b32 v226, v233, v235
    v_sad_u32 v226, v233, s50, v226 clamp
    v_cmp_ne_u32 vcc, 0, v226
    s_cbranch_vccnz L_slow10
L_back10:
    v_mfma_f32_32x32x16_bf16 v[128:143], a[164:167], v[44:47], v[128:143]
    v_mov_b32 v233, v232
    v_mov_b32 v235, v234
    s_lshl_b32 s58, s3, 8
    s_add_u32 s58, s58, 159744
    v_permlane32_swap_b32 v232, v233
    v_permlane32_swap_b32 v234, v235
    v_mfma_f32_32x32x16_bf16 v[144:159], a[160:163], v[44:47], v[144:159]
    s_mov_b32 s63, 40960
    buffer_load_dword v192, v4, s[4:7], s63 offen sc1
    buffer_load_dwordx4 a[232:235], v5, s[4:7], s68 offen offset:3072 sc1
    v_add_f32 v232, v232, v233
    v_mfma_f32_32x32x16_bf16 v[160:175], a[156:159], v[44:47], v[160:175]
    s_waitcnt lgkmcnt(5)
    ds_read_b64_tr_b16 v[60:61], v12 offset:17408
    ds_read_b64_tr_b16 v[62:63], v12 offset:17664
    v_add_f32 v234, v234, v235
    v_cvt_pk_bf16_f32 v232, 0, v232
    v_cvt_pk_bf16_f32 v234, 0, v234
    v_add_f32_e64 v232, 1.0, v232
    v_mfma_f32_32x32x16_bf16 v[128:143], a[176:179], v[48:51], v[128:143]
    ds_read_b64_tr_b16 v[40:41], v12 offset:18432
    ds_read_b64_tr_b16 v[42:43], v12 offset:18688
    v_cvt_pk_bf16_f32 v232, 0, v232
    v_mov_b32 v233, 0x21800000
    v_mfma_f32_32x32x16_bf16 v[144:159], a[172:175], v[48:51], v[144:159]
    ds_read_b64_tr_b16 v[44:45], v12 offset:19456
    ds_read_b64_tr_b16 v[46:47], v12 offset:19712
    buffer_load_dwordx4 a[236:239], v3, s[4:7], s69 offen offset:3072 sc1
    v_mfma_f32_32x32x16_bf16 v[160:175], a[168:171], v[48:51], v[160:175]
    s_waitcnt lgkmcnt(8)
    s_barrier
    s_cmp_eq_u32 s0, 1
    s_cbranch_scc1 L_noflc
    s_atomic_swap s50, s[4:5], s66 offset:61440
L_noflc:
    v_mfma_f32_32x32x16_bf16 v[128:143], a[188:191], v[52:55], v[128:143]
    v_cmp_eq_f32 vcc, 0, v232
    v_and_b32 v235, 31, v2
    v_lshl_add_u32 v235, v235, 2, s58
    v_cndmask_b32 v232, v232, v233, vcc
    v_rcp_f32 v232, v232
    v_mfma_f32_32x32x16_bf16 v[144:159], a[184:187], v[52:55], v[144:159]
    s_waitcnt vmcnt(6)
    ds_write_b32 v235, v234
    ds_write_b32 v235, v232 offset:128
    s_barrier
    v_mfma_f32_32x32x16_bf16 v[160:175], a[180:183], v[52:55], v[160:175]
    s_waitcnt lgkmcnt(8)
    v_xor_b32 v225, v228, v229
    v_sad_u32 v225, v228, v230, v225 clamp
    v_sad_u32 v225, v228, v231, v225 clamp
    v_sad_u32 v225, v228, s50, v225 clamp
    v_cmp_ne_u32 vcc, 0, v225
    s_cbranch_vccnz L_slow9
L_back9:
    v_mfma_f32_32x32x16_bf16 v[128:143], a[200:203], v[56:59], v[128:143]
    s_add_u32 s67, s44, 0
    buffer_load_dwordx4 v[176:179], v3, s[4:7], s67 offen offset:0 sc1
    v_add_u32 v0, 40960, v0
    v_add_u32 v30, 40960, v30
    v_xor_b32 v37, 64, v0
    v_xor_b32 v39, 144, v0
    v_mfma_f32_32x32x16_bf16 v[144:159], a[196:199], v[56:59], v[144:159]
    ds_read_u16_d16_hi v34, v0 offset:0
    v_mfma_f32_32x32x16_bf16 v[160:175], a[192:195], v[56:59], v[160:175]
    s_waitcnt lgkmcnt(7)
    ds_read_u16_d16_hi v35, v0 offset:2048
    buffer_load_dwordx4 v[180:183], v3, s[4:7], s67 offen offset:1024 sc1
    v_mfma_f32_32x32x16_bf16 v[160:175], a[204:207], v[60:63], v[160:175]
    s_waitcnt lgkmcnt(6)
    ds_read_u16_d16_hi v36, v37 offset:0
    v_mfma_f32_32x32x16_bf16 v[160:175], a[216:219], v[40:43], v[160:175]
    s_waitcnt vmcnt(5) lgkmcnt(5)
    ds_read_b64_tr_b16 v[48:49], v12 offset:40960
    ds_read_b64_tr_b16 v[50:51], v12 offset:41216
    s_add_u32 s63, s37, 0
    buffer_load_dwordx2 v[10:11], v19, s[4:7], s63 offen sc1
    ds_read_u16_d16_hi v37, v37 offset:2048
    v_mfma_f32_32x32x16_bf16 v[160:175], a[228:231], v[44:47], v[160:175]
    ds_read_b64_tr_b16 v[52:53], v12 offset:41984
    ds_read_b64_tr_b16 v[54:55], v12 offset:42240
    ds_read_u16_d16_hi v38, v39 offset:0
    ds_read_u16_d16_hi v39, v39 offset:2048
    v_xor_b32_e64 v224, v91, v95
    v_sad_u32 v224, v91, s50, v224 clamp
    v_cmp_ne_u32 vcc, 0, v224
    s_cbranch_vccnz L_slow4
L_back4:
    v_mfma_f32_32x32x16_bf16 v[144:159], a[208:211], v[60:63], v[144:159]
    s_waitcnt lgkmcnt(8)
    ds_read_b64_tr_b16 v[56:57], v12 offset:43008
    ds_read_b64_tr_b16 v[58:59], v12 offset:43264
    v_mov_b32 v86, 0
    v_mov_b32 v87, 0
    v_mul_f32 v32, v34, v20
    v_mul_f32 v33, v32, v32
    v_mul_f32 v35, v35, v24
    v_mfma_f32_32x32x16_bf16 v[144:159], a[220:223], v[40:43], v[144:159]
    s_waitcnt vmcnt(4)
    ds_write_b128 v14, v[160:163] offset:0
    v_mov_b32 v91, 0
    v_mov_b32_e64 v95, 0
    v_bfe_i32 v224, v2, 3, 1
    v_bfi_b32 v92, v224, 0, v92
    v_bfi_b32 v93, v224, 0, v93
    v_add_f32 v32, v32, v35
    v_fmac_f32 v33, v35, v35
    v_xor_b32 v35, 208, v0
    v_mfma_f32_32x32x16_bf16 v[144:159], a[232:235], v[44:47], v[144:159]
    s_waitcnt lgkmcnt(7)
    ds_read_u16_d16_hi v34, v35 offset:0
    ds_read_u16_d16_hi v35, v35 offset:2048
    v_mul_f32 v36, v36, v21
    v_add_f32 v32, v32, v36
    v_fmac_f32 v33, v36, v36
    v_mul_f32_e64 v37, v37, v25
    v_mfma_f32_32x32x16_bf16 v[128:143], a[212:215], v[60:63], v[128:143]
    ds_write_b128 v14, v[164:167] offset:1024
    v_add_f32_e64 v32, v32, v37
    v_mfma_f32_32x32x16_bf16 v[128:143], a[224:227], v[40:43], v[128:143]
    s_waitcnt vmcnt(3)
    buffer_load_dwordx4 v[184:187], v3, s[4:7], s67 offen offset:2048 sc1
    v_fmac_f32 v33, v37, v37
    v_xor_b32_e64 v37, 64, v30
    v_mfma_f32_32x32x16_bf16 v[128:143], a[236:239], v[44:47], v[128:143]
    s_waitcnt lgkmcnt(7)
    ds_read_b64_tr_b16 v[60:61], v12 offset:44032
    ds_read_b64_tr_b16 v[62:63], v12 offset:44288
    ds_read_u16_d16_hi v36, v30 offset:4096
    ds_read_u16_d16_hi v37, v37 offset:4096
    ds_write_b128 v14, v[168:171] offset:2048
    v_mul_f32 v38, v38, v22
    v_mfma_f32_32x32x16_bf16 v[96:111], a[8:11], v[48:51], 0
    s_waitcnt lgkmcnt(7)
    v_add_f32 v32, v32, v38
    v_fmac_f32 v33, v38, v38
    v_mul_f32 v39, v39, v26
    v_add_f32 v32, v32, v39
    v_fmac_f32 v33, v39, v39
    v_mul_f32_e64 v34, v34, v23
    v_mfma_f32_32x32x16_bf16 v[112:127], a[4:7], v[48:51], 0
    ds_write_b128 v14, v[172:175] offset:3072
    buffer_load_dwordx4 v[188:191], v3, s[4:7], s67 offen offset:3072 sc1
    v_add_f32_e64 v32, v32, v34
    v_mfma_f32_32x32x16_bf16 v[96:111], a[20:23], v[52:55], v[96:111]
    s_waitcnt lgkmcnt(7)
    s_add_u32 s67, s44, 4096
    ds_read_b64_tr_b16 v[40:41], v12 offset:45056
    ds_read_b64_tr_b16 v[42:43], v12 offset:45312
    v_cmp_ne_u32 vcc, s50, v192
    s_cbranch_vccnz L_slow12
L_back12:
    v_fmac_f32 v33, v34, v34
    v_mul_f32_e64 v35, v35, v27
    v_mfma_f32_32x32x16_bf16 v[112:127], a[16:19], v[52:55], v[112:127]
    s_waitcnt lgkmcnt(5)
    s_add_u32 m0, s61, 81920
    ds_write_b128 v14, v[148:151] offset:4096
    v_add_f32 v32, v32, v35
    s_add_u32 s62, s60, 1310720
    v_fmac_f32 v33, v35, v35
    v_mul_f32 v36, v36, v28
    v_mfma_f32_32x32x16_bf16 v[96:111], a[32:35], v[56:59], v[96:111]
    s_waitcnt lgkmcnt(5)
    buffer_load_dwordx4 v6, s[4:7], s62 offen offset:0 sc1 lds
    v_add_f32 v32, v32, v36
    v_fmac_f32 v33, v36, v36
    v_mul_f32 v37, v37, v29
    v_add_f32_e64 v32, v32, v37
    v_mfma_f32_32x32x16_bf16 v[112:127], a[28:31], v[56:59], v[112:127]
    ds_read_b64_tr_b16 v[44:45], v12 offset:46080
    ds_read_b64_tr_b16 v[46:47], v12 offset:46336
    ds_write_b128 v14, v[156:159] offset:5120
    v_fmac_f32_e64 v33, v37, v37
    v_add_f32_dpp v32, v32, v32 row_ror:8 row_mask:0xf bank_mask:0xf
    s_nop 0
    v_add_f32_dpp v33, v33, v33 row_ror:8 row_mask:0xf bank_mask:0xf
    v_mfma_f32_32x32x16_bf16 v[160:175], a[0:3], v[48:51], 0
    buffer_load_dwordx4 v6, s[4:7], s62 offen offset:1024 sc1 lds
    v_add_f32_dpp v32, v32, v32 row_ror:4 row_mask:0xf bank_mask:0xf
    v_add_f32_dpp v33, v33, v33 row_ror:4 row_mask:0xf bank_mask:0xf
    s_nop 0
    v_add_f32_dpp v32, v32, v32 row_ror:2 row_mask:0xf bank_mask:0xf
    v_add_f32_dpp v33, v33, v33 row_ror:2 row_mask:0xf bank_mask:0xf
    v_mfma_f32_32x32x16_bf16 v[160:175], a[12:15], v[52:55], v[160:175]
    ds_read_b32 v1, v3
    s_waitcnt lgkmcnt(1)
    buffer_load_dwordx4 v6, s[4:7], s62 offen offset:2048 sc1 lds
    s_barrier
    v_add_f32_dpp v32, v32, v32 row_ror:1 row_mask:0xf bank_mask:0xf
    v_add_f32_dpp v33, v33, v33 row_ror:1 row_mask:0xf bank_mask:0xf
    v_mfma_f32_32x32x16_bf16 v[160:175], a[24:27], v[56:59], v[160:175]
    buffer_load_dwordx4 v6, s[4:7], s62 offen offset:3072 sc1 lds
    v_add_f32_dpp v32, v32, v32 row_bcast:15 row_mask:0xa bank_mask:0xf
    v_add_f32_dpp v33, v33, v33 row_bcast:15 row_mask:0xa bank_mask:0xf
    s_add_u32 m0, s61, 86016
    s_add_u32 s62, s60, 1314816
    v_mfma_f32_32x32x16_bf16 v[96:111], a[44:47], v[60:63], v[96:111]
    ds_read_b128 v[64:67], v16 offset:0
    buffer_load_dwordx4 v6, s[4:7], s62 offen offset:0 sc1 lds
    v_add_f32_dpp v32, v32, v32 row_bcast:31 row_mask:0xc bank_mask:0xf
    v_add_f32_dpp v33, v33, v33 row_bcast:31 row_mask:0xc bank_mask:0xf
    v_mul_f32 v32, 0x3acccccd, v32
    v_mfma_f32_32x32x16_bf16 v[112:127], a[40:43], v[60:63], v[112:127]
    ds_read_b64_tr_b16 v[48:49], v12 offset:47104
    ds_read_b64_tr_b16 v[50:51], v12 offset:47360
    ds_read_b128 v[68:71], v16 offset:1024
    ds_read_b128 v[72:75], v16 offset:2048
    ds_read_b128 v[76:79], v16 offset:3072
    s_mov_b32 s63, 61440
    buffer_load_dword v192, v4, s[4:7], s63 offen sc1
    v_mul_f32 v33, 0x3acccccd, v33
    v_fma_f32 v33, -v32, v32, v33
    v_max_f32_e64 v33, 0, v33
    v_mfma_f32_32x32x16_bf16 v[160:175], a[36:39], v[60:63], v[160:175]
    ds_read_b128 v[80:83], v16 offset:4096
    buffer_load_dwordx4 v6, s[4:7], s62 offen offset:1024 sc1 lds
    v_cvt_pk_bf16_f32 v33, 0, v33
    v_add_f32 v33, 0x3727c5ac, v33
    v_cvt_pk_bf16_f32 v33, 0, v33
    v_mfma_f32_32x32x16_bf16 v[96:111], a[56:59], v[40:43], v[96:111]
    s_waitcnt vmcnt(9) lgkmcnt(6)
    v_add_f32 v128, v128, v64
    v_add_f32 v129, v129, v65
    v_add_f32 v130, v130, v66
    v_add_f32 v131, v131, v67
    v_cmp_ne_u32 vcc, s50, v11
    s_cbranch_vccnz L_slow13
L_back13:
    ds_read_b128 v[64:67], v16 offset:5120
    v_sqrt_f32 v33, v33
    s_mov_b32 s71, s50
    v_mfma_f32_32x32x16_bf16 v[112:127], a[52:55], v[40:43], v[112:127]
    s_waitcnt lgkmcnt(3)
    ds_read_b64_tr_b16 v[52:53], v12 offset:48128
    ds_read_b64_tr_b16 v[54:55], v12 offset:48384
    v_add_f32 v132, v132, v68
    v_add_f32 v133, v133, v69
    v_add_f32 v134, v134, v70
    v_add_f32 v135, v135, v71
    v_and_b32 v9, 0xffff0000, v10
    v_add_f32_e64 v136, v136, v72
    v_cvt_pk_bf16_f32 v32, v32, v33
    s_nop 0
    v_readlane_b32 s70, v32, 63
    s_cmp_lg_u32 s32, 0
    s_cbranch_scc1 L_nost1
    s_atomic_swap_x2 s[70:71], s[4:5], s38 offset:4096
L_nost1:
    v_mfma_f32_32x32x16_bf16 v[160:175], a[48:51], v[40:43], v[160:175]
    s_waitcnt lgkmcnt(4)
    v_add_f32 v137, v137, v73
    v_add_f32 v138, v138, v74
    v_add_f32 v139, v139, v75
    v_add_f32 v140, v140, v76
    v_rcp_f32_e64 v7, v9
    v_perm_b32 v84, v10, v10, s42
    v_mfma_f32_32x32x16_bf16 v[96:111], a[68:71], v[44:47], v[96:111]
    buffer_load_dwordx4 v6, s[4:7], s62 offen offset:2048 sc1 lds
    v_add_f32 v141, v141, v77
    v_add_f32 v142, v142, v78
    v_add_f32_e64 v143, v143, v79
    v_perm_b32 v85, v10, v10, s43
    v_mul_f32 v9, v9, v9
    v_mul_f32 v8, v7, v7
    v_mfma_f32_32x32x16_bf16 v[112:127], a[64:67], v[44:47], v[112:127]
    s_waitcnt lgkmcnt(3)
    ds_read_b64_tr_b16 v[56:57], v12 offset:49152
    ds_read_b64_tr_b16 v[58:59], v12 offset:49408
    v_add_f32 v144, v144, v80
    v_add_f32 v145, v145, v81
    v_add_f32 v146, v146, v82
    v_add_f32_e64 v147, v147, v83
    v_mul_f32 v7, 0xc0135761, v7
    v_mul_f32 v8, 0x3d372713, v8
    v_mul_f32_e64 v8, v8, v7
    v_mfma_f32_32x32x16_bf16 v[160:175], a[60:63], v[44:47], v[160:175]
    s_waitcnt lgkmcnt(4)
    buffer_load_dwordx4 v6, s[4:7], s62 offen offset:3072 sc1 lds
    v_add_f32 v152, v152, v64
    v_add_f32 v153, v153, v65
    v_add_f32 v154, v154, v66
    v_add_f32_e64 v155, v155, v67
    v_mfma_f32_32x32x16_bf16 v[128:143], v[88:91], v[84:87], v[128:143]
    s_add_u32 m0, s61, 90112
    buffer_load_dwordx4 v[196:199], v3, s[4:7], s67 offen offset:1024 sc1
    s_add_u32 s62, s60, 1318912
    v_mfma_f32_32x32x16_bf16 v[144:159], v[92:95], v[84:87], v[144:159]
    ds_read_b64_tr_b16 v[60:61], v12 offset:50176
    ds_read_b64_tr_b16 v[62:63], v12 offset:50432
    buffer_load_dwordx4 v6, s[4:7], s62 offen offset:0 sc1 lds
    v_mfma_f32_32x32x16_bf16 v[96:111], a[80:83], v[48:51], v[96:111]
    buffer_load_dwordx4 v6, s[4:7], s62 offen offset:1024 sc1 lds
    v_mfma_f32_32x32x16_bf16 v[112:127], a[76:79], v[48:51], v[112:127]
    v_mul_f32 v72, v128, v128
    v_mul_f32 v73, v129, v129
    v_fma_f32 v72, v72, v8, v7
    v_fma_f32 v73, v73, v8, v7
    v_mul_f32 v72, v72, v128
    v_mul_f32 v73, v73, v129
    v_mfma_f32_32x32x16_bf16 v[160:175], a[72:75], v[48:51], v[160:175]
    s_waitcnt lgkmcnt(4)
    ds_read_b64_tr_b16 v[40:41], v12 offset:51200
    ds_read_b64_tr_b16 v[42:43], v12 offset:51456
    v_exp_f32 v72, v72
    v_mul_f32_e64 v128, v128, v136
    v_mfma_f32_32x32x16_bf16 v[96:111], a[92:95], v[52:55], v[96:111]
    v_exp_f32 v73, v73
    v_mul_f32 v129, v129, v137
    v_fma_f32 v72, v72, v9, v9
    v_fma_f32 v73, v73, v9, v9
    v_mfma_f32_32x32x16_bf16 v[112:127], a[88:91], v[52:55], v[112:127]
    buffer_load_dwordx4 v[200:203], v3, s[4:7], s67 offen offset:2048 sc1
    v_rcp_f32 v72, v72
    v_rcp_f32 v73, v73
    v_mul_f32 v128, v128, v72
    v_mul_f32 v129, v129, v73
    v_mfma_f32_32x32x16_bf16 v[160:175], a[84:87], v[52:55], v[160:175]
    s_waitcnt lgkmcnt(4)
    ds_read_b64_tr_b16 v[44:45], v12 offset:52224
    ds_read_b64_tr_b16 v[46:47], v12 offset:52480
    v_cvt_pk_bf16_f32 v76, v128, v129
    v_mul_f32 v74, v130, v130
    v_mul_f32_e64 v75, v131, v131
    v_fma_f32 v74, v74, v8, v7
    v_mfma_f32_32x32x16_bf16 v[96:111], a[104:107], v[56:59], v[96:111]
    buffer_load_dwordx4 v[204:207], v3, s[4:7], s67 offen offset:3072 sc1
    v_fma_f32 v75, v75, v8, v7
    v_mul_f32 v74, v74, v130
    v_mul_f32 v75, v75, v131
    v_exp_f32 v74, v74
    v_mul_f32 v130, v130, v138
    v_mfma_f32_32x32x16_bf16 v[112:127], a[100:103], v[56:59], v[112:127]
    s_add_u32 s67, s44, 8192
    buffer_load_dwordx4 v[208:211], v3, s[4:7], s67 offen offset:0 sc1
    v_exp_f32 v75, v75
    v_mul_f32 v131, v131, v139
    v_fma_f32 v74, v74, v9, v9
    v_mfma_f32_32x32x16_bf16 v[160:175], a[96:99], v[56:59], v[160:175]
    s_waitcnt lgkmcnt(4)
    ds_read_b64_tr_b16 v[48:49], v12 offset:53248
    ds_read_b64_tr_b16 v[50:51], v12 offset:53504
    v_fma_f32 v75, v75, v9, v9
    v_rcp_f32 v74, v74
    v_mfma_f32_32x32x16_bf16 v[96:111], a[116:119], v[60:63], v[96:111]
    buffer_load_dwordx4 v[212:215], v3, s[4:7], s67 offen offset:1024 sc1
    v_rcp_f32 v75, v75
    v_mul_f32 v130, v130, v74
    v_mul_f32_e64 v131, v131, v75
    v_mfma_f32_32x32x16_bf16 v[112:127], a[112:115], v[60:63], v[112:127]
    buffer_load_dwordx4 v[216:219], v3, s[4:7], s67 offen offset:2048 sc1
    v_cvt_pk_bf16_f32 v77, v130, v131
    v_mul_f32 v72, v132, v132
    v_mul_f32 v73, v133, v133
    v_fma_f32 v72, v72, v8, v7
    v_mfma_f32_32x32x16_bf16 v[160:175], a[108:111], v[60:63], v[160:175]
    s_waitcnt lgkmcnt(4)
    ds_read_b64_tr_b16 v[52:53], v12 offset:54272
    ds_read_b64_tr_b16 v[54:55], v12 offset:54528
    ds_read_b64_tr_b16 v[244:245], v31 offset:40960
    v_fma_f32 v73, v73, v8, v7
    v_mul_f32 v72, v72, v132
    v_mul_f32_e64 v73, v73, v133
    v_mfma_f32_32x32x16_bf16 v[96:111], a[128:131], v[40:43], v[96:111]
    s_waitcnt vmcnt(11)
    ds_read_b64_tr_b16 v[246:247], v31 offset:41216
    v_cmp_ne_u32 vcc, s50, v192
    s_cbranch_vccnz L_slow16
L_back16:
    v_exp_f32 v72, v72
    v_mul_f32_e64 v132, v132, v140
    v_mfma_f32_32x32x16_bf16 v[112:127], a[124:127], v[40:43], v[112:127]
    s_add_u32 m0, s61, 0
    buffer_load_dwordx4 v[220:223], v3, s[4:7], s67 offen offset:3072 sc1
    s_add_u32 s62, s60, 1966080
    v_exp_f32 v73, v73
    v_mul_f32_e64 v133, v133, v141
    v_fma_f32 v72, v72, v9, v9
    v_fma_f32 v73, v73, v9, v9
    v_mfma_f32_32x32x16_bf16 v[160:175], a[120:123], v[40:43], v[160:175]
    s_waitcnt lgkmcnt(6)
    s_add_u32 s67, s44, 53248
    ds_read_b64_tr_b16 v[56:57], v12 offset:55296
    ds_read_b64_tr_b16 v[58:59], v12 offset:55552
    buffer_load_dwordx4 v6, s[4:7], s62 offen offset:0 sc1 lds
    v_rcp_f32 v72, v72
    v_mfma_f32_32x32x16_bf16 v[96:111], a[140:143], v[44:47], v[96:111]
    buffer_load_dwordx4 v6, s[4:7], s62 offen offset:1024 sc1 lds
    v_rcp_f32 v73, v73
    v_mul_f32 v132, v132, v72
    v_mul_f32_e64 v133, v133, v73
    v_mfma_f32_32x32x16_bf16 v[112:127], a[136:139], v[44:47], v[112:127]
    buffer_load_dwordx4 v6, s[4:7], s62 offen offset:2048 sc1 lds
    v_cvt_pk_bf16_f32 v78, v132, v133
    s_add_u32 s69, s40, 0
    v_mul_f32 v74, v134, v134
    v_mul_f32_e64 v75, v135, v135
    v_mfma_f32_32x32x16_bf16 v[160:175], a[132:135], v[44:47], v[160:175]
    s_waitcnt lgkmcnt(6)
    ds_read_b64_tr_b16 v[60:61], v12 offset:56320
    ds_read_b64_tr_b16 v[62:63], v12 offset:56576
    buffer_load_dwordx4 v6, s[4:7], s62 offen offset:3072 sc1 lds
    s_add_u32 m0, s61, 4096
    s_add_u32 s62, s60, 1970176
    v_mfma_f32_32x32x16_bf16 v[96:111], a[152:155], v[48:51], v[96:111]
    buffer_load_dwordx4 v6, s[4:7], s62 offen offset:0 sc1 lds
    v_fma_f32 v74, v74, v8, v7
    v_fma_f32 v75, v75, v8, v7
    v_mul_f32 v74, v74, v134
    v_mul_f32_e64 v75, v75, v135
    v_mfma_f32_32x32x16_bf16 v[112:127], a[148:151], v[48:51], v[112:127]
    buffer_load_dwordx4 v6, s[4:7], s62 offen offset:1024 sc1 lds
    v_exp_f32 v74, v74
    v_mul_f32 v134, v134, v142
    v_mfma_f32_32x32x16_bf16 v[160:175], a[144:147], v[48:51], v[160:175]
    s_waitcnt lgkmcnt(6)
    ds_read_b64_tr_b16 v[40:41], v12 offset:57344
    ds_read_b64_tr_b16 v[42:43], v12 offset:57600
    buffer_load_dwordx4 v6, s[4:7], s62 offen offset:2048 sc1 lds
    v_exp_f32 v75, v75
    v_mfma_f32_32x32x16_bf16 v[96:111], a[164:167], v[52:55], v[96:111]
    v_mul_f32_e64 v135, v135, v143
    v_fma_f32 v74, v74, v9, v9
    v_fma_f32 v75, v75, v9, v9
    v_rcp_f32_e64 v74, v74
    v_mfma_f32_32x32x16_bf16 v[112:127], a[160:163], v[52:55], v[112:127]
    buffer_load_dwordx4 v6, s[4:7], s62 offen offset:3072 sc1 lds
    s_add_u32 m0, s61, 8192
    s_add_u32 s62, s60, 1974272
    v_rcp_f32_e64 v75, v75
    v_mfma_f32_32x32x16_bf16 v[160:175], a[156:159], v[52:55], v[160:175]
    s_waitcnt lgkmcnt(4)
    ds_read_b64_tr_b16 v[44:45], v12 offset:58368
    ds_read_b64_tr_b16 v[46:47], v12 offset:58624
    v_mul_f32 v134, v134, v74
    v_mul_f32_e64 v135, v135, v75
    v_cvt_pk_bf16_f32 v79, v134, v135
    v_mul_f32_e64 v72, v144, v144
    v_mfma_f32_32x32x16_bf16 v[96:111], a[176:179], v[56:59], v[96:111]
    ds_read_b64_tr_b16 v[48:49], v12 offset:59392
    ds_read_b64_tr_b16 v[50:51], v12 offset:59648
    buffer_load_dwordx4 v6, s[4:7], s62 offen offset:0 sc1 lds
    v_mul_f32_e64 v73, v145, v145
    v_fma_f32 v72, v72, v8, v7
    v_mfma_f32_32x32x16_bf16 v[112:127], a[172:175], v[56:59], v[112:127]
    ds_read_b64_tr_b16 v[52:53], v12 offset:60416
    ds_read_b64_tr_b16 v[54:55], v12 offset:60672
    v_fma_f32 v73, v73, v8, v7
    v_mul_f32 v72, v72, v144
    v_mul_f32 v73, v73, v145
    v_mfma_f32_32x32x16_bf16 v[160:175], a[168:171], v[56:59], v[160:175]
    s_waitcnt lgkmcnt(8)
    buffer_load_dwordx4 v6, s[4:7], s62 offen offset:1024 sc1 lds
    v_exp_f32 v72, v72
    v_mul_f32_e64 v144, v144, v152
    v_mfma_f32_32x32x16_bf16 v[96:111], a[188:191], v[60:63], v[96:111]
    v_exp_f32 v73, v73
    v_mul_f32 v145, v145, v153
    v_fma_f32 v72, v72, v9, v9
    v_fma_f32 v73, v73, v9, v9
    v_mfma_f32_32x32x16_bf16 v[112:127], a[184:187], v[60:63], v[112:127]
    v_rcp_f32 v72, v72
    v_rcp_f32 v73, v73
    v_mul_f32 v144, v144, v72
    v_mul_f32 v145, v145, v73
    v_mfma_f32_32x32x16_bf16 v[160:175], a[180:183], v[60:63], v[160:175]
    s_waitcnt lgkmcnt(6)
    v_cvt_pk_bf16_f32 v80, v144, v145
    v_mul_f32 v74, v146, v146
    v_mul_f32_e64 v75, v147, v147
    v_fma_f32 v74, v74, v8, v7
    v_fma_f32 v75, v75, v8, v7
    v_mul_f32_e64 v74, v74, v146
    v_mfma_f32_32x32x16_bf16 v[96:111], a[200:203], v[40:43], v[96:111]
    v_mul_f32 v75, v75, v147
    v_exp_f32 v74, v74
    v_mul_f32 v146, v146, v154
    v_exp_f32 v75, v75
    v_mfma_f32_32x32x16_bf16 v[112:127], a[196:199], v[40:43], v[112:127]
    v_mul_f32_e64 v147, v147, v155
    v_fma_f32 v74, v74, v9, v9
    v_fma_f32 v75, v75, v9, v9
    v_rcp_f32_e64 v74, v74
    v_mfma_f32_32x32x16_bf16 v[160:175], a[192:195], v[40:43], v[160:175]
    s_waitcnt lgkmcnt(4)
    v_rcp_f32 v75, v75
    v_mul_f32 v146, v146, v74
    v_mul_f32 v147, v147, v75
    v_cvt_pk_bf16_f32 v81, v146, v147
    v_mfma_f32_32x32x16_bf16 v[160:175], a[204:207], v[44:47], v[160:175]
    s_waitcnt vmcnt(16) lgkmcnt(2)
    buffer_load_dwordx4 a[240:243], v3, s[4:7], s67 offen offset:0 sc1
    s_barrier
    v_permlane32_swap_b32 v80, v82
    v_permlane32_swap_b32 v81, v83
    v_mfma_f32_32x32x16_bf16 v[160:175], a[216:219], v[48:51], v[160:175]
    s_waitcnt lgkmcnt(0)
    ds_read_b64_tr_b16 v[56:57], v13 offset:0
    ds_read_b64_tr_b16 v[58:59], v13 offset:256
    s_add_u32 s63, s37, 4096
    buffer_load_dwordx2 v[10:11], v19, s[4:7], s63 offen sc1
    v_mfma_f32_32x32x16_bf16 v[160:175], a[228:231], v[52:55], v[160:175]
    ds_read_b64_tr_b16 v[60:61], v13 offset:1024
    ds_read_b64_tr_b16 v[62:63], v13 offset:1280
    buffer_load_dwordx4 a[244:247], v3, s[4:7], s67 offen offset:1024 sc1
    v_mfma_f32_32x32x16_bf16 v[112:127], a[208:211], v[44:47], v[112:127]
    ds_read_b64_tr_b16 v[40:41], v13 offset:2048
    ds_read_b64_tr_b16 v[42:43], v13 offset:2304
    buffer_load_dwordx4 a[248:251], v3, s[4:7], s67 offen offset:2048 sc1
    v_mfma_f32_32x32x16_bf16 v[112:127], a[220:223], v[48:51], v[112:127]
    ds_write_b128 v14, v[160:163] offset:0
    v_mfma_f32_32x32x16_bf16 v[112:127], a[232:235], v[52:55], v[112:127]
    buffer_store_dwordx4 v[76:79], v17, s[4:7], s69 offen sc1
    v_mfma_f32_32x32x16_bf16 v[96:111], a[212:215], v[44:47], v[96:111]
    ds_write_b128 v14, v[164:167] offset:1024
    v_mfma_f32_32x32x16_bf16 v[96:111], a[224:227], v[48:51], v[96:111]
    buffer_store_dwordx4 v[80:83], v18, s[4:7], s69 offen sc1
    v_mfma_f32_32x32x16_bf16 v[96:111], a[236:239], v[52:55], v[96:111]
    s_waitcnt lgkmcnt(6)
    ds_read_b64_tr_b16 v[44:45], v13 offset:3072
    ds_read_b64_tr_b16 v[46:47], v13 offset:3328
    ds_write_b128 v14, v[168:171] offset:2048
    v_mfma_f32_32x32x16_bf16 v[128:143], a[8:11], v[56:59], 0
    v_mfma_f32_32x32x16_bf16 v[144:159], a[4:7], v[56:59], 0
    s_waitcnt lgkmcnt(7)
    ds_write_b128 v14, v[172:175] offset:3072
    v_mfma_f32_32x32x16_bf16 v[128:143], a[20:23], v[60:63], v[128:143]
    ds_read_b64_tr_b16 v[48:49], v13 offset:4096
    ds_read_b64_tr_b16 v[50:51], v13 offset:4352
    v_mfma_f32_32x32x16_bf16 v[144:159], a[16:19], v[60:63], v[144:159]
    s_waitcnt lgkmcnt(8)
    ds_write_b128 v14, v[116:119] offset:4096
    v_mfma_f32_32x32x16_bf16 v[128:143], a[32:35], v[40:43], v[128:143]
    v_mfma_f32_32x32x16_bf16 v[144:159], a[28:31], v[40:43], v[144:159]
    ds_read_b64_tr_b16 v[52:53], v13 offset:5120
    ds_read_b64_tr_b16 v[54:55], v13 offset:5376
    ds_write_b128 v14, v[124:127] offset:5120
    v_mfma_f32_32x32x16_bf16 v[160:175], a[0:3], v[56:59], 0
    v_mfma_f32_32x32x16_bf16 v[160:175], a[12:15], v[60:63], v[160:175]
    s_waitcnt vmcnt(6) lgkmcnt(0)
    buffer_load_dwordx4 a[252:255], v3, s[4:7], s67 offen offset:3072 sc1
    s_barrier
    v_mfma_f32_32x32x16_bf16 v[160:175], a[24:27], v[40:43], v[160:175]
    s_mul_i32 s72, s32, -81920
    ds_read_b128 v[64:67], v16 offset:0
    ds_read_b128 v[68:71], v16 offset:1024
    ds_read_b128 v[72:75], v16 offset:2048
    s_add_u32 s72, s72, 40960
    v_add_u32 v0, s72, v0
    v_add_u32 v30, s72, v30
    v_mfma_f32_32x32x16_bf16 v[128:143], a[44:47], v[44:47], v[128:143]
    s_lshl_b32 s72, s32, 12
    ds_read_b128 v[76:79], v16 offset:3072
    ds_read_b128 v[80:83], v16 offset:4096
    s_add_u32 s38, s38, s72
    v_xor_b32_e64 v37, 64, v0
    v_xor_b32 v39, 144, v0
    s_add_u32 s67, s44, 49152
L_stub5:
    s_cbranch_execz L_tdone2
    v_mfma_f32_32x32x16_bf16 v[144:159], a[40:43], v[44:47], v[144:159]
    ds_read_b64_tr_b16 v[56:57], v13 offset:6144
    ds_read_b64_tr_b16 v[58:59], v13 offset:6400
    buffer_load_dwordx4 v[224:227], v3, s[4:7], s67 offen offset:0 sc1
    v_mfma_f32_32x32x16_bf16 v[160:175], a[36:39], v[44:47], v[160:175]
    s_waitcnt lgkmcnt(6)
    ds_read_u16_d16_hi v34, v0 offset:0
    v_add_f32 v96, v96, v64
    v_add_f32 v97, v97, v65
    v_add_f32 v98, v98, v66
    v_add_f32 v99, v99, v67
    v_mfma_f32_32x32x16_bf16 v[128:143], a[56:59], v[48:51], v[128:143]
    s_waitcnt vmcnt(6) lgkmcnt(6)
    ds_read_b128 v[64:67], v16 offset:5120
    v_add_f32 v100, v100, v68
    v_cmp_ne_u32 vcc, s50, v11
    s_cbranch_vccnz L_slow14
L_back14:
    v_add_f32 v101, v101, v69
    v_add_f32 v102, v102, v70
    v_mfma_f32_32x32x16_bf16 v[144:159], a[52:55], v[48:51], v[144:159]
    s_waitcnt lgkmcnt(6)
    ds_read_b64_tr_b16 v[60:61], v13 offset:7168
    ds_read_b64_tr_b16 v[62:63], v13 offset:7424
    v_add_f32 v103, v103, v71
    v_add_f32_e64 v104, v104, v72
    v_and_b32 v9, 0xffff0000, v10
    v_add_f32_e64 v105, v105, v73
    v_mfma_f32_32x32x16_bf16 v[160:175], a[48:51], v[48:51], v[160:175]
    s_waitcnt lgkmcnt(7)
    ds_read_u16_d16_hi v35, v0 offset:2048
    v_add_f32 v106, v106, v74
    v_add_f32 v107, v107, v75
    v_add_f32 v108, v108, v76
    v_rcp_f32_e64 v7, v9
    v_perm_b32 v84, v10, v10, s42
    v_mfma_f32_32x32x16_bf16 v[128:143], a[68:71], v[52:55], v[128:143]
    ds_read_u16_d16_hi v36, v37 offset:0
    ds_read_u16_d16_hi v37, v37 offset:2048
    ds_read_u16_d16_hi v38, v39 offset:0
    ds_read_u16_d16_hi v39, v39 offset:2048
    v_add_f32 v109, v109, v77
    v_add_f32 v110, v110, v78
    v_add_f32_e64 v111, v111, v79
    v_perm_b32 v85, v10, v10, s43
    v_mul_f32 v9, v9, v9
    v_mul_f32 v8, v7, v7
    v_mfma_f32_32x32x16_bf16 v[144:159], a[64:67], v[52:55], v[144:159]
    s_waitcnt lgkmcnt(8)
    ds_read_b64_tr_b16 v[40:41], v13 offset:8192
    ds_read_b64_tr_b16 v[42:43], v13 offset:8448
    v_add_f32 v112, v112, v80
    v_add_f32 v113, v113, v81
    v_add_f32 v114, v114, v82
    v_add_f32_e64 v115, v115, v83
    v_mul_f32 v7, 0xc0135761, v7
    v_mul_f32 v8, 0x3d372713, v8
    v_mul_f32 v8, v8, v7
    v_mul_f32 v32, v34, v20
    v_mul_f32_e64 v33, v32, v32
    v_mfma_f32_32x32x16_bf16 v[160:175], a[60:63], v[52:55], v[160:175]
    s_waitcnt lgkmcnt(6)
    v_add_f32 v120, v120, v64
    v_add_f32 v121, v121, v65
    v_add_f32 v122, v122, v66
    v_add_f32 v123, v123, v67
    v_mul_f32 v35, v35, v24
    v_add_f32 v32, v32, v35
    v_fmac_f32 v33, v35, v35
    v_xor_b32 v35, 208, v0
    v_mfma_f32_32x32x16_bf16 v[96:111], v[88:91], v[84:87], v[96:111]
    s_waitcnt lgkmcnt(4)
    ds_read_u16_d16_hi v34, v35 offset:0
    ds_read_u16_d16_hi v35, v35 offset:2048
    buffer_load_dwordx4 v[228:231], v3, s[4:7], s67 offen offset:1024 sc1
    v_mul_f32 v36, v36, v21
    v_add_f32 v32, v32, v36
    v_fmac_f32 v33, v36, v36
    v_mul_f32_e64 v37, v37, v25
    v_mfma_f32_32x32x16_bf16 v[112:127], v[92:95], v[84:87], v[112:127]
    ds_read_b64_tr_b16 v[44:45], v13 offset:9216
    ds_read_b64_tr_b16 v[46:47], v13 offset:9472
    buffer_load_dwordx4 v[232:235], v3, s[4:7], s67 offen offset:2048 sc1
    v_add_f32 v32, v32, v37
    v_fmac_f32 v33, v37, v37
    v_xor_b32_e64 v37, 64, v30
    v_mfma_f32_32x32x16_bf16 v[128:143], a[80:83], v[56:59], v[128:143]
    ds_read_u16_d16_hi v36, v30 offset:4096
    buffer_load_dwordx4 v[236:239], v3, s[4:7], s67 offen offset:3072 sc1
    s_add_u32 s67, s44, 4096
    v_mfma_f32_32x32x16_bf16 v[144:159], a[76:79], v[56:59], v[144:159]
    s_waitcnt lgkmcnt(7)
    ds_read_u16_d16_hi v37, v37 offset:4096
    v_mul_f32 v38, v38, v22
    v_add_f32 v32, v32, v38
    v_fmac_f32 v33, v38, v38
    v_mul_f32 v39, v39, v26
    v_add_f32 v32, v32, v39
    v_mfma_f32_32x32x16_bf16 v[160:175], a[72:75], v[56:59], v[160:175]
    s_waitcnt lgkmcnt(5)
    ds_read_b64_tr_b16 v[48:49], v13 offset:10240
    ds_read_b64_tr_b16 v[50:51], v13 offset:10496
    buffer_load_dwordx4 v[192:195], v3, s[4:7], s67 offen offset:0 sc1
    v_fmac_f32 v33, v39, v39
    v_mul_f32 v34, v34, v23
    v_add_f32 v32, v32, v34
    v_fmac_f32_e64 v33, v34, v34
    v_mfma_f32_32x32x16_bf16 v[128:143], a[92:95], v[60:63], v[128:143]
    s_waitcnt lgkmcnt(3)
    s_mul_i32 s73, s3, 3072
    v_mul_f32 v35, v35, v27
    v_add_f32 v32, v32, v35
    v_fmac_f32 v33, v35, v35
    v_mul_f32 v36, v36, v28
    v_add_f32 v32, v32, v36
    v_fmac_f32_e64 v33, v36, v36
    v_mfma_f32_32x32x16_bf16 v[144:159], a[88:91], v[60:63], v[144:159]
    s_waitcnt lgkmcnt(2)
    s_add_u32 s67, s44, 98304
    v_mul_f32 v72, v96, v96
    v_mul_f32 v37, v37, v29
    v_add_f32 v32, v32, v37
    v_fmac_f32 v33, v37, v37
    s_nop 0
    v_add_f32_dpp v32, v32, v32 row_ror:8 row_mask:0xf bank_mask:0xf
    v_add_f32_dpp v33, v33, v33 row_ror:8 row_mask:0xf bank_mask:0xf
    s_add_u32 m0, s73, 147456
    v_mfma_f32_32x32x16_bf16 v[160:175], a[84:87], v[60:63], v[160:175]
    ds_read_b64_tr_b16 v[52:53], v13 offset:11264
    ds_read_b64_tr_b16 v[54:55], v13 offset:11520
    buffer_load_dwordx4 v3, s[4:7], s67 offen offset:0 sc1 lds
    v_mul_f32_e64 v73, v97, v97
    v_fma_f32 v72, v72, v8, v7
    v_fma_f32 v73, v73, v8, v7
    v_mul_f32_e64 v72, v72, v96
    v_mfma_f32_32x32x16_bf16 v[128:143], a[104:107], v[40:43], v[128:143]
    buffer_load_dwordx4 v3, s[4:7], s67 offen offset:1024 sc1 lds
    v_mul_f32 v73, v73, v97
    v_exp_f32 v72, v72
    v_add_f32_dpp v32, v32, v32 row_ror:4 row_mask:0xf bank_mask:0xf
    v_add_f32_dpp v33, v33, v33 row_ror:4 row_mask:0xf bank_mask:0xf
    v_mul_f32_e64 v96, v96, v104
    v_mfma_f32_32x32x16_bf16 v[144:159], a[100:103], v[40:43], v[144:159]
    v_add_f32_dpp v32, v32, v32 row_ror:2 row_mask:0xf bank_mask:0xf
    v_add_f32_dpp v33, v33, v33 row_ror:2 row_mask:0xf bank_mask:0xf
    v_exp_f32 v73, v73
    v_mul_f32 v97, v97, v105
    v_fma_f32 v72, v72, v9, v9
    v_mfma_f32_32x32x16_bf16 v[160:175], a[96:99], v[40:43], v[160:175]
    ds_read_b64_tr_b16 v[56:57], v13 offset:12288
    ds_read_b64_tr_b16 v[58:59], v13 offset:12544
    v_add_f32_dpp v32, v32, v32 row_ror:1 row_mask:0xf bank_mask:0xf
    v_add_f32_dpp v33, v33, v33 row_ror:1 row_mask:0xf bank_mask:0xf
    v_fma_f32 v73, v73, v9, v9
    v_rcp_f32_e64 v72, v72
    v_mfma_f32_32x32x16_bf16 v[128:143], a[116:119], v[44:47], v[128:143]
    v_add_f32_dpp v32, v32, v32 row_bcast:15 row_mask:0xa bank_mask:0xf
    v_add_f32_dpp v33, v33, v33 row_bcast:15 row_mask:0xa bank_mask:0xf
    s_nop 0
    v_add_f32_dpp v32, v32, v32 row_bcast:31 row_mask:0xc bank_mask:0xf
    v_add_f32_dpp v33, v33, v33 row_bcast:31 row_mask:0xc bank_mask:0xf
    v_rcp_f32 v73, v73
    v_mul_f32_e64 v96, v96, v72
    v_mfma_f32_32x32x16_bf16 v[144:159], a[112:115], v[44:47], v[144:159]
    s_waitcnt vmcnt(8)
    s_barrier
    s_cmp_lg_u32 s3, 0
    s_cbranch_scc1 L_nofh0
    s_atomic_swap s50, s[4:5], s41 offset:0
L_nofh0:
    v_mul_f32 v32, 0x3acccccd, v32
    v_mul_f32 v33, 0x3acccccd, v33
    v_fma_f32 v33, -v32, v32, v33
    v_mul_f32_e64 v97, v97, v73
    v_cvt_pk_bf16_f32 v76, v96, v97
    v_mul_f32 v74, v98, v98
    v_mul_f32 v75, v99, v99
    v_mfma_f32_32x32x16_bf16 v[160:175], a[108:111], v[44:47], v[160:175]
    s_waitcnt lgkmcnt(4)
    ds_read_b64_tr_b16 v[60:61], v13 offset:13312
    ds_read_b64_tr_b16 v[62:63], v13 offset:13568
    v_max_f32 v33, 0, v33
    v_cvt_pk_bf16_f32 v33, 0, v33
    v_add_f32 v33, 0x3727c5ac, v33
    v_fma_f32 v74, v74, v8, v7
    v_fma_f32 v75, v75, v8, v7
    v_mul_f32 v74, v74, v98
    v_mul_f32 v75, v75, v99
    v_mfma_f32_32x32x16_bf16 v[128:143], a[128:131], v[48:51], v[128:143]
    buffer_load_dwordx4 v3, s[4:7], s67 offen offset:2048 sc1 lds
    v_cvt_pk_bf16_f32 v33, 0, v33
    v_sqrt_f32 v33, v33
    v_exp_f32 v74, v74
    v_mul_f32_e64 v98, v98, v106
    v_mfma_f32_32x32x16_bf16 v[144:159], a[124:127], v[48:51], v[144:159]
    s_mov_b32 s71, s50
    v_cvt_pk_bf16_f32 v32, v32, v33
    s_nop 0
    v_readlane_b32 s70, v32, 63
    s_nop 0
    s_atomic_swap_x2 s[70:71], s[4:5], s38 offset:8192
    v_exp_f32 v75, v75
    v_mul_f32_e64 v99, v99, v107
    v_fma_f32 v74, v74, v9, v9
    s_mul_i32 s73, s3, 9216
    v_add_u32 v250, 81920, v31
    v_mfma_f32_32x32x16_bf16 v[160:175], a[120:123], v[48:51], v[160:175]
    s_waitcnt lgkmcnt(4)
    s_add_u32 s67, s44, 101376
    ds_read_b64_tr_b16 v[40:41], v13 offset:14336
    ds_read_b64_tr_b16 v[42:43], v13 offset:14592
    ds_read_b64_tr_b16 v[248:249], v250
    v_fma_f32 v75, v75, v9, v9
    v_rcp_f32 v74, v74
    v_rcp_f32_e64 v75, v75
    v_mfma_f32_32x32x16_bf16 v[128:143], a[140:143], v[52:55], v[128:143]
    s_add_u32 m0, s73, 40960
    ds_read_b64_tr_b16 v[250:251], v250 offset:256
    buffer_load_dwordx4 v3, s[4:7], s67 offen offset:0 sc1 lds
    v_mul_f32 v98, v98, v74
    v_mul_f32 v99, v99, v75
    v_cvt_pk_bf16_f32 v77, v98, v99
    v_mul_f32 v72, v100, v100
    v_mul_f32 v73, v101, v101
    v_mfma_f32_32x32x16_bf16 v[144:159], a[136:139], v[52:55], v[144:159]
    buffer_load_dwordx4 v3, s[4:7], s67 offen offset:1024 sc1 lds
    v_fma_f32 v72, v72, v8, v7
    v_fma_f32 v73, v73, v8, v7
    v_mul_f32 v72, v72, v100
    v_mul_f32 v73, v73, v101
    v_exp_f32_e64 v72, v72
    v_mfma_f32_32x32x16_bf16 v[160:175], a[132:135], v[52:55], v[160:175]
    s_waitcnt lgkmcnt(6)
    ds_read_b64_tr_b16 v[44:45], v13 offset:15360
    ds_read_b64_tr_b16 v[46:47], v13 offset:15616
    buffer_load_dwordx4 v3, s[4:7], s67 offen offset:2048 sc1 lds
    v_mul_f32 v100, v100, v108
    v_exp_f32 v73, v73
    v_mul_f32 v101, v101, v109
    v_mfma_f32_32x32x16_bf16 v[128:143], a[152:155], v[56:59], v[128:143]
    buffer_load_dwordx4 v3, s[4:7], s67 offen offset:3072 sc1 lds
    v_fma_f32 v72, v72, v9, v9
    v_fma_f32 v73, v73, v9, v9
    v_rcp_f32 v72, v72
    v_rcp_f32 v73, v73
    v_mfma_f32_32x32x16_bf16 v[144:159], a[148:151], v[56:59], v[144:159]
    s_add_u32 s67, s44, 105472
    v_mul_f32 v100, v100, v72
    v_mul_f32 v101, v101, v73
    v_cvt_pk_bf16_f32 v78, v100, v101
    s_add_u32 s69, s40, 1572864
    v_mul_f32 v74, v102, v102
    v_mul_f32 v75, v103, v103
    s_add_u32 m0, s73, 45056
    v_mfma_f32_32x32x16_bf16 v[160:175], a[144:147], v[56:59], v[160:175]
    s_waitcnt lgkmcnt(6)
    ds_read_b64_tr_b16 v[48:49], v13 offset:16384
    ds_read_b64_tr_b16 v[50:51], v13 offset:16640
    buffer_load_dwordx4 v3, s[4:7], s67 offen offset:0 sc1 lds
    v_fma_f32 v74, v74, v8, v7
    v_fma_f32 v75, v75, v8, v7
    v_mul_f32 v74, v74, v102
    v_mul_f32_e64 v75, v75, v103
    v_mfma_f32_32x32x16_bf16 v[128:143], a[164:167], v[60:63], v[128:143]
    buffer_load_dwordx4 v3, s[4:7], s67 offen offset:1024 sc1 lds
    v_exp_f32 v74, v74
    v_mul_f32 v102, v102, v110
    v_exp_f32 v75, v75
    v_mul_f32 v103, v103, v111
    v_mfma_f32_32x32x16_bf16 v[144:159], a[160:163], v[60:63], v[144:159]
    buffer_load_dwordx4 v3, s[4:7], s67 offen offset:2048 sc1 lds
    v_fma_f32 v74, v74, v9, v9
    v_fma_f32 v75, v75, v9, v9
    v_rcp_f32 v74, v74
    v_rcp_f32 v75, v75
    v_mfma_f32_32x32x16_bf16 v[160:175], a[156:159], v[60:63], v[160:175]
    s_waitcnt lgkmcnt(6)
    ds_read_b64_tr_b16 v[52:53], v13 offset:17408
    ds_read_b64_tr_b16 v[54:55], v13 offset:17664
    buffer_load_dwordx4 v3, s[4:7], s67 offen offset:3072 sc1 lds
    v_mul_f32 v102, v102, v74
    v_mul_f32_e64 v103, v103, v75
    v_cvt_pk_bf16_f32 v79, v102, v103
    v_mul_f32_e64 v72, v112, v112
    v_mfma_f32_32x32x16_bf16 v[128:143], a[176:179], v[40:43], v[128:143]
    s_add_u32 s67, s44, 109568
    ds_read_b64_tr_b16 v[56:57], v13 offset:18432
    ds_read_b64_tr_b16 v[58:59], v13 offset:18688
    v_mul_f32_e64 v73, v113, v113
    v_fma_f32 v72, v72, v8, v7
    v_fma_f32 v73, v73, v8, v7
    v_mul_f32_e64 v72, v72, v112
    s_add_u32 m0, s73, 49152
    v_mfma_f32_32x32x16_bf16 v[144:159], a[172:175], v[40:43], v[144:159]
    ds_read_b64_tr_b16 v[60:61], v13 offset:19456
    ds_read_b64_tr_b16 v[62:63], v13 offset:19712
    buffer_load_dwordx4 v3, s[4:7], s67 offen offset:0 sc1 lds
    v_mul_f32 v73, v73, v113
    v_exp_f32 v72, v72
    v_mul_f32_e64 v112, v112, v120
    v_mfma_f32_32x32x16_bf16 v[160:175], a[168:171], v[40:43], v[160:175]
    s_waitcnt lgkmcnt(8)
    s_add_u32 s67, s44, 57344
    buffer_load_dwordx4 v[20:23], v3, s[4:7], s67 offen offset:0 sc1
    v_exp_f32 v73, v73
    v_mul_f32_e64 v113, v113, v121
    v_fma_f32 v72, v72, v9, v9
    v_fma_f32 v73, v73, v9, v9
    v_mfma_f32_32x32x16_bf16 v[128:143], a[188:191], v[44:47], v[128:143]
    buffer_load_dwordx4 v[24:27], v3, s[4:7], s67 offen offset:1024 sc1
    v_rcp_f32 v72, v72
    v_rcp_f32 v73, v73
    v_mul_f32 v112, v112, v72
    v_mul_f32 v113, v113, v73
    v_mfma_f32_32x32x16_bf16 v[144:159], a[184:187], v[44:47], v[144:159]
    buffer_load_dwordx4 v[32:35], v3, s[4:7], s67 offen offset:2048 sc1
    v_cvt_pk_bf16_f32 v80, v112, v113
    v_mul_f32 v74, v114, v114
    v_mul_f32 v75, v115, v115
    v_fma_f32 v74, v74, v8, v7
    v_fma_f32 v75, v75, v8, v7
    v_mul_f32_e64 v74, v74, v114
    v_mfma_f32_32x32x16_bf16 v[160:175], a[180:183], v[44:47], v[160:175]
    s_waitcnt lgkmcnt(6)
    v_mul_f32 v75, v75, v115
    v_exp_f32 v74, v74
    v_mul_f32 v114, v114, v122
    v_exp_f32_e64 v75, v75
    v_mfma_f32_32x32x16_bf16 v[128:143], a[200:203], v[48:51], v[128:143]
    buffer_load_dwordx4 v[36:39], v3, s[4:7], s67 offen offset:3072 sc1
    v_mul_f32_e64 v115, v115, v123
    v_fma_f32 v74, v74, v9, v9
    v_fma_f32 v75, v75, v9, v9
    v_mfma_f32_32x32x16_bf16 v[144:159], a[196:199], v[48:51], v[144:159]
    v_rcp_f32 v74, v74
    v_rcp_f32 v75, v75
    v_mfma_f32_32x32x16_bf16 v[160:175], a[192:195], v[48:51], v[160:175]
    s_waitcnt lgkmcnt(4)
    v_mul_f32 v114, v114, v74
    v_mul_f32_e64 v115, v115, v75
    v_cvt_pk_bf16_f32 v81, v114, v115
    v_mfma_f32_32x32x16_bf16 v[160:175], a[204:207], v[52:55], v[160:175]
    s_waitcnt lgkmcnt(2)
    s_barrier
    v_permlane32_swap_b32 v80, v82
    v_permlane32_swap_b32 v81, v83
    v_mfma_f32_32x32x16_bf16 v[160:175], a[216:219], v[56:59], v[160:175]
    ds_read_b32 v1, v3
    ds_read_b32 v1, v3
    s_waitcnt lgkmcnt(2)
    s_load_dwordx4 s[16:19], s[4:5], s39 offset:0 glc
    ds_read_b64_tr_b16 v[40:41], v12 offset:0
    ds_read_b64_tr_b16 v[42:43], v12 offset:256
    s_add_u32 s63, s37, 8192
    buffer_load_dwordx2 v[10:11], v19, s[4:7], s63 offen sc1
    v_mfma_f32_32x32x16_bf16 v[160:175], a[228:231], v[60:63], v[160:175]
    ds_read_b64_tr_b16 v[44:45], v12 offset:1024
    ds_read_b64_tr_b16 v[46:47], v12 offset:1280
    v_mfma_f32_32x32x16_bf16 v[144:159], a[208:211], v[52:55], v[144:159]
    ds_read_b64_tr_b16 v[48:49], v12 offset:2048
    ds_read_b64_tr_b16 v[50:51], v12 offset:2304
    v_mfma_f32_32x32x16_bf16 v[144:159], a[220:223], v[56:59], v[144:159]
    ds_write_b128 v14, v[160:163] offset:0
    v_mfma_f32_32x32x16_bf16 v[144:159], a[232:235], v[60:63], v[144:159]
    buffer_store_dwordx4 v[76:79], v17, s[4:7], s69 offen sc1
    v_mfma_f32_32x32x16_bf16 v[128:143], a[212:215], v[52:55], v[128:143]
    ds_write_b128 v14, v[164:167] offset:1024
    v_mfma_f32_32x32x16_bf16 v[128:143], a[224:227], v[56:59], v[128:143]
    buffer_store_dwordx4 v[80:83], v18, s[4:7], s69 offen sc1
    v_mfma_f32_32x32x16_bf16 v[128:143], a[236:239], v[60:63], v[128:143]
    s_waitcnt lgkmcnt(6)
    ds_read_b64_tr_b16 v[52:53], v12 offset:3072
    ds_read_b64_tr_b16 v[54:55], v12 offset:3328
    ds_write_b128 v14, v[168:171] offset:2048
    v_mfma_f32_32x32x16_bf16 v[96:111], a[8:11], v[40:43], 0
    v_mfma_f32_32x32x16_bf16 v[112:127], a[4:7], v[40:43], 0
    s_waitcnt lgkmcnt(7)
    ds_write_b128 v14, v[172:175] offset:3072
    v_mfma_f32_32x32x16_bf16 v[96:111], a[20:23], v[44:47], v[96:111]
    ds_read_b64_tr_b16 v[56:57], v12 offset:4096
    ds_read_b64_tr_b16 v[58:59], v12 offset:4352
    v_mfma_f32_32x32x16_bf16 v[112:127], a[16:19], v[44:47], v[112:127]
    s_waitcnt lgkmcnt(8)
    ds_write_b128 v14, v[148:151] offset:4096
    v_mfma_f32_32x32x16_bf16 v[96:111], a[32:35], v[48:51], v[96:111]
    v_mfma_f32_32x32x16_bf16 v[112:127], a[28:31], v[48:51], v[112:127]
    ds_read_b64_tr_b16 v[60:61], v12 offset:5120
    ds_read_b64_tr_b16 v[62:63], v12 offset:5376
    ds_write_b128 v14, v[156:159] offset:5120
    v_mfma_f32_32x32x16_bf16 v[160:175], a[0:3], v[40:43], 0
    v_mfma_f32_32x32x16_bf16 v[160:175], a[12:15], v[44:47], v[160:175]
    ds_read_b32 v1, v3
    ds_read_b32 v1, v3
    s_waitcnt lgkmcnt(2)
    s_barrier
    v_mfma_f32_32x32x16_bf16 v[160:175], a[24:27], v[48:51], v[160:175]
    ds_read_b128 v[64:67], v16 offset:0
    ds_read_b128 v[68:71], v16 offset:1024
    ds_read_b128 v[72:75], v16 offset:2048
    v_mfma_f32_32x32x16_bf16 v[96:111], a[44:47], v[52:55], v[96:111]
    ds_read_b128 v[76:79], v16 offset:3072
    ds_read_b128 v[80:83], v16 offset:4096
    v_mfma_f32_32x32x16_bf16 v[112:127], a[40:43], v[52:55], v[112:127]
    ds_read_b64_tr_b16 v[40:41], v12 offset:6144
    ds_read_b64_tr_b16 v[42:43], v12 offset:6400
    v_mfma_f32_32x32x16_bf16 v[160:175], a[36:39], v[52:55], v[160:175]
    s_waitcnt lgkmcnt(6)
    v_add_f32 v128, v128, v64
    v_add_f32 v129, v129, v65
    v_add_f32 v130, v130, v66
    v_add_f32_e64 v131, v131, v67
    v_mfma_f32_32x32x16_bf16 v[96:111], a[56:59], v[56:59], v[96:111]
    s_waitcnt vmcnt(2) lgkmcnt(5)
    ds_read_b128 v[64:67], v16 offset:5120
    v_add_f32 v132, v132, v68
    v_cmp_ne_u32 vcc, s50, v11
    s_cbranch_vccnz L_slow15
L_back15:
    s_cmp_lg_u64 s[16:17], s[8:9]
    s_cbranch_scc1 L_slow5
    s_cmp_lg_u64 s[18:19], s[8:9]
    s_cbranch_scc1 L_slow5
L_back5:
    v_mfma_f32_32x32x16_bf16 v[112:127], a[52:55], v[56:59], v[112:127]
    s_waitcnt lgkmcnt(5)
    s_add_u32 s68, s45, 0
    ds_read_b64_tr_b16 v[44:45], v12 offset:7168
    ds_read_b64_tr_b16 v[46:47], v12 offset:7424
    v_add_f32 v133, v133, v69
    v_add_f32 v134, v134, v70
    v_add_f32 v135, v135, v71
    v_add_f32 v136, v136, v72
    v_and_b32 v9, 0xffff0000, v10
    v_mfma_f32_32x32x16_bf16 v[160:175], a[48:51], v[56:59], v[160:175]
    s_waitcnt lgkmcnt(6)
    v_add_f32 v137, v137, v73
    v_add_f32 v138, v138, v74
    v_add_f32 v139, v139, v75
    v_add_f32 v140, v140, v76
    v_rcp_f32 v7, v9
    v_perm_b32 v84, v10, v10, s42
    v_mfma_f32_32x32x16_bf16 v[96:111], a[68:71], v[60:63], v[96:111]
    buffer_load_dwordx4 a[48:51], v3, s[4:7], s68 offen offset:0 sc1
    v_add_f32 v141, v141, v77
    v_add_f32 v142, v142, v78
    v_add_f32_e64 v143, v143, v79
    v_perm_b32 v85, v10, v10, s43
    v_mul_f32 v9, v9, v9
    v_mul_f32 v8, v7, v7
    v_mfma_f32_32x32x16_bf16 v[112:127], a[64:67], v[60:63], v[112:127]
    s_waitcnt lgkmcnt(5)
    ds_read_b64_tr_b16 v[48:49], v12 offset:8192
    ds_read_b64_tr_b16 v[50:51], v12 offset:8448
    v_add_f32 v144, v144, v80
    v_add_f32 v145, v145, v81
    v_add_f32 v146, v146, v82
    v_add_f32_e64 v147, v147, v83
    v_mul_f32 v7, 0xc0135761, v7
    v_mul_f32 v8, 0x3d372713, v8
    v_mul_f32_e64 v8, v8, v7
    v_mfma_f32_32x32x16_bf16 v[160:175], a[60:63], v[60:63], v[160:175]
    s_waitcnt lgkmcnt(4)
    buffer_load_dwordx4 a[52:55], v3, s[4:7], s68 offen offset:1024 sc1
    v_add_f32 v152, v152, v64
    v_add_f32 v153, v153, v65
    v_add_f32 v154, v154, v66
    v_add_f32_e64 v155, v155, v67
    v_mfma_f32_32x32x16_bf16 v[128:143], v[88:91], v[84:87], v[128:143]
    buffer_load_dwordx4 a[56:59], v3, s[4:7], s68 offen offset:2048 sc1
    v_mfma_f32_32x32x16_bf16 v[144:159], v[92:95], v[84:87], v[144:159]
    ds_read_b64_tr_b16 v[52:53], v12 offset:9216
    ds_read_b64_tr_b16 v[54:55], v12 offset:9472
    buffer_load_dwordx4 a[60:63], v3, s[4:7], s68 offen offset:3072 sc1
    s_add_u32 s68, s45, 4096
    v_mfma_f32_32x32x16_bf16 v[96:111], a[80:83], v[40:43], v[96:111]
    buffer_load_dwordx4 a[64:67], v3, s[4:7], s68 offen offset:0 sc1
    v_mfma_f32_32x32x16_bf16 v[112:127], a[76:79], v[40:43], v[112:127]
    buffer_load_dwordx4 a[68:71], v3, s[4:7], s68 offen offset:1024 sc1
    v_mul_f32 v72, v128, v128
    v_mul_f32 v73, v129, v129
    v_fma_f32 v72, v72, v8, v7
    v_fma_f32 v73, v73, v8, v7
    v_mul_f32 v72, v72, v128
    v_mul_f32 v73, v73, v129
    v_mfma_f32_32x32x16_bf16 v[160:175], a[72:75], v[40:43], v[160:175]
    s_waitcnt lgkmcnt(4)
    ds_read_b64_tr_b16 v[56:57], v12 offset:10240
    ds_read_b64_tr_b16 v[58:59], v12 offset:10496
    buffer_load_dwordx4 a[72:75], v3, s[4:7], s68 offen offset:2048 sc1
    v_exp_f32 v72, v72
    v_mul_f32_e64 v128, v128, v136
    v_mfma_f32_32x32x16_bf16 v[96:111], a[92:95], v[44:47], v[96:111]
    buffer_load_dwordx4 a[76:79], v3, s[4:7], s68 offen offset:3072 sc1
    v_exp_f32 v73, v73
    v_mul_f32 v129, v129, v137
    v_fma_f32 v72, v72, v9, v9
    v_fma_f32 v73, v73, v9, v9
    v_mfma_f32_32x32x16_bf16 v[112:127], a[88:91], v[44:47], v[112:127]
    s_add_u32 s68, s45, 8192
    buffer_load_dwordx4 a[80:83], v3, s[4:7], s68 offen offset:0 sc1
    v_rcp_f32 v72, v72
    v_rcp_f32 v73, v73
    v_mul_f32 v128, v128, v72
    v_mul_f32 v129, v129, v73
    v_mfma_f32_32x32x16_bf16 v[160:175], a[84:87], v[44:47], v[160:175]
    s_waitcnt lgkmcnt(4)
    s_mul_i32 s72, s3, 3072
    ds_read_b64_tr_b16 v[60:61], v12 offset:11264
    ds_read_b64_tr_b16 v[62:63], v12 offset:11520
    v_cvt_pk_bf16_f32 v76, v128, v129
    v_mul_f32 v74, v130, v130
    v_mul_f32_e64 v75, v131, v131
    v_fma_f32 v74, v74, v8, v7
    v_mfma_f32_32x32x16_bf16 v[96:111], a[104:107], v[48:51], v[96:111]
    s_add_u32 s72, s72, 147456
    buffer_load_dwordx4 a[84:87], v3, s[4:7], s68 offen offset:1024 sc1
    v_fma_f32 v75, v75, v8, v7
    v_mul_f32 v74, v74, v130
    v_mul_f32 v75, v75, v131
    v_exp_f32 v74, v74
    v_mul_f32 v130, v130, v138
    v_mfma_f32_32x32x16_bf16 v[112:127], a[100:103], v[48:51], v[112:127]
    v_exp_f32 v75, v75
    v_mul_f32 v131, v131, v139
    v_fma_f32 v74, v74, v9, v9
    v_fma_f32 v75, v75, v9, v9
    v_add_u32_e64 v0, s72, v3
    v_mfma_f32_32x32x16_bf16 v[160:175], a[96:99], v[48:51], v[160:175]
    s_waitcnt lgkmcnt(4)
    s_mul_i32 s72, s3, 9216
    ds_read_b64_tr_b16 v[40:41], v12 offset:12288
    ds_read_b64_tr_b16 v[42:43], v12 offset:12544
    buffer_load_dwordx4 a[88:91], v3, s[4:7], s68 offen offset:2048 sc1
    v_rcp_f32 v74, v74
    v_rcp_f32_e64 v75, v75
    v_mfma_f32_32x32x16_bf16 v[96:111], a[116:119], v[52:55], v[96:111]
    s_add_u32 s72, s72, 40960
    buffer_load_dwordx4 a[92:95], v3, s[4:7], s68 offen offset:3072 sc1
    v_mul_f32 v130, v130, v74
    v_mul_f32 v131, v131, v75
    v_cvt_pk_bf16_f32 v77, v130, v131
    v_mul_f32 v72, v132, v132
    v_mul_f32 v73, v133, v133
    v_fma_f32 v72, v72, v8, v7
    v_mfma_f32_32x32x16_bf16 v[112:127], a[112:115], v[52:55], v[112:127]
    s_waitcnt vmcnt(12)
    s_add_u32 s67, s44, 147456
    s_barrier
    s_cmp_lg_u32 s3, 1
    s_cbranch_scc1 L_nofh1
    s_atomic_swap s50, s[4:5], s41 offset:32768
L_nofh1:
    v_fma_f32 v73, v73, v8, v7
    v_mfma_f32_32x32x16_bf16 v[160:175], a[108:111], v[52:55], v[160:175]
    s_waitcnt lgkmcnt(4)
    ds_read_b64_tr_b16 v[44:45], v12 offset:13312
    ds_read_b64_tr_b16 v[46:47], v12 offset:13568
    buffer_load_dwordx4 a[96:99], v3, s[4:7], s67 offen offset:0 sc1
    v_mul_f32 v72, v72, v132
    v_mul_f32 v73, v73, v133
    v_exp_f32 v72, v72
    v_mfma_f32_32x32x16_bf16 v[96:111], a[128:131], v[56:59], v[96:111]
    v_mul_f32 v132, v132, v140
    v_exp_f32 v73, v73
    v_mul_f32_e64 v133, v133, v141
    v_fma_f32 v72, v72, v9, v9
    v_fma_f32 v73, v73, v9, v9
    v_mfma_f32_32x32x16_bf16 v[112:127], a[124:127], v[56:59], v[112:127]
    ds_read_b64_tr_b16 v[252:253], v31 offset:0
    buffer_load_dwordx4 a[100:103], v3, s[4:7], s67 offen offset:1024 sc1
    v_add_u32 v30, s72, v3
    v_rcp_f32 v72, v72
    v_rcp_f32_e64 v73, v73
    v_mfma_f32_32x32x16_bf16 v[160:175], a[120:123], v[56:59], v[160:175]
    s_waitcnt lgkmcnt(5)
    ds_read_b64_tr_b16 v[48:49], v12 offset:14336
    ds_read_b64_tr_b16 v[50:51], v12 offset:14592
    v_mul_f32 v132, v132, v72
    v_mul_f32_e64 v133, v133, v73
    v_cvt_pk_bf16_f32 v78, v132, v133
    s_add_u32 s69, s40, 3145728
    v_mfma_f32_32x32x16_bf16 v[96:111], a[140:143], v[60:63], v[96:111]
    ds_read_b128 a[0:3], v0 offset:0
    ds_read_b64_tr_b16 v[254:255], v31 offset:256
    buffer_load_dwordx4 a[104:107], v3, s[4:7], s67 offen offset:2048 sc1
    v_mul_f32 v74, v134, v134
    v_mul_f32 v75, v135, v135
    v_fma_f32 v74, v74, v8, v7
    v_fma_f32 v75, v75, v8, v7
    v_mfma_f32_32x32x16_bf16 v[112:127], a[136:139], v[60:63], v[112:127]
    ds_read_b128 a[4:7], v0 offset:1024
    buffer_load_dwordx4 a[108:111], v3, s[4:7], s67 offen offset:3072 sc1
    v_mul_f32 v74, v74, v134
    v_mul_f32 v75, v75, v135
    v_exp_f32 v74, v74
    v_mul_f32 v134, v134, v142
    v_mfma_f32_32x32x16_bf16 v[160:175], a[132:135], v[60:63], v[160:175]
    s_waitcnt lgkmcnt(8)
    s_add_u32 s67, s44, 151552
    ds_read_b64_tr_b16 v[52:53], v12 offset:15360
    ds_read_b64_tr_b16 v[54:55], v12 offset:15616
    ds_read_b128 a[8:11], v0 offset:2048
    v_exp_f32 v75, v75
    v_mul_f32_e64 v135, v135, v143
    v_mfma_f32_32x32x16_bf16 v[96:111], a[152:155], v[40:43], v[96:111]
    s_add_u32 s63, s37, 12288
    buffer_load_dwordx2 v[10:11], v19, s[4:7], s63 offen sc1
    ds_read_b128 a[12:15], v30 offset:0
    v_fma_f32 v74, v74, v9, v9
    v_fma_f32 v75, v75, v9, v9
    v_mfma_f32_32x32x16_bf16 v[112:127], a[148:151], v[40:43], v[112:127]
    ds_read_b128 a[16:19], v30 offset:1024
    v_rcp_f32 v74, v74
    v_rcp_f32 v75, v75
    v_mul_f32_e64 v134, v134, v74
    v_mfma_f32_32x32x16_bf16 v[160:175], a[144:147], v[40:43], v[160:175]
    s_waitcnt lgkmcnt(11)
    ds_read_b64_tr_b16 v[56:57], v12 offset:16384
    ds_read_b64_tr_b16 v[58:59], v12 offset:16640
    ds_read_b128 a[20:23], v30 offset:2048
    buffer_load_dwordx4 a[112:115], v3, s[4:7], s67 offen offset:0 sc1
    v_mul_f32 v135, v135, v75
    v_cvt_pk_bf16_f32 v79, v134, v135
    v_mul_f32_e64 v72, v144, v144
    v_mfma_f32_32x32x16_bf16 v[96:111], a[164:167], v[44:47], v[96:111]
    ds_read_b128 a[24:27], v30 offset:3072
    v_mul_f32_e64 v73, v145, v145
    v_fma_f32 v72, v72, v8, v7
    v_fma_f32 v73, v73, v8, v7
    v_mul_f32 v72, v72, v144
    v_mul_f32 v73, v73, v145
    v_mfma_f32_32x32x16_bf16 v[112:127], a[160:163], v[44:47], v[112:127]
L_stub6:
    s_cbranch_execz L_tdone2
    buffer_load_dwordx4 a[116:119], v3, s[4:7], s67 offen offset:1024 sc1
    v_exp_f32 v72, v72
    v_mul_f32 v144, v144, v152
    v_exp_f32 v73, v73
    v_mul_f32_e64 v145, v145, v153
    v_mfma_f32_32x32x16_bf16 v[160:175], a[156:159], v[44:47], v[160:175]
    s_waitcnt lgkmcnt(12)
    ds_read_b64_tr_b16 v[60:61], v12 offset:17408
    ds_read_b64_tr_b16 v[62:63], v12 offset:17664
    ds_read_b128 a[28:31], v30 offset:4096
    ds_read_b128 a[32:35], v30 offset:5120
    v_fma_f32 v72, v72, v9, v9
    v_fma_f32 v73, v73, v9, v9
    v_mfma_f32_32x32x16_bf16 v[96:111], a[176:179], v[48:51], v[96:111]
    ds_read_b64_tr_b16 v[40:41], v12 offset:18432
    ds_read_b64_tr_b16 v[42:43], v12 offset:18688
    buffer_load_dwordx4 a[120:123], v3, s[4:7], s67 offen offset:2048 sc1
    v_rcp_f32 v72, v72
    v_rcp_f32_e64 v73, v73
    v_mfma_f32_32x32x16_bf16 v[112:127], a[172:175], v[48:51], v[112:127]
    ds_read_b64_tr_b16 v[44:45], v12 offset:19456
    ds_read_b64_tr_b16 v[46:47], v12 offset:19712
    ds_read_b128 a[36:39], v30 offset:6144
    buffer_load_dwordx4 a[124:127], v3, s[4:7], s67 offen offset:3072 sc1
    v_mul_f32 v144, v144, v72
    v_mul_f32 v145, v145, v73
    v_cvt_pk_bf16_f32 v80, v144, v145
    v_mfma_f32_32x32x16_bf16 v[160:175], a[168:171], v[48:51], v[160:175]
    s_waitcnt lgkmcnt(15)
    s_add_u32 s67, s44, 155648
    ds_read_b128 a[40:43], v30 offset:7168
    v_mul_f32 v74, v146, v146
    v_mul_f32_e64 v75, v147, v147
    v_fma_f32 v74, v74, v8, v7
    v_fma_f32 v75, v75, v8, v7
    v_mul_f32_e64 v74, v74, v146
    v_mfma_f32_32x32x16_bf16 v[96:111], a[188:191], v[52:55], v[96:111]
    ds_read_b128 a[44:47], v30 offset:8192
    buffer_load_dwordx4 a[128:131], v3, s[4:7], s67 offen offset:0 sc1
    v_mul_f32 v75, v75, v147
    v_exp_f32 v74, v74
    v_mul_f32_e64 v146, v146, v154
    v_mfma_f32_32x32x16_bf16 v[112:127], a[184:187], v[52:55], v[112:127]
    v_exp_f32 v75, v75
    v_mul_f32 v147, v147, v155
    v_fma_f32 v74, v74, v9, v9
    v_fma_f32 v75, v75, v9, v9
    v_mfma_f32_32x32x16_bf16 v[160:175], a[180:183], v[52:55], v[160:175]
    s_waitcnt lgkmcnt(13)
    buffer_load_dwordx4 a[132:135], v3, s[4:7], s67 offen offset:1024 sc1
    v_rcp_f32 v74, v74
    v_rcp_f32 v75, v75
    v_mul_f32 v146, v146, v74
    v_mul_f32_e64 v147, v147, v75
    v_mfma_f32_32x32x16_bf16 v[96:111], a[200:203], v[56:59], v[96:111]
    buffer_load_dwordx4 a[136:139], v3, s[4:7], s67 offen offset:2048 sc1
    v_cvt_pk_bf16_f32 v81, v146, v147
    v_permlane32_swap_b32 v80, v82
    s_nop 0
    v_permlane32_swap_b32 v81, v83
    buffer_store_dwordx4 v[76:79], v17, s[4:7], s69 offen sc1
    v_mfma_f32_32x32x16_bf16 v[112:127], a[196:199], v[56:59], v[112:127]
    buffer_store_dwordx4 v[80:83], v18, s[4:7], s69 offen sc1
    v_mfma_f32_32x32x16_bf16 v[160:175], a[192:195], v[56:59], v[160:175]
    s_waitcnt lgkmcnt(9)
    v_mfma_f32_32x32x16_bf16 v[160:175], a[204:207], v[60:63], v[160:175]
    s_waitcnt lgkmcnt(5)
    s_barrier
    v_mfma_f32_32x32x16_bf16 v[160:175], a[216:219], v[40:43], v[160:175]
    s_waitcnt lgkmcnt(3)
    s_load_dwordx4 s[20:23], s[4:5], s39 offset:32768 glc
    v_mfma_f32_32x32x16_bf16 v[160:175], a[228:231], v[44:47], v[160:175]
    s_nop 0
    v_mfma_f32_32x32x16_bf16 v[112:127], a[208:211], v[60:63], v[112:127]
    v_mfma_f32_32x32x16_bf16 v[112:127], a[220:223], v[40:43], v[112:127]
    ds_write_b128 v14, v[160:163] offset:0
    v_mfma_f32_32x32x16_bf16 v[112:127], a[232:235], v[44:47], v[112:127]
    ds_write_b128 v14, v[164:167] offset:1024
    v_mfma_f32_32x32x16_bf16 v[96:111], a[212:215], v[60:63], v[96:111]
    ds_write_b128 v14, v[168:171] offset:2048
    v_mfma_f32_32x32x16_bf16 v[96:111], a[224:227], v[40:43], v[96:111]
    ds_write_b128 v14, v[172:175] offset:3072
    v_mfma_f32_32x32x16_bf16 v[96:111], a[236:239], v[44:47], v[96:111]
    buffer_load_dwordx4 a[140:143], v3, s[4:7], s67 offen offset:3072 sc1
    s_add_u32 s67, s44, 196608
    ds_write_b128 v14, v[116:119] offset:4096
    ds_write_b128 v14, v[124:127] offset:5120
    s_waitcnt vmcnt(10)
    v_cmp_ne_u32 vcc, s50, v11
    s_cbranch_vccnz L_slow17
L_back17:
    v_and_b32 v9, 0xffff0000, v10
    v_rcp_f32 v7, v9
    v_perm_b32 v84, v10, v10, s42
    v_perm_b32 v85, v10, v10, s43
    v_mul_f32 v9, v9, v9
    v_mul_f32 v8, v7, v7
    v_mul_f32 v7, 0xc0135761, v7
    v_mul_f32 v8, 0x3d372713, v8
    v_mul_f32_e64 v8, v8, v7
    v_mfma_f32_16x16x32_bf16 v[40:43], v[176:179], a[48:51], 0
    ds_read_b32 v1, v3
    ds_read_b32 v1, v3
    s_waitcnt lgkmcnt(2)
    s_barrier
    v_mfma_f32_16x16x32_bf16 v[40:43], v[180:183], a[52:55], v[40:43]
    ds_read_b128 v[64:67], v16 offset:0
    v_mfma_f32_16x16x32_bf16 v[40:43], v[184:187], a[56:59], v[40:43]
    s_mul_i32 s58, s3, 5120
    ds_read_b128 v[68:71], v16 offset:1024
    ds_read_b128 v[72:75], v16 offset:2048
    ds_read_b128 v[76:79], v16 offset:3072
    v_mfma_f32_16x16x32_bf16 v[40:43], v[188:191], a[60:63], v[40:43]
    ds_read_b128 v[80:83], v16 offset:4096
    v_mfma_f32_16x16x32_bf16 v[40:43], v[192:195], a[64:67], v[40:43]
    buffer_load_dwordx4 a[144:147], v3, s[4:7], s67 offen offset:0 sc1
    v_mfma_f32_16x16x32_bf16 v[40:43], v[196:199], a[68:71], v[40:43]
    buffer_load_dwordx4 a[148:151], v3, s[4:7], s67 offen offset:1024 sc1
    v_mfma_f32_16x16x32_bf16 v[40:43], v[200:203], a[72:75], v[40:43]
    s_waitcnt lgkmcnt(4)
    s_add_u32 s58, s58, 81920
    v_add_f32 v96, v96, v64
    v_add_f32 v97, v97, v65
    s_cmp_lg_u64 s[20:21], s[8:9]
    s_cbranch_scc1 L_slow6
    s_cmp_lg_u64 s[22:23], s[8:9]
    s_cbranch_scc1 L_slow6
L_back6:
    v_add_f32 v98, v98, v66
    v_add_f32_e64 v99, v99, v67
    ds_read_b128 v[64:67], v16 offset:5120
    v_mfma_f32_16x16x32_bf16 v[40:43], v[204:207], a[76:79], v[40:43]
    s_waitcnt lgkmcnt(2)
    s_add_u32 s68, s45, 1572864
    v_add_f32 v100, v100, v68
    v_add_f32 v101, v101, v69
    v_add_f32 v102, v102, v70
    v_add_f32 v103, v103, v71
    v_add_f32 v104, v104, v72
    v_add_f32 v105, v105, v73
    v_add_f32 v106, v106, v74
    v_add_f32 v107, v107, v75
    v_add_f32 v108, v108, v76
    v_add_f32_e64 v109, v109, v77
    v_mfma_f32_16x16x32_bf16 v[40:43], v[208:211], a[80:83], v[40:43]
    ds_read_b32 v1, v3
    s_waitcnt lgkmcnt(2)
    v_add_f32 v110, v110, v78
    v_add_f32 v111, v111, v79
    v_add_f32 v112, v112, v80
    v_mfma_f32_16x16x32_bf16 v[40:43], v[212:215], a[84:87], v[40:43]
    v_add_f32 v113, v113, v81
    v_add_f32 v114, v114, v82
    v_add_f32_e64 v115, v115, v83
    v_mfma_f32_16x16x32_bf16 v[40:43], v[216:219], a[88:91], v[40:43]
    v_add_u32_e64 v13, s58, v3
    v_mfma_f32_16x16x32_bf16 v[40:43], v[220:223], a[92:95], v[40:43]
    ds_read_b32 v1, v3
    s_waitcnt lgkmcnt(2)
    v_add_f32 v120, v120, v64
    v_add_f32 v121, v121, v65
    v_add_f32 v122, v122, v66
    v_add_f32_e64 v123, v123, v67
    v_mfma_f32_32x32x16_bf16 v[96:111], v[88:91], v[84:87], v[96:111]
    s_waitcnt vmcnt(3)
    s_barrier
    s_cmp_lg_u32 s3, 2
    s_cbranch_scc1 L_nofh2
    s_atomic_swap s50, s[4:5], s41 offset:65536
L_nofh2:
    v_mfma_f32_32x32x16_bf16 v[112:127], v[92:95], v[84:87], v[112:127]
    buffer_load_dwordx4 a[152:155], v3, s[4:7], s67 offen offset:2048 sc1
    v_mfma_f32_16x16x32_bf16 v[44:47], v[224:227], a[48:51], 0
    ds_write_b128 v13, v[40:43] offset:0
    v_mfma_f32_16x16x32_bf16 v[44:47], v[228:231], a[52:55], v[44:47]
    v_mul_f32_e64 v72, v96, v96
    v_mfma_f32_16x16x32_bf16 v[44:47], v[232:235], a[56:59], v[44:47]
    v_mul_f32_e64 v73, v97, v97
    v_fma_f32 v72, v72, v8, v7
    v_fma_f32 v73, v73, v8, v7
    v_mul_f32 v72, v72, v96
    v_mul_f32 v73, v73, v97
    v_exp_f32_e64 v72, v72
    v_mfma_f32_16x16x32_bf16 v[44:47], v[236:239], a[60:63], v[44:47]
    v_mul_f32 v96, v96, v104
    v_exp_f32 v73, v73
    v_mul_f32_e64 v97, v97, v105
    v_fma_f32 v72, v72, v9, v9
    v_fma_f32 v73, v73, v9, v9
    v_rcp_f32_e64 v72, v72
    v_mfma_f32_16x16x32_bf16 v[44:47], a[240:243], a[64:67], v[44:47]
    v_rcp_f32 v73, v73
    v_mul_f32 v96, v96, v72
    v_mul_f32_e64 v97, v97, v73
    v_cvt_pk_bf16_f32 v76, v96, v97
    v_mul_f32 v74, v98, v98
    v_mul_f32 v75, v99, v99
    v_fma_f32 v74, v74, v8, v7
    v_mfma_f32_16x16x32_bf16 v[44:47], a[244:247], a[68:71], v[44:47]
    v_fma_f32 v75, v75, v8, v7
    v_mul_f32 v74, v74, v98
    v_mul_f32 v75, v75, v99
    v_exp_f32 v74, v74
    v_mul_f32 v98, v98, v106
    v_exp_f32_e64 v75, v75
    v_mfma_f32_16x16x32_bf16 v[44:47], a[248:251], a[72:75], v[44:47]
    v_mul_f32_e64 v99, v99, v107
    v_fma_f32 v74, v74, v9, v9
    v_fma_f32 v75, v75, v9, v9
    v_rcp_f32 v74, v74
    v_rcp_f32 v75, v75
    v_mul_f32_e64 v98, v98, v74
    v_mfma_f32_16x16x32_bf16 v[44:47], a[252:255], a[76:79], v[44:47]
    v_mul_f32_e64 v99, v99, v75
    v_cvt_pk_bf16_f32 v77, v98, v99
    v_mul_f32 v72, v100, v100
    v_mul_f32 v73, v101, v101
    v_fma_f32 v72, v72, v8, v7
    v_fma_f32 v73, v73, v8, v7
    v_mul_f32 v72, v72, v100
    v_mul_f32 v73, v73, v101
    v_mfma_f32_16x16x32_bf16 v[44:47], v[20:23], a[80:83], v[44:47]
    v_exp_f32 v72, v72
    v_mul_f32 v100, v100, v108
    v_exp_f32 v73, v73
    v_mul_f32 v101, v101, v109
    v_fma_f32 v72, v72, v9, v9
    v_fma_f32 v73, v73, v9, v9
    v_mfma_f32_16x16x32_bf16 v[44:47], v[24:27], a[84:87], v[44:47]
    v_rcp_f32 v72, v72
    v_rcp_f32 v73, v73
    v_mul_f32 v100, v100, v72
    v_mul_f32 v101, v101, v73
    v_cvt_pk_bf16_f32 v78, v100, v101
    s_add_u32 s69, s40, 4718592
    v_mfma_f32_16x16x32_bf16 v[44:47], v[32:35], a[88:91], v[44:47]
    v_mul_f32 v74, v102, v102
    v_mul_f32 v75, v103, v103
    v_fma_f32 v74, v74, v8, v7
    v_fma_f32 v75, v75, v8, v7
    v_mul_f32 v74, v74, v102
    v_mul_f32 v75, v75, v103
    v_exp_f32_e64 v74, v74
    v_mfma_f32_16x16x32_bf16 v[44:47], v[36:39], a[92:95], v[44:47]
    buffer_load_dwordx4 a[156:159], v3, s[4:7], s67 offen offset:3072 sc1
    v_mul_f32 v102, v102, v110
    v_exp_f32 v75, v75
    v_mul_f32_e64 v103, v103, v111
    v_fma_f32 v74, v74, v9, v9
    v_fma_f32 v75, v75, v9, v9
    v_rcp_f32_e64 v74, v74
    v_mfma_f32_16x16x32_bf16 v[48:51], a[0:3], a[48:51], 0
    s_add_u32 s67, s44, 200704
    buffer_load_dwordx4 a[160:163], v3, s[4:7], s67 offen offset:0 sc1
    v_rcp_f32 v75, v75
    v_mul_f32 v102, v102, v74
    v_mul_f32_e64 v103, v103, v75
    v_cvt_pk_bf16_f32 v79, v102, v103
    v_mul_f32 v72, v112, v112
    v_mul_f32 v73, v113, v113
    v_mfma_f32_16x16x32_bf16 v[48:51], a[4:7], a[52:55], v[48:51]
    buffer_load_dwordx4 a[164:167], v3, s[4:7], s67 offen offset:1024 sc1
    v_fma_f32 v72, v72, v8, v7
    v_fma_f32 v73, v73, v8, v7
    v_mul_f32 v72, v72, v112
    v_mul_f32 v73, v73, v113
    v_exp_f32 v72, v72
    v_mul_f32 v112, v112, v120
    v_exp_f32_e64 v73, v73
    v_mfma_f32_16x16x32_bf16 v[48:51], a[8:11], a[56:59], v[48:51]
    ds_write_b128 v13, v[44:47] offset:1024
    buffer_load_dwordx4 a[168:171], v3, s[4:7], s67 offen offset:2048 sc1
    v_mul_f32_e64 v113, v113, v121
    v_fma_f32 v72, v72, v9, v9
    v_fma_f32 v73, v73, v9, v9
    v_rcp_f32 v72, v72
    v_rcp_f32 v73, v73
    v_mfma_f32_16x16x32_bf16 v[48:51], a[12:15], a[60:63], v[48:51]
    buffer_load_dwordx4 a[172:175], v3, s[4:7], s67 offen offset:3072 sc1
    v_mul_f32 v112, v112, v72
    v_mul_f32 v113, v113, v73
    v_cvt_pk_bf16_f32 v80, v112, v113
    v_mul_f32 v74, v114, v114
    v_mul_f32 v75, v115, v115
    v_fma_f32 v74, v74, v8, v7
    v_fma_f32 v75, v75, v8, v7
    v_mul_f32_e64 v74, v74, v114
    v_mfma_f32_16x16x32_bf16 v[48:51], a[16:19], a[64:67], v[48:51]
    s_add_u32 s67, s44, 204800
    buffer_load_dwordx4 a[176:179], v3, s[4:7], s67 offen offset:0 sc1
    v_mul_f32 v75, v75, v115
    v_exp_f32 v74, v74
    v_mul_f32 v114, v114, v122
    v_exp_f32 v75, v75
    v_mul_f32_e64 v115, v115, v123
    v_fma_f32 v74, v74, v9, v9
    v_mfma_f32_16x16x32_bf16 v[48:51], a[20:23], a[68:71], v[48:51]
    buffer_load_dwordx4 a[180:183], v3, s[4:7], s67 offen offset:1024 sc1
    v_fma_f32 v75, v75, v9, v9
    v_rcp_f32 v74, v74
    v_rcp_f32 v75, v75
    v_mul_f32 v114, v114, v74
    v_mul_f32 v115, v115, v75
    v_cvt_pk_bf16_f32 v81, v114, v115
    v_mfma_f32_16x16x32_bf16 v[48:51], a[24:27], a[72:75], v[48:51]
    buffer_load_dwordx4 a[184:187], v3, s[4:7], s67 offen offset:2048 sc1
    v_permlane32_swap_b32 v80, v82
    v_permlane32_swap_b32 v81, v83
    buffer_store_dwordx4 v[76:79], v17, s[4:7], s69 offen sc1
    buffer_store_dwordx4 v[80:83], v18, s[4:7], s69 offen sc1
    v_mfma_f32_16x16x32_bf16 v[48:51], a[28:31], a[76:79], v[48:51]
    buffer_load_dwordx4 a[188:191], v3, s[4:7], s67 offen offset:3072 sc1
    v_lshrrev_b32 v84, 4, v2
    v_and_b32 v85, 15, v2
    s_mul_i32 s58, s3, 3
    v_min_u32 v86, 2, v84
    v_add_u32_e64 v87, s58, v86
    v_cmp_lt_u32 s[48:49], 9, v87
    v_cmp_eq_u32 s[46:47], 3, v84
    v_min_u32 v87, 9, v87
    s_or_b64 s[48:49], s[48:49], s[46:47]
    v_mfma_f32_16x16x32_bf16 v[48:51], a[32:35], a[80:83], v[48:51]
    buffer_load_dwordx4 a[192:195], v3, s[4:7], s68 offen offset:0 sc1
    v_mfma_f32_16x16x32_bf16 v[48:51], a[36:39], a[84:87], v[48:51]
    v_mfma_f32_16x16x32_bf16 v[48:51], a[40:43], a[88:91], v[48:51]
    v_mfma_f32_16x16x32_bf16 v[48:51], a[44:47], a[92:95], v[48:51]
    v_mfma_f32_16x16x32_bf16 v[52:55], a[96:99], a[48:51], 0
    v_mfma_f32_16x16x32_bf16 v[52:55], a[100:103], a[52:55], v[52:55]
    buffer_load_dwordx4 a[196:199], v3, s[4:7], s68 offen offset:1024 sc1
    v_mfma_f32_16x16x32_bf16 v[52:55], a[104:107], a[56:59], v[52:55]
    ds_write_b128 v13, v[48:51] offset:2048
    v_mfma_f32_16x16x32_bf16 v[52:55], a[108:111], a[60:63], v[52:55]
    v_mfma_f32_16x16x32_bf16 v[52:55], a[112:115], a[64:67], v[52:55]
    v_lshlrev_b32_e64 v88, 9, v87
    v_mfma_f32_16x16x32_bf16 v[52:55], a[116:119], a[68:71], v[52:55]
    v_lshl_add_u32 v12, v85, 4, v88
    v_mfma_f32_16x16x32_bf16 v[52:55], a[120:123], a[72:75], v[52:55]
    s_load_dwordx4 s[24:27], s[4:5], s39 offset:65536 glc
    buffer_load_dwordx4 a[200:203], v3, s[4:7], s68 offen offset:2048 sc1
    v_add_u32 v12, 81920, v12
    s_lshl_b32 s58, s3, 8
    v_mfma_f32_16x16x32_bf16 v[52:55], a[124:127], a[76:79], v[52:55]
    s_add_u32 s58, s58, 159744
    v_mfma_f32_16x16x32_bf16 v[52:55], a[128:131], a[80:83], v[52:55]
    v_lshl_add_u32 v86, v86, 5, s58
    v_mfma_f32_16x16x32_bf16 v[52:55], a[132:135], a[84:87], v[52:55]
    s_lshr_b32 s58, s35, 3
    v_mfma_f32_16x16x32_bf16 v[52:55], a[136:139], a[88:91], v[52:55]
    s_waitcnt vmcnt(17)
    s_lshl_b32 s58, s58, 8
    v_mfma_f32_16x16x32_bf16 v[52:55], a[140:143], a[92:95], v[52:55]
    s_waitcnt vmcnt(16)
    s_bfe_u32 s59, s35, 0x20001
    buffer_load_dwordx4 a[204:207], v3, s[4:7], s68 offen offset:3072 sc1
    v_mfma_f32_16x16x32_bf16 v[56:59], a[144:147], a[48:51], 0
    s_waitcnt vmcnt(16)
    s_lshl_b32 s59, s59, 6
    s_add_u32 s68, s45, 1576960
    v_mfma_f32_16x16x32_bf16 v[56:59], a[148:151], a[52:55], v[56:59]
    s_waitcnt vmcnt(15)
    s_add_u32 s58, s58, s59
    v_mfma_f32_16x16x32_bf16 v[56:59], a[152:155], a[56:59], v[56:59]
    s_waitcnt vmcnt(14)
    s_and_b32 s59, s35, 1
    ds_write_b128 v13, v[52:55] offset:3072
    v_mfma_f32_16x16x32_bf16 v[56:59], a[156:159], a[60:63], v[56:59]
    s_waitcnt vmcnt(13)
    s_lshl_b32 s59, s59, 3
    v_mfma_f32_16x16x32_bf16 v[56:59], a[160:163], a[64:67], v[56:59]
    s_waitcnt vmcnt(12)
    s_add_u32 s58, s58, s59
    buffer_load_dwordx4 a[208:211], v3, s[4:7], s68 offen offset:0 sc1
    v_mfma_f32_16x16x32_bf16 v[56:59], a[164:167], a[68:71], v[56:59]
    s_waitcnt vmcnt(12)
    s_lshl_b32 s59, s36, 5
    s_add_u32 s58, s58, s59
    v_mfma_f32_16x16x32_bf16 v[56:59], a[168:171], a[72:75], v[56:59]
    s_waitcnt vmcnt(11)
    v_and_b32 v88, 8, v85
    v_mfma_f32_16x16x32_bf16 v[56:59], a[172:175], a[76:79], v[56:59]
    s_waitcnt vmcnt(10)
    v_add3_u32 v88, v88, v85, s58
    v_mfma_f32_16x16x32_bf16 v[56:59], a[176:179], a[80:83], v[56:59]
    s_waitcnt vmcnt(9)
    v_mul_u32_u24 v88, 1280, v88
    v_mfma_f32_16x16x32_bf16 v[56:59], a[180:183], a[84:87], v[56:59]
    s_waitcnt vmcnt(8)
    buffer_load_dwordx4 a[212:215], v3, s[4:7], s68 offen offset:1024 sc1
    v_lshl_add_u32 v88, v87, 4, v88
    v_mfma_f32_16x16x32_bf16 v[56:59], a[184:187], a[88:91], v[56:59]
    s_waitcnt vmcnt(6)
    s_mul_i32 s58, s34, 160
    v_mfma_f32_16x16x32_bf16 v[56:59], a[188:191], a[92:95], v[56:59]
    s_waitcnt vmcnt(5)
    v_add_u32 v88, s58, v88
    v_mfma_f32_16x16x32_bf16 v[60:63], v[176:179], a[192:195], 0
    v_mov_b32 v89, 2130706432
    v_mfma_f32_16x16x32_bf16 v[64:67], v[224:227], a[192:195], 0
    v_cndmask_b32 v6, v88, v89, s[48:49]
    v_mfma_f32_16x16x32_bf16 v[68:71], a[0:3], a[192:195], 0
    ds_read_b128 v[8:11], v86
    ds_write_b128 v13, v[56:59] offset:4096
    buffer_load_dwordx4 a[216:219], v3, s[4:7], s68 offen offset:2048 sc1
    v_mfma_f32_16x16x32_bf16 v[72:75], a[96:99], a[192:195], 0
    ds_read_b128 v[16:19], v86 offset:16
    v_mfma_f32_16x16x32_bf16 v[76:79], a[144:147], a[192:195], 0
    s_waitcnt vmcnt(5)
    ds_read_b128 v[116:119], v86 offset:128
    ds_read_b128 v[124:127], v86 offset:144
    v_mfma_f32_16x16x32_bf16 v[60:63], v[180:183], a[196:199], v[60:63]
    s_nop 0
    v_mfma_f32_16x16x32_bf16 v[64:67], v[228:231], a[196:199], v[64:67]
    buffer_load_dwordx4 a[220:223], v3, s[4:7], s68 offen offset:3072 sc1
    v_mfma_f32_16x16x32_bf16 v[68:71], a[4:7], a[196:199], v[68:71]
    s_waitcnt lgkmcnt(3)
    s_add_u32 s68, s45, 1581056
    s_barrier
    v_mfma_f32_16x16x32_bf16 v[72:75], a[100:103], a[196:199], v[72:75]
    ds_read_b128 v[80:83], v12 offset:0
    ds_read_b128 v[84:87], v12 offset:256
    v_mfma_f32_16x16x32_bf16 v[76:79], a[148:151], a[196:199], v[76:79]
    s_waitcnt vmcnt(5)
    ds_read_b128 v[88:91], v12 offset:5120
    v_mfma_f32_16x16x32_bf16 v[60:63], v[184:187], a[200:203], v[60:63]
    buffer_load_dwordx4 a[224:227], v3, s[4:7], s68 offen offset:0 sc1
    v_mfma_f32_16x16x32_bf16 v[64:67], v[232:235], a[200:203], v[64:67]
    ds_read_b128 v[92:95], v12 offset:5376
    ds_read_b128 v[96:99], v12 offset:10240
    v_mfma_f32_16x16x32_bf16 v[68:71], a[8:11], a[200:203], v[68:71]
    ds_read_b128 v[100:103], v12 offset:10496
    v_mfma_f32_16x16x32_bf16 v[72:75], a[104:107], a[200:203], v[72:75]
    buffer_load_dwordx4 a[228:231], v3, s[4:7], s68 offen offset:1024 sc1
    v_mfma_f32_16x16x32_bf16 v[76:79], a[152:155], a[200:203], v[76:79]
    s_waitcnt vmcnt(6)
    buffer_load_dwordx4 a[232:235], v3, s[4:7], s68 offen offset:2048 sc1
    s_barrier
    s_cmp_lg_u32 s3, 3
    s_cbranch_scc1 L_nofh3
    s_atomic_swap s50, s[4:5], s41 offset:98304
L_nofh3:
    s_cmp_lg_u64 s[24:25], s[8:9]
    s_cbranch_scc1 L_slow7
    s_cmp_lg_u64 s[26:27], s[8:9]
    s_cbranch_scc1 L_slow7
L_back7:
    v_mfma_f32_16x16x32_bf16 v[60:63], v[188:191], a[204:207], v[60:63]
    buffer_load_dwordx4 a[236:239], v3, s[4:7], s68 offen offset:3072 sc1
    v_mfma_f32_16x16x32_bf16 v[64:67], v[236:239], a[204:207], v[64:67]
    s_add_u32 s68, s45, 3145728
    ds_read_b128 v[104:107], v12 offset:15360
    ds_read_b128 v[108:111], v12 offset:15616
    v_mfma_f32_16x16x32_bf16 v[68:71], a[12:15], a[204:207], v[68:71]
    s_waitcnt lgkmcnt(5)
    v_add_f32_e64 v80, v80, v88
    v_mfma_f32_16x16x32_bf16 v[72:75], a[108:111], a[204:207], v[72:75]
    v_mfma_f32_16x16x32_bf16 v[76:79], a[156:159], a[204:207], v[76:79]
    s_waitcnt vmcnt(7)
    v_mfma_f32_16x16x32_bf16 v[60:63], v[192:195], a[208:211], v[60:63]
    s_nop 0
    v_mfma_f32_16x16x32_bf16 v[64:67], a[240:243], a[208:211], v[64:67]
    ds_read_b32 v1, v3
    ds_read_b32 v1, v3
    s_waitcnt lgkmcnt(3)
    v_add_f32 v96, v96, v104
    v_add_f32 v81, v81, v89
    v_add_f32 v97, v97, v105
    v_add_f32_e64 v82, v82, v90
    v_mfma_f32_16x16x32_bf16 v[68:71], a[16:19], a[208:211], v[68:71]
    v_add_f32 v98, v98, v106
    v_add_f32 v83, v83, v91
    v_mfma_f32_16x16x32_bf16 v[72:75], a[112:115], a[208:211], v[72:75]
    v_add_f32 v99, v99, v107
    v_add_f32 v84, v84, v92
    v_mfma_f32_16x16x32_bf16 v[76:79], a[160:163], a[208:211], v[76:79]
    s_waitcnt vmcnt(6)
    buffer_load_dwordx4 v[128:131], v3, s[4:7], s68 offen offset:0 sc1
    v_mfma_f32_16x16x32_bf16 v[60:63], v[196:199], a[212:215], v[60:63]
    ds_read_b32 v1, v3
    s_waitcnt lgkmcnt(3)
    v_add_f32 v100, v100, v108
    v_add_f32 v85, v85, v93
    v_mfma_f32_16x16x32_bf16 v[64:67], a[244:247], a[212:215], v[64:67]
    buffer_load_dwordx4 v[132:135], v3, s[4:7], s68 offen offset:1024 sc1
    v_mfma_f32_16x16x32_bf16 v[68:71], a[20:23], a[212:215], v[68:71]
    v_add_f32 v101, v101, v109
    v_add_f32 v86, v86, v94
    v_mfma_f32_16x16x32_bf16 v[72:75], a[116:119], a[212:215], v[72:75]
    v_add_f32 v102, v102, v110
    v_add_f32 v87, v87, v95
    v_mfma_f32_16x16x32_bf16 v[76:79], a[164:167], a[212:215], v[76:79]
    s_waitcnt vmcnt(7)
    v_add_f32 v103, v103, v111
    v_add_f32_e64 v80, v80, v96
    v_mfma_f32_16x16x32_bf16 v[60:63], v[200:203], a[216:219], v[60:63]
    buffer_load_dwordx4 v[136:139], v3, s[4:7], s68 offen offset:2048 sc1
    v_mfma_f32_16x16x32_bf16 v[64:67], a[248:251], a[216:219], v[64:67]
    v_lshlrev_b32 v88, 16, v240
    v_mul_f32 v80, v80, v8
    v_mfma_f32_16x16x32_bf16 v[68:71], a[24:27], a[216:219], v[68:71]
    v_fmac_f32 v80, v88, v116
    v_add_f32 v81, v81, v97
    v_mfma_f32_16x16x32_bf16 v[72:75], a[120:123], a[216:219], v[72:75]
    v_and_b32 v89, 0xffff0000, v240
    v_mul_f32_e64 v81, v81, v9
    v_mfma_f32_16x16x32_bf16 v[76:79], a[168:171], a[216:219], v[76:79]
    s_waitcnt vmcnt(7)
    buffer_load_dwordx4 v[140:143], v3, s[4:7], s68 offen offset:3072 sc1
    v_mfma_f32_16x16x32_bf16 v[60:63], v[204:207], a[220:223], v[60:63]
    s_add_u32 s68, s45, 3149824
    v_fmac_f32 v81, v89, v117
    v_cvt_pk_bf16_f32 v112, v80, v81
    v_mfma_f32_16x16x32_bf16 v[64:67], a[252:255], a[220:223], v[64:67]
    v_add_f32 v82, v82, v98
    v_lshlrev_b32 v90, 16, v241
    v_mfma_f32_16x16x32_bf16 v[68:71], a[28:31], a[220:223], v[68:71]
    v_mul_f32 v82, v82, v10
    v_fmac_f32 v82, v90, v118
    v_mfma_f32_16x16x32_bf16 v[72:75], a[124:127], a[220:223], v[72:75]
    buffer_load_dwordx4 v[144:147], v3, s[4:7], s68 offen offset:0 sc1
    v_mfma_f32_16x16x32_bf16 v[76:79], a[172:175], a[220:223], v[76:79]
    s_waitcnt vmcnt(8)
    v_add_f32 v83, v83, v99
    v_and_b32 v91, 0xffff0000, v241
    v_mfma_f32_16x16x32_bf16 v[60:63], v[208:211], a[224:227], v[60:63]
    s_waitcnt vmcnt(7)
    v_mul_f32 v83, v83, v11
    v_fmac_f32_e64 v83, v91, v119
    v_mfma_f32_16x16x32_bf16 v[60:63], v[212:215], a[228:231], v[60:63]
    s_waitcnt vmcnt(6)
    buffer_load_dwordx4 v[148:151], v3, s[4:7], s68 offen offset:1024 sc1
    v_mfma_f32_16x16x32_bf16 v[60:63], v[216:219], a[232:235], v[60:63]
    s_waitcnt vmcnt(6)
    v_cvt_pk_bf16_f32 v113, v82, v83
    v_add_f32_e64 v84, v84, v100
    v_mfma_f32_16x16x32_bf16 v[60:63], v[220:223], a[236:239], v[60:63]
    v_lshlrev_b32 v92, 16, v242
    v_mul_f32 v84, v84, v16
    v_mfma_f32_16x16x32_bf16 v[64:67], v[20:23], a[224:227], v[64:67]
    v_fmac_f32 v84, v92, v124
    v_add_f32 v85, v85, v101
    v_mfma_f32_16x16x32_bf16 v[64:67], v[24:27], a[228:231], v[64:67]
    buffer_load_dwordx4 v[152:155], v3, s[4:7], s68 offen offset:2048 sc1
    v_mfma_f32_16x16x32_bf16 v[64:67], v[32:35], a[232:235], v[64:67]
    ds_write_b128 v13, v[60:63] offset:20480
    v_mfma_f32_16x16x32_bf16 v[64:67], v[36:39], a[236:239], v[64:67]
    v_and_b32 v93, 0xffff0000, v242
    v_mul_f32_e64 v85, v85, v17
    v_mfma_f32_16x16x32_bf16 v[68:71], a[32:35], a[224:227], v[68:71]
    buffer_load_dwordx4 v[156:159], v3, s[4:7], s68 offen offset:3072 sc1
    v_mfma_f32_16x16x32_bf16 v[68:71], a[36:39], a[228:231], v[68:71]
    s_add_u32 s68, s45, 3153920
    v_fmac_f32_e64 v85, v93, v125
    v_cvt_pk_bf16_f32 v114, v84, v85
    v_mfma_f32_16x16x32_bf16 v[68:71], a[40:43], a[232:235], v[68:71]
    ds_write_b128 v13, v[64:67] offset:21504
    v_mfma_f32_16x16x32_bf16 v[68:71], a[44:47], a[236:239], v[68:71]
    buffer_load_dwordx4 v[160:163], v3, s[4:7], s68 offen offset:0 sc1
    v_mfma_f32_16x16x32_bf16 v[72:75], a[128:131], a[224:227], v[72:75]
    v_add_f32 v86, v86, v102
    v_lshlrev_b32 v94, 16, v243
    v_mfma_f32_16x16x32_bf16 v[72:75], a[132:135], a[228:231], v[72:75]
    v_mul_f32 v86, v86, v18
    v_fmac_f32 v86, v94, v126
    v_mfma_f32_16x16x32_bf16 v[72:75], a[136:139], a[232:235], v[72:75]
    s_load_dwordx4 s[28:31], s[4:5], s39 offset:98304 glc
    ds_write_b128 v13, v[68:71] offset:22528
    v_mfma_f32_16x16x32_bf16 v[72:75], a[140:143], a[236:239], v[72:75]
    v_add_f32_e64 v87, v87, v103
    v_and_b32 v95, 0xffff0000, v243
    v_mfma_f32_16x16x32_bf16 v[76:79], a[176:179], a[224:227], v[76:79]
    buffer_load_dwordx4 v[164:167], v3, s[4:7], s68 offen offset:1024 sc1
    v_mfma_f32_16x16x32_bf16 v[76:79], a[180:183], a[228:231], v[76:79]
    v_mul_f32 v87, v87, v19
    v_fmac_f32 v87, v95, v127
    v_mfma_f32_16x16x32_bf16 v[76:79], a[184:187], a[232:235], v[76:79]
    ds_write_b128 v13, v[72:75] offset:23552
    v_mfma_f32_16x16x32_bf16 v[76:79], a[188:191], a[236:239], v[76:79]
    s_waitcnt vmcnt(9)
    v_cvt_pk_bf16_f32 v115, v86, v87
    s_mov_b32 s69, 0
    buffer_store_dwordx4 v[112:115], v6, s[12:15], s69 offen nt
    v_mfma_f32_16x16x32_bf16 v[40:43], v[176:179], v[128:131], 0
    v_mfma_f32_16x16x32_bf16 v[44:47], v[224:227], v[128:131], 0
    v_mfma_f32_16x16x32_bf16 v[48:51], a[0:3], v[128:131], 0
    ds_write_b128 v13, v[76:79] offset:24576
    v_mfma_f32_16x16x32_bf16 v[52:55], a[96:99], v[128:131], 0
    buffer_load_dwordx4 v[168:171], v3, s[4:7], s68 offen offset:2048 sc1
    v_mfma_f32_16x16x32_bf16 v[56:59], a[144:147], v[128:131], 0
    s_waitcnt vmcnt(10)
    v_mfma_f32_16x16x32_bf16 v[40:43], v[180:183], v[132:135], v[40:43]
    s_nop 0
    v_mfma_f32_16x16x32_bf16 v[44:47], v[228:231], v[132:135], v[44:47]
    buffer_load_dwordx4 v[172:175], v3, s[4:7], s68 offen offset:3072 sc1
    v_mfma_f32_16x16x32_bf16 v[48:51], a[4:7], v[132:135], v[48:51]
    ds_read_b32 v1, v3
    ds_read_b32 v1, v3
    ds_read_b32 v1, v3
    s_waitcnt lgkmcnt(3)
    s_barrier
    v_mfma_f32_16x16x32_bf16 v[52:55], a[100:103], v[132:135], v[52:55]
    ds_read_b128 v[80:83], v12 offset:20480
    ds_read_b128 v[84:87], v12 offset:20736
    v_mfma_f32_16x16x32_bf16 v[56:59], a[148:151], v[132:135], v[56:59]
    s_waitcnt vmcnt(10)
    ds_read_b128 v[88:91], v12 offset:25600
    ds_read_b128 v[92:95], v12 offset:25856
    v_mfma_f32_16x16x32_bf16 v[40:43], v[184:187], v[136:139], v[40:43]
    ds_read_b128 v[96:99], v12 offset:30720
    v_mfma_f32_16x16x32_bf16 v[44:47], v[232:235], v[136:139], v[44:47]
    ds_read_b128 v[100:103], v12 offset:30976
    v_mfma_f32_16x16x32_bf16 v[48:51], a[8:11], v[136:139], v[48:51]
    ds_read_b128 v[104:107], v12 offset:35840
    v_mfma_f32_16x16x32_bf16 v[52:55], a[104:107], v[136:139], v[52:55]
    ds_read_b128 v[108:111], v12 offset:36096
    v_mfma_f32_16x16x32_bf16 v[56:59], a[152:155], v[136:139], v[56:59]
    s_waitcnt vmcnt(9) lgkmcnt(5)
    v_add_f32_e64 v80, v80, v88
    v_mfma_f32_16x16x32_bf16 v[40:43], v[188:191], v[140:143], v[40:43]
    v_mfma_f32_16x16x32_bf16 v[44:47], v[236:239], v[140:143], v[44:47]
    v_mfma_f32_16x16x32_bf16 v[48:51], a[12:15], v[140:143], v[48:51]
    ds_read_b32 v1, v3
    s_waitcnt lgkmcnt(2)
    v_add_f32 v96, v96, v104
    v_add_f32_e64 v81, v81, v89
    v_mfma_f32_16x16x32_bf16 v[52:55], a[108:111], v[140:143], v[52:55]
    v_add_f32 v97, v97, v105
    v_add_f32 v82, v82, v90
    v_mfma_f32_16x16x32_bf16 v[56:59], a[156:159], v[140:143], v[56:59]
    s_waitcnt vmcnt(8)
    v_add_f32 v98, v98, v106
L_stub7:
    s_cbranch_execz L_tdone2
    v_add_f32 v83, v83, v91
    v_mfma_f32_16x16x32_bf16 v[40:43], v[192:195], v[144:147], v[40:43]
    v_add_f32 v99, v99, v107
    v_add_f32 v84, v84, v92
    v_mfma_f32_16x16x32_bf16 v[44:47], a[240:243], v[144:147], v[44:47]
    ds_read_b32 v1, v3
    s_waitcnt lgkmcnt(2)
    v_add_f32 v100, v100, v108
    v_add_f32_e64 v85, v85, v93
    v_mfma_f32_16x16x32_bf16 v[48:51], a[16:19], v[144:147], v[48:51]
    v_add_f32 v101, v101, v109
    v_add_f32 v86, v86, v94
    v_mfma_f32_16x16x32_bf16 v[52:55], a[112:115], v[144:147], v[52:55]
    v_add_f32 v102, v102, v110
    v_add_f32 v87, v87, v95
    v_mfma_f32_16x16x32_bf16 v[56:59], a[160:163], v[144:147], v[56:59]
    s_waitcnt vmcnt(7)
    s_cmp_lg_u64 s[28:29], s[8:9]
    s_cbranch_scc1 L_slow8
    s_cmp_lg_u64 s[30:31], s[8:9]
    s_cbranch_scc1 L_slow8
L_back8:
    v_mfma_f32_16x16x32_bf16 v[40:43], v[196:199], v[148:151], v[40:43]
    s_add_u32 s68, s45, 4718592
    buffer_load_dwordx4 a[48:51], v3, s[4:7], s68 offen offset:0 sc1
    v_mfma_f32_16x16x32_bf16 v[44:47], a[244:247], v[148:151], v[44:47]
    buffer_load_dwordx4 a[52:55], v3, s[4:7], s68 offen offset:1024 sc1
    v_mfma_f32_16x16x32_bf16 v[48:51], a[20:23], v[148:151], v[48:51]
    buffer_load_dwordx4 a[56:59], v3, s[4:7], s68 offen offset:2048 sc1
    v_mfma_f32_16x16x32_bf16 v[52:55], a[116:119], v[148:151], v[52:55]
    buffer_load_dwordx4 a[60:63], v3, s[4:7], s68 offen offset:3072 sc1
    v_mfma_f32_16x16x32_bf16 v[56:59], a[164:167], v[148:151], v[56:59]
    s_waitcnt vmcnt(10)
    s_add_u32 s68, s45, 4722688
    buffer_load_dwordx4 a[64:67], v3, s[4:7], s68 offen offset:0 sc1
    v_mfma_f32_16x16x32_bf16 v[40:43], v[200:203], v[152:155], v[40:43]
    v_add_f32 v103, v103, v111
    v_add_f32 v80, v80, v96
    v_mfma_f32_16x16x32_bf16 v[44:47], a[248:251], v[152:155], v[44:47]
    v_lshlrev_b32 v88, 16, v244
    v_mul_f32 v80, v80, v8
    v_mfma_f32_16x16x32_bf16 v[48:51], a[24:27], v[152:155], v[48:51]
    buffer_load_dwordx4 a[68:71], v3, s[4:7], s68 offen offset:1024 sc1
    v_mfma_f32_16x16x32_bf16 v[52:55], a[120:123], v[152:155], v[52:55]
    v_fmac_f32 v80, v88, v116
    v_add_f32 v81, v81, v97
    v_mfma_f32_16x16x32_bf16 v[56:59], a[168:171], v[152:155], v[56:59]
    s_waitcnt vmcnt(11)
    buffer_load_dwordx4 a[72:75], v3, s[4:7], s68 offen offset:2048 sc1
    v_mfma_f32_16x16x32_bf16 v[40:43], v[204:207], v[156:159], v[40:43]
    v_and_b32 v89, 0xffff0000, v244
    v_mul_f32 v81, v81, v9
    v_mfma_f32_16x16x32_bf16 v[44:47], a[252:255], v[156:159], v[44:47]
    v_fmac_f32_e64 v81, v89, v117
    v_cvt_pk_bf16_f32 v112, v80, v81
    v_mfma_f32_16x16x32_bf16 v[48:51], a[28:31], v[156:159], v[48:51]
    buffer_load_dwordx4 a[76:79], v3, s[4:7], s68 offen offset:3072 sc1
    v_mfma_f32_16x16x32_bf16 v[52:55], a[124:127], v[156:159], v[52:55]
    s_add_u32 s68, s45, 4726784
    v_add_f32 v82, v82, v98
    v_lshlrev_b32 v90, 16, v245
    v_mfma_f32_16x16x32_bf16 v[56:59], a[172:175], v[156:159], v[56:59]
    s_waitcnt vmcnt(12)
    v_mul_f32 v82, v82, v10
    v_fmac_f32_e64 v82, v90, v118
    v_mfma_f32_16x16x32_bf16 v[40:43], v[208:211], v[160:163], v[40:43]
    s_waitcnt vmcnt(11)
    buffer_load_dwordx4 a[80:83], v3, s[4:7], s68 offen offset:0 sc1
    v_mfma_f32_16x16x32_bf16 v[40:43], v[212:215], v[164:167], v[40:43]
    s_waitcnt vmcnt(10)
    v_add_f32_e64 v83, v83, v99
    v_and_b32 v91, 0xffff0000, v245
    v_mfma_f32_16x16x32_bf16 v[40:43], v[216:219], v[168:171], v[40:43]
    s_waitcnt vmcnt(9)
    v_mul_f32 v83, v83, v11
    v_fmac_f32_e64 v83, v91, v119
    v_mfma_f32_16x16x32_bf16 v[40:43], v[220:223], v[172:175], v[40:43]
    buffer_load_dwordx4 a[84:87], v3, s[4:7], s68 offen offset:1024 sc1
    v_mfma_f32_16x16x32_bf16 v[44:47], v[20:23], v[160:163], v[44:47]
    v_cvt_pk_bf16_f32 v113, v82, v83
    v_add_f32_e64 v84, v84, v100
    v_mfma_f32_16x16x32_bf16 v[44:47], v[24:27], v[164:167], v[44:47]
    v_lshlrev_b32 v92, 16, v246
    v_mul_f32 v84, v84, v16
    v_mfma_f32_16x16x32_bf16 v[44:47], v[32:35], v[168:171], v[44:47]
    ds_write_b128 v13, v[40:43] offset:0
    v_mfma_f32_16x16x32_bf16 v[44:47], v[36:39], v[172:175], v[44:47]
    v_fmac_f32 v84, v92, v124
    v_add_f32 v85, v85, v101
    v_mfma_f32_16x16x32_bf16 v[48:51], a[32:35], v[160:163], v[48:51]
    buffer_load_dwordx4 a[88:91], v3, s[4:7], s68 offen offset:2048 sc1
    v_mfma_f32_16x16x32_bf16 v[48:51], a[36:39], v[164:167], v[48:51]
    v_and_b32 v93, 0xffff0000, v246
    v_mul_f32_e64 v85, v85, v17
    v_mfma_f32_16x16x32_bf16 v[48:51], a[40:43], v[168:171], v[48:51]
    ds_write_b128 v13, v[44:47] offset:1024
    v_mfma_f32_16x16x32_bf16 v[48:51], a[44:47], v[172:175], v[48:51]
    v_fmac_f32_e64 v85, v93, v125
    v_cvt_pk_bf16_f32 v114, v84, v85
    v_mfma_f32_16x16x32_bf16 v[52:55], a[128:131], v[160:163], v[52:55]
    v_add_f32 v86, v86, v102
    v_lshlrev_b32 v94, 16, v247
    v_mfma_f32_16x16x32_bf16 v[52:55], a[132:135], v[164:167], v[52:55]
    buffer_load_dwordx4 a[92:95], v3, s[4:7], s68 offen offset:3072 sc1
    v_mfma_f32_16x16x32_bf16 v[52:55], a[136:139], v[168:171], v[52:55]
    ds_write_b128 v13, v[48:51] offset:2048
    v_mul_f32_e64 v86, v86, v18
    v_mfma_f32_16x16x32_bf16 v[52:55], a[140:143], v[172:175], v[52:55]
    v_fmac_f32 v86, v94, v126
    v_add_f32 v87, v87, v103
    v_mfma_f32_16x16x32_bf16 v[56:59], a[176:179], v[160:163], v[56:59]
    v_and_b32 v95, 0xffff0000, v247
    v_mul_f32_e64 v87, v87, v19
    v_mfma_f32_16x16x32_bf16 v[56:59], a[180:183], v[164:167], v[56:59]
    v_fmac_f32_e64 v87, v95, v127
    v_cvt_pk_bf16_f32 v115, v86, v87
    v_mfma_f32_16x16x32_bf16 v[56:59], a[184:187], v[168:171], v[56:59]
    ds_write_b128 v13, v[52:55] offset:3072
    v_mfma_f32_16x16x32_bf16 v[56:59], a[188:191], v[172:175], v[56:59]
    s_waitcnt vmcnt(11)
    s_mov_b32 s69, 655360
    buffer_store_dwordx4 v[112:115], v6, s[12:15], s69 offen nt
    v_mfma_f32_16x16x32_bf16 v[60:63], v[176:179], a[48:51], 0
    s_nop 0
    v_mfma_f32_16x16x32_bf16 v[64:67], v[224:227], a[48:51], 0
    v_mfma_f32_16x16x32_bf16 v[68:71], a[0:3], a[48:51], 0
    ds_write_b128 v13, v[56:59] offset:4096
    v_mfma_f32_16x16x32_bf16 v[72:75], a[96:99], a[48:51], 0
    v_mfma_f32_16x16x32_bf16 v[76:79], a[144:147], a[48:51], 0
    s_waitcnt vmcnt(11)
    v_mfma_f32_16x16x32_bf16 v[60:63], v[180:183], a[52:55], v[60:63]
    v_mfma_f32_16x16x32_bf16 v[64:67], v[228:231], a[52:55], v[64:67]
    v_mfma_f32_16x16x32_bf16 v[68:71], a[4:7], a[52:55], v[68:71]
    s_waitcnt lgkmcnt(0)
    s_barrier
    v_mfma_f32_16x16x32_bf16 v[72:75], a[100:103], a[52:55], v[72:75]
    ds_read_b128 v[80:83], v12 offset:0
    ds_read_b128 v[84:87], v12 offset:256
    v_mfma_f32_16x16x32_bf16 v[76:79], a[148:151], a[52:55], v[76:79]
    s_waitcnt vmcnt(10)
    ds_read_b128 v[88:91], v12 offset:5120
    ds_read_b128 v[92:95], v12 offset:5376
    v_mfma_f32_16x16x32_bf16 v[60:63], v[184:187], a[56:59], v[60:63]
    ds_read_b128 v[96:99], v12 offset:10240
    v_mfma_f32_16x16x32_bf16 v[64:67], v[232:235], a[56:59], v[64:67]
    ds_read_b128 v[100:103], v12 offset:10496
    v_mfma_f32_16x16x32_bf16 v[68:71], a[8:11], a[56:59], v[68:71]
    ds_read_b128 v[104:107], v12 offset:15360
    v_mfma_f32_16x16x32_bf16 v[72:75], a[104:107], a[56:59], v[72:75]
    ds_read_b128 v[108:111], v12 offset:15616
    v_mfma_f32_16x16x32_bf16 v[76:79], a[152:155], a[56:59], v[76:79]
    s_waitcnt vmcnt(9) lgkmcnt(5)
    v_add_f32 v80, v80, v88
    v_mfma_f32_16x16x32_bf16 v[60:63], v[188:191], a[60:63], v[60:63]
    v_mfma_f32_16x16x32_bf16 v[64:67], v[236:239], a[60:63], v[64:67]
    v_mfma_f32_16x16x32_bf16 v[68:71], a[12:15], a[60:63], v[68:71]
    s_waitcnt lgkmcnt(1)
    v_add_f32 v96, v96, v104
    v_add_f32_e64 v81, v81, v89
    v_mfma_f32_16x16x32_bf16 v[72:75], a[108:111], a[60:63], v[72:75]
    v_add_f32 v97, v97, v105
    v_add_f32 v82, v82, v90
    v_mfma_f32_16x16x32_bf16 v[76:79], a[156:159], a[60:63], v[76:79]
    s_waitcnt vmcnt(8)
    v_add_f32 v98, v98, v106
    v_add_f32_e64 v83, v83, v91
    v_mfma_f32_16x16x32_bf16 v[60:63], v[192:195], a[64:67], v[60:63]
    v_add_f32 v99, v99, v107
    v_add_f32 v84, v84, v92
    v_mfma_f32_16x16x32_bf16 v[64:67], a[240:243], a[64:67], v[64:67]
    s_waitcnt lgkmcnt(0)
    v_add_f32 v100, v100, v108
    v_add_f32_e64 v85, v85, v93
    v_mfma_f32_16x16x32_bf16 v[68:71], a[16:19], a[64:67], v[68:71]
    v_add_f32 v101, v101, v109
    v_add_f32 v86, v86, v94
    v_mfma_f32_16x16x32_bf16 v[72:75], a[112:115], a[64:67], v[72:75]
    v_add_f32 v102, v102, v110
    v_add_f32 v87, v87, v95
    v_mfma_f32_16x16x32_bf16 v[76:79], a[160:163], a[64:67], v[76:79]
    s_waitcnt vmcnt(7)
    v_add_f32 v103, v103, v111
    v_add_f32_e64 v80, v80, v96
    v_mfma_f32_16x16x32_bf16 v[60:63], v[196:199], a[68:71], v[60:63]
    v_lshlrev_b32 v88, 16, v248
    v_mul_f32 v80, v80, v8
    v_mfma_f32_16x16x32_bf16 v[64:67], a[244:247], a[68:71], v[64:67]
    v_fmac_f32 v80, v88, v116
    v_add_f32 v81, v81, v97
    v_mfma_f32_16x16x32_bf16 v[68:71], a[20:23], a[68:71], v[68:71]
    v_and_b32 v89, 0xffff0000, v248
    v_mul_f32_e64 v81, v81, v9
    v_mfma_f32_16x16x32_bf16 v[72:75], a[116:119], a[68:71], v[72:75]
    v_fmac_f32_e64 v81, v89, v117
    v_cvt_pk_bf16_f32 v112, v80, v81
    v_mfma_f32_16x16x32_bf16 v[76:79], a[164:167], a[68:71], v[76:79]
    s_waitcnt vmcnt(6)
    v_add_f32 v82, v82, v98
    v_lshlrev_b32_e64 v90, 16, v249
    v_mfma_f32_16x16x32_bf16 v[60:63], v[200:203], a[72:75], v[60:63]
    v_mul_f32 v82, v82, v10
    v_fmac_f32 v82, v90, v118
    v_mfma_f32_16x16x32_bf16 v[64:67], a[248:251], a[72:75], v[64:67]
    v_add_f32_e64 v83, v83, v99
    v_and_b32 v91, 0xffff0000, v249
    v_mfma_f32_16x16x32_bf16 v[68:71], a[24:27], a[72:75], v[68:71]
    v_mul_f32 v83, v83, v11
    v_fmac_f32 v83, v91, v119
    v_mfma_f32_16x16x32_bf16 v[72:75], a[120:123], a[72:75], v[72:75]
    v_cvt_pk_bf16_f32 v113, v82, v83
    v_add_f32_e64 v84, v84, v100
    v_mfma_f32_16x16x32_bf16 v[76:79], a[168:171], a[72:75], v[76:79]
    s_waitcnt vmcnt(5)
    v_lshlrev_b32 v92, 16, v250
    v_mul_f32_e64 v84, v84, v16
    v_mfma_f32_16x16x32_bf16 v[60:63], v[204:207], a[76:79], v[60:63]
    v_fmac_f32 v84, v92, v124
    v_add_f32 v85, v85, v101
    v_mfma_f32_16x16x32_bf16 v[64:67], a[252:255], a[76:79], v[64:67]
    v_and_b32 v93, 0xffff0000, v250
    v_mul_f32_e64 v85, v85, v17
    v_mfma_f32_16x16x32_bf16 v[68:71], a[28:31], a[76:79], v[68:71]
    v_fmac_f32_e64 v85, v93, v125
    v_cvt_pk_bf16_f32 v114, v84, v85
    v_mfma_f32_16x16x32_bf16 v[72:75], a[124:127], a[76:79], v[72:75]
    v_add_f32 v86, v86, v102
    v_lshlrev_b32 v94, 16, v251
    v_mfma_f32_16x16x32_bf16 v[76:79], a[172:175], a[76:79], v[76:79]
    s_waitcnt vmcnt(4)
    v_mul_f32 v86, v86, v18
    v_fmac_f32_e64 v86, v94, v126
    v_mfma_f32_16x16x32_bf16 v[60:63], v[208:211], a[80:83], v[60:63]
    s_waitcnt vmcnt(3)
    v_add_f32 v87, v87, v103
    v_and_b32 v95, 0xffff0000, v251
    v_mfma_f32_16x16x32_bf16 v[60:63], v[212:215], a[84:87], v[60:63]
    s_waitcnt vmcnt(2)
    v_mul_f32 v87, v87, v19
    v_fmac_f32_e64 v87, v95, v127
    v_mfma_f32_16x16x32_bf16 v[60:63], v[216:219], a[88:91], v[60:63]
    s_waitcnt vmcnt(1)
    v_cvt_pk_bf16_f32 v115, v86, v87
    v_mfma_f32_16x16x32_bf16 v[60:63], v[220:223], a[92:95], v[60:63]
    v_mfma_f32_16x16x32_bf16 v[64:67], v[20:23], a[80:83], v[64:67]
    v_lshlrev_b32 v40, 16, v252
    v_and_b32 v41, 0xffff0000, v252
    v_mfma_f32_16x16x32_bf16 v[64:67], v[24:27], a[84:87], v[64:67]
    v_mul_f32 v40, v40, v116
    v_mul_f32 v41, v41, v117
    v_mfma_f32_16x16x32_bf16 v[64:67], v[32:35], a[88:91], v[64:67]
    ds_write_b128 v13, v[60:63] offset:20480
    v_mfma_f32_16x16x32_bf16 v[64:67], v[36:39], a[92:95], v[64:67]
    s_mov_b32 s69, 1310720
    buffer_store_dwordx4 v[112:115], v6, s[12:15], s69 offen nt
    v_lshlrev_b32_e64 v42, 16, v253
    v_and_b32 v43, 0xffff0000, v253
    v_mfma_f32_16x16x32_bf16 v[68:71], a[32:35], a[80:83], v[68:71]
    v_mul_f32 v42, v42, v118
    v_mul_f32 v43, v43, v119
    v_mfma_f32_16x16x32_bf16 v[68:71], a[36:39], a[84:87], v[68:71]
    v_lshlrev_b32_e64 v44, 16, v254
    v_and_b32 v45, 0xffff0000, v254
    v_mfma_f32_16x16x32_bf16 v[68:71], a[40:43], a[88:91], v[68:71]
    ds_write_b128 v13, v[64:67] offset:21504
    v_mfma_f32_16x16x32_bf16 v[68:71], a[44:47], a[92:95], v[68:71]
    v_mul_f32 v44, v44, v124
    v_mul_f32 v45, v45, v125
    v_mfma_f32_16x16x32_bf16 v[72:75], a[128:131], a[80:83], v[72:75]
    v_lshlrev_b32_e64 v46, 16, v255
    v_and_b32 v47, 0xffff0000, v255
    v_mfma_f32_16x16x32_bf16 v[72:75], a[132:135], a[84:87], v[72:75]
    v_mul_f32 v46, v46, v126
    v_mul_f32 v47, v47, v127
    v_mfma_f32_16x16x32_bf16 v[72:75], a[136:139], a[88:91], v[72:75]
    ds_write_b128 v13, v[68:71] offset:22528
    v_mfma_f32_16x16x32_bf16 v[72:75], a[140:143], a[92:95], v[72:75]
    v_mfma_f32_16x16x32_bf16 v[76:79], a[176:179], a[80:83], v[76:79]
    v_mfma_f32_16x16x32_bf16 v[76:79], a[180:183], a[84:87], v[76:79]
    v_mfma_f32_16x16x32_bf16 v[76:79], a[184:187], a[88:91], v[76:79]
    ds_write_b128 v13, v[72:75] offset:23552
    v_mfma_f32_16x16x32_bf16 v[76:79], a[188:191], a[92:95], v[76:79]
    s_nop 7
    ds_write_b128 v13, v[76:79] offset:24576
    s_waitcnt lgkmcnt(0)
    s_barrier
    s_nop 0
    ds_read_b128 v[80:83], v12 offset:20480
    ds_read_b128 v[84:87], v12 offset:20736
    ds_read_b128 v[88:91], v12 offset:25600
    ds_read_b128 v[92:95], v12 offset:25856
    ds_read_b128 v[96:99], v12 offset:30720
    ds_read_b128 v[100:103], v12 offset:30976
    ds_read_b128 v[104:107], v12 offset:35840
    ds_read_b128 v[108:111], v12 offset:36096
    s_waitcnt lgkmcnt(5)
    v_pk_add_f32 v[80:81], v[80:81], v[88:89]
    v_pk_add_f32 v[82:83], v[82:83], v[90:91]
    s_waitcnt lgkmcnt(4)
    v_pk_add_f32 v[84:85], v[84:85], v[92:93]
    v_pk_add_f32 v[86:87], v[86:87], v[94:95]
    s_waitcnt lgkmcnt(3)
    v_pk_add_f32 v[80:81], v[80:81], v[96:97]
    v_pk_add_f32 v[82:83], v[82:83], v[98:99]
    s_waitcnt lgkmcnt(2)
    v_pk_add_f32 v[84:85], v[84:85], v[100:101]
    v_pk_add_f32 v[86:87], v[86:87], v[102:103]
    s_waitcnt lgkmcnt(1)
    s_nop 0
    v_pk_add_f32 v[80:81], v[80:81], v[104:105]
    v_pk_fma_f32 v[80:81], v[80:81], v[8:9], v[40:41]
    v_cvt_pk_bf16_f32 v112, v80, v81
    v_pk_add_f32 v[82:83], v[82:83], v[106:107]
    v_pk_fma_f32 v[82:83], v[82:83], v[10:11], v[42:43]
    v_cvt_pk_bf16_f32 v113, v82, v83
    s_waitcnt lgkmcnt(0)
    s_nop 0
    v_pk_add_f32 v[84:85], v[84:85], v[108:109]
    v_pk_fma_f32 v[84:85], v[84:85], v[16:17], v[44:45]
    v_cvt_pk_bf16_f32 v114, v84, v85
    v_pk_add_f32 v[86:87], v[86:87], v[110:111]
    v_pk_fma_f32 v[86:87], v[86:87], v[18:19], v[46:47]
    v_cvt_pk_bf16_f32 v115, v86, v87
    s_mov_b32 s69, 1966080
    buffer_store_dwordx4 v[112:115], v6, s[12:15], s69 offen nt
    s_or_b32 s58, s2, s3
    s_cbranch_scc1 L_noep
    s_atomic_swap s50, s[4:5], 0
L_noep:
    s_endpgm
L_slow0:
    s_sub_u32 s55, s55, 1
    s_cbranch_scc1 L_giveup0
    s_sleep 2
    buffer_load_dwordx2 v[56:57], v29, s[4:7], 0 offen sc1
    s_waitcnt vmcnt(0)
    v_cmp_ne_u32 vcc, s50, v57
    s_cbranch_vccnz L_slow0
    s_branch L_back0
L_giveup0:
    s_mov_b32 s55, 0
    s_branch L_back0
L_slow1:
    s_sub_u32 s55, s55, 1
    s_cbranch_scc1 L_giveup1
    s_sleep 2
    buffer_load_dword v58, v28, s[4:7], 0 offen sc1
    s_waitcnt vmcnt(0)
    v_cmp_ne_u32 vcc, s50, v58
    s_cbranch_vccnz L_slow1
    s_branch L_back1
L_giveup1:
    s_mov_b32 s55, 0
    s_branch L_back1
L_slow2:
    s_sub_u32 s55, s55, 1
    s_cbranch_scc1 L_giveup2
    s_sleep 2
    buffer_load_dword v4, v6, s[4:7], 0 offen sc1
    s_waitcnt vmcnt(0)
    v_cmp_ne_u32 vcc, s50, v4
    s_cbranch_vccnz L_slow2
    s_branch L_back2
L_giveup2:
    s_mov_b32 s55, 0
    s_branch L_back2
L_slow3:
    s_sub_u32 s55, s55, 1
    s_cbranch_scc1 L_giveup3
    s_sleep 2
    s_mov_b32 s63, 0
    buffer_load_dword v31, v4, s[4:7], s63 offen sc1
    s_waitcnt vmcnt(0)
    v_cmp_ne_u32 vcc, s50, v31
    s_cbranch_vccnz L_slow3
    s_branch L_back3
L_giveup3:
    s_mov_b32 s55, 0
    s_branch L_back3
L_slow4:
    s_sub_u32 s55, s55, 1
    s_cbranch_scc1 L_giveup4
    s_sleep 2
    buffer_load_dwordx4 v[88:91], v3, s[4:7], s77 offen sc1
    buffer_load_dwordx4 v[92:95], v5, s[4:7], s49 offen sc1
    s_waitcnt vmcnt(0)
    v_xor_b32_e64 v224, v91, v95
    v_sad_u32 v224, v91, s50, v224 clamp
    v_cmp_ne_u32 vcc, 0, v224
    s_cbranch_vccnz L_slow4
    s_branch L_back4
L_giveup4:
    s_mov_b32 s55, 0
    s_branch L_back4
L_again5:
    s_sub_u32 s55, s55, 1
    s_cbranch_scc1 L_giveup5
    s_load_dwordx4 s[16:19], s[4:5], s39 offset:0 glc
L_slow5:
    s_waitcnt lgkmcnt(0)
    s_cmp_lg_u64 s[16:17], s[8:9]
    s_cbranch_scc1 L_again5
    s_cmp_lg_u64 s[18:19], s[8:9]
    s_cbranch_scc1 L_again5
    s_branch L_back5
L_giveup5:
    s_mov_b32 s55, 0
    s_branch L_back5
L_again6:
    s_sub_u32 s55, s55, 1
    s_cbranch_scc1 L_giveup6
    s_load_dwordx4 s[20:23], s[4:5], s39 offset:32768 glc
L_slow6:
    s_waitcnt lgkmcnt(0)
    s_cmp_lg_u64 s[20:21], s[8:9]
    s_cbranch_scc1 L_again6
    s_cmp_lg_u64 s[22:23], s[8:9]
    s_cbranch_scc1 L_again6
    s_branch L_back6
L_giveup6:
    s_mov_b32 s55, 0
    s_branch L_back6
L_again7:
    s_sub_u32 s55, s55, 1
    s_cbranch_scc1 L_giveup7
    s_load_dwordx4 s[24:27], s[4:5], s39 offset:65536 glc
L_slow7:
    s_waitcnt lgkmcnt(0)
    s_cmp_lg_u64 s[24:25], s[8:9]
    s_cbranch_scc1 L_again7
    s_cmp_lg_u64 s[26:27], s[8:9]
    s_cbranch_scc1 L_again7
    s_branch L_back7
L_giveup7:
    s_mov_b32 s55, 0
    s_branch L_back7
L_again8:
    s_sub_u32 s55, s55, 1
    s_cbranch_scc1 L_giveup8
    s_load_dwordx4 s[28:31], s[4:5], s39 offset:98304 glc
L_slow8:
    s_waitcnt lgkmcnt(0)
    s_cmp_lg_u64 s[28:29], s[8:9]
    s_cbranch_scc1 L_again8
    s_cmp_lg_u64 s[30:31], s[8:9]
    s_cbranch_scc1 L_again8
    s_branch L_back8
L_giveup8:
    s_mov_b32 s55, 0
    s_branch L_back8
L_slow9:
    s_sub_u32 s55, s55, 1
    s_cbranch_scc1 L_giveup9
    s_sleep 2
    buffer_load_dwordx4 v[228:231], v236, s[4:7], 0 offen sc1
    s_waitcnt vmcnt(0)
    v_xor_b32 v225, v228, v229
    v_sad_u32 v225, v228, v230, v225 clamp
    v_sad_u32 v225, v228, v231, v225 clamp
    v_sad_u32 v225, v228, s50, v225 clamp
    v_cmp_ne_u32 vcc, 0, v225
    s_cbranch_vccnz L_slow9
    s_branch L_back9
L_giveup9:
    s_mov_b32 s55, 0
    s_branch L_back9
L_slow10:
    s_sub_u32 s55, s55, 1
    s_cbranch_scc1 L_giveup10
    s_sleep 2
    buffer_load_dwordx2 v[232:233], v227, s[4:7], s64 offen sc1
    buffer_load_dwordx2 v[234:235], v227, s[4:7], s65 offen sc1
    s_waitcnt vmcnt(0)
    v_xor_b32 v226, v233, v235
    v_sad_u32 v226, v233, s50, v226 clamp
    v_cmp_ne_u32 vcc, 0, v226
    s_cbranch_vccnz L_slow10
    s_branch L_back10
L_giveup10:
    s_mov_b32 s55, 0
    s_branch L_back10
L_slow11:
    s_sub_u32 s55, s55, 1
    s_cbranch_scc1 L_giveup11
    s_sleep 2
    s_mov_b32 s63, 20480
    buffer_load_dword v192, v4, s[4:7], s63 offen sc1
    s_waitcnt vmcnt(0)
    v_cmp_ne_u32 vcc, s50, v192
    s_cbranch_vccnz L_slow11
    s_branch L_back11
L_giveup11:
    s_mov_b32 s55, 0
    s_branch L_back11
L_slow12:
    s_sub_u32 s55, s55, 1
    s_cbranch_scc1 L_giveup12
    s_sleep 2
    s_mov_b32 s63, 40960
    buffer_load_dword v192, v4, s[4:7], s63 offen sc1
    s_waitcnt vmcnt(0)
    v_cmp_ne_u32 vcc, s50, v192
    s_cbranch_vccnz L_slow12
    s_branch L_back12
L_giveup12:
    s_mov_b32 s55, 0
    s_branch L_back12
L_slow13:
    s_sub_u32 s55, s55, 1
    s_cbranch_scc1 L_giveup13
    s_sleep 2
    s_add_u32 s63, s37, 0
    buffer_load_dwordx2 v[10:11], v19, s[4:7], s63 offen sc1
    s_waitcnt vmcnt(0)
    v_cmp_ne_u32 vcc, s50, v11
    s_cbranch_vccnz L_slow13
    s_branch L_back13
L_giveup13:
    s_mov_b32 s55, 0
    s_branch L_back13
L_slow14:
    s_sub_u32 s55, s55, 1
    s_cbranch_scc1 L_giveup14
    s_sleep 2
    s_add_u32 s63, s37, 4096
    buffer_load_dwordx2 v[10:11], v19, s[4:7], s63 offen sc1
    s_waitcnt vmcnt(0)
    v_cmp_ne_u32 vcc, s50, v11
    s_cbranch_vccnz L_slow14
    s_branch L_back14
L_giveup14:
    s_mov_b32 s55, 0
    s_branch L_back14
L_slow15:
    s_sub_u32 s55, s55, 1
    s_cbranch_scc1 L_giveup15
    s_sleep 2
    s_add_u32 s63, s37, 8192
    buffer_load_dwordx2 v[10:11], v19, s[4:7], s63 offen sc1
    s_waitcnt vmcnt(0)
    v_cmp_ne_u32 vcc, s50, v11
    s_cbranch_vccnz L_slow15
    s_branch L_back15
L_giveup15:
    s_mov_b32 s55, 0
    s_branch L_back15
L_slow16:
    s_sub_u32 s55, s55, 1
    s_cbranch_scc1 L_giveup16
    s_sleep 2
    s_mov_b32 s63, 61440
    buffer_load_dword v192, v4, s[4:7], s63 offen sc1
    s_waitcnt vmcnt(0)
    v_cmp_ne_u32 vcc, s50, v192
    s_cbranch_vccnz L_slow16
    s_branch L_back16
L_giveup16:
    s_mov_b32 s55, 0
    s_branch L_back16
L_slow17:
    s_sub_u32 s55, s55, 1
    s_cbranch_scc1 L_giveup17
    s_sleep 2
    s_add_u32 s63, s37, 12288
    buffer_load_dwordx2 v[10:11], v19, s[4:7], s63 offen sc1
    s_waitcnt vmcnt(0)
    v_cmp_ne_u32 vcc, s50, v11
    s_cbranch_vccnz L_slow17
    s_branch L_back17
L_giveup17:
    s_mov_b32 s55, 0
    s_branch L_back17
L_spare:
    s_mov_b64 exec, 0
    s_cmp_eq_u32 s3, 0
    s_cbranch_scc1 L_s0
    s_cmp_eq_u32 s3, 1
    s_cbranch_scc1 L_s1
    s_cmp_eq_u32 s3, 2
    s_cbranch_scc1 L_s2
    s_branch L_s3
L_s0:
    s_mov_b64 exec, -1
    v_lshrrev_b32_e64 v112, 4, v2
    v_bfe_u32 v113, v2, 2, 2
    v_lshlrev_b32_e64 v114, 10, v112
    v_lshl_add_u32 v114, v113, 7, v114
    v_and_b32 v112, 1, v112
    v_lshrrev_b32 v113, 1, v113
    v_lshl_or_b32 v112, v112, 1, v113
    v_lshl_add_u32 v114, v112, 5, v114
    v_and_b32_e64 v112, 3, v2
    v_lshl_add_u32 v112, v112, 3, v114
    v_add_u32 v112, s66, v112
    v_xor_b32 v113, 32, v112
    v_xor_b32_e64 v114, 64, v112
    v_xor_b32 v115, 96, v112
    s_waitcnt lgkmcnt(0)
    s_mul_i32 s50, s67, 1664525
    s_add_u32 s50, s50, 1013904223
    s_lshl_b32 s58, s3, 5
    v_subrev_u32 v57, s66, v112
    v_xor_b32 v57, s58, v57
    v_add_u32 v56, 122880, v57
    v_lshrrev_b32 v58, 4, v2
    v_lshlrev_b32 v58, 4, v58
    v_add_u32 v51, 111104, v58
    v_lshlrev_b32_e64 v59, 3, v2
    v_mov_b32 v43, 2130706432
    v_cmp_gt_u32_e64 vcc, 16, v2
    v_add_u32 v42, 111104, v12
    s_mov_b32 s65, -1
    v_cndmask_b32 v59, v43, v59, vcc
    s_waitcnt vmcnt(1)
    v_lshlrev_b32 v32, 16, v200
    v_and_b32 v33, 0xffff0000, v200
    v_lshlrev_b32_e64 v34, 16, v201
    v_and_b32 v35, 0xffff0000, v201
    v_mul_f32 v36, 0xbfb8aa3b, v32
    v_mul_f32 v37, 0xbfb8aa3b, v33
    v_mul_f32 v38, 0xbfb8aa3b, v34
    v_mul_f32 v39, 0xbfb8aa3b, v35
    v_exp_f32 v36, v36
    v_exp_f32 v37, v37
    v_exp_f32 v38, v38
    v_exp_f32 v39, v39
    v_add_f32 v36, 1.0, v36
    v_add_f32 v37, 1.0, v37
    v_add_f32 v38, 1.0, v38
    v_add_f32 v39, 1.0, v39
    v_rcp_f32 v36, v36
    v_rcp_f32 v37, v37
    v_rcp_f32 v38, v38
    v_rcp_f32 v39, v39
    v_mul_f32 v32, v32, v36
    v_mul_f32 v33, v33, v37
    v_mul_f32 v34, v34, v38
    v_mul_f32 v35, v35, v39
    v_cvt_pk_bf16_f32 v32, v32, v33
    v_cvt_pk_bf16_f32 v33, v34, v35
    ds_write_b64 v42, v[32:33]
    s_add_u32 m0, s73, 1024
    s_add_u32 s72, s72, 61440
    buffer_load_dwordx4 v111, s[28:31], s72 offen nt lds
    s_add_u32 m0, s73, 2048
    s_add_u32 s72, s72, 61440
    buffer_load_dwordx4 v110, s[28:31], s72 offen nt lds
    s_add_u32 m0, s73, 3072
    s_add_u32 s72, s72, 61440
    buffer_load_dwordx4 v111, s[28:31], s72 offen nt lds
    s_add_u32 m0, s73, 4096
    s_add_u32 s72, s72, 61440
    buffer_load_dwordx4 v110, s[28:31], s72 offen nt lds
    s_add_u32 m0, s73, 5120
    s_add_u32 s72, s72, 61440
    buffer_load_dwordx4 v111, s[28:31], s72 offen nt lds
    s_add_u32 m0, s73, 6144
    s_add_u32 s72, s72, 61440
    buffer_load_dwordx4 v110, s[28:31], s72 offen nt lds
    s_add_u32 m0, s73, 7168
    s_add_u32 s72, s72, 61440
    buffer_load_dwordx4 v111, s[28:31], s72 offen nt lds
    s_add_u32 m0, s73, 8192
    s_add_u32 s72, s72, 61440
    buffer_load_dwordx4 v110, s[28:31], s72 offen nt lds
    s_add_u32 m0, s73, 9216
    s_add_u32 s72, s72, 61440
    buffer_load_dwordx4 v111, s[28:31], s72 offen nt lds
    s_cmp_lt_u32 s52, 23
    s_cbranch_scc1 L_sp_a
    s_and_b32 s58, s70, 1
    s_mul_i32 s58, s58, 640
    v_add_u32 v58, s58, v51
    s_waitcnt vmcnt(0)
    s_waitcnt lgkmcnt(0)
    s_barrier
    s_nop 0
    ds_read_b64_tr_b16 v[128:129], v57 offset:0
    ds_read_b64_tr_b16 v[130:131], v57 offset:512
    ds_read_b128 v[132:135], v58 offset:0
    ds_read_b64_tr_b16 v[136:137], v57 offset:4096
    ds_read_b64_tr_b16 v[138:139], v57 offset:4608
    ds_read_b128 v[140:143], v58 offset:64
    ds_read_b64_tr_b16 v[144:145], v57 offset:8192
    ds_read_b64_tr_b16 v[146:147], v57 offset:8704
    ds_read_b128 v[148:151], v58 offset:128
    ds_read_b64_tr_b16 v[152:153], v57 offset:12288
    ds_read_b64_tr_b16 v[154:155], v57 offset:12800
    ds_read_b128 v[156:159], v58 offset:192
    ds_read_b64_tr_b16 v[160:161], v57 offset:16384
    ds_read_b64_tr_b16 v[162:163], v57 offset:16896
    ds_read_b128 v[164:167], v58 offset:256
    ds_read_b64_tr_b16 v[168:169], v57 offset:20480
    ds_read_b64_tr_b16 v[170:171], v57 offset:20992
    ds_read_b128 v[172:175], v58 offset:320
    ds_read_b64_tr_b16 v[176:177], v57 offset:24576
    ds_read_b64_tr_b16 v[178:179], v57 offset:25088
    ds_read_b128 v[180:183], v58 offset:384
    ds_read_b64_tr_b16 v[184:185], v57 offset:28672
    ds_read_b64_tr_b16 v[186:187], v57 offset:29184
    ds_read_b128 v[188:191], v58 offset:448
    ds_read_b64_tr_b16 v[192:193], v57 offset:32768
    ds_read_b64_tr_b16 v[194:195], v57 offset:33280
    ds_read_b128 v[196:199], v58 offset:512
    ds_read_b64_tr_b16 v[200:201], v57 offset:36864
    ds_read_b64_tr_b16 v[202:203], v57 offset:37376
    ds_read_b128 v[204:207], v58 offset:576
    s_waitcnt lgkmcnt(15)
    v_mfma_f32_16x16x32_bf16 v[52:55], v[132:135], v[128:131], 0
    s_nop 0
    v_mfma_f32_16x16x32_bf16 v[52:55], v[140:143], v[136:139], v[52:55]
    v_mfma_f32_16x16x32_bf16 v[52:55], v[148:151], v[144:147], v[52:55]
    v_mfma_f32_16x16x32_bf16 v[52:55], v[156:159], v[152:155], v[52:55]
    v_mfma_f32_16x16x32_bf16 v[52:55], v[164:167], v[160:163], v[52:55]
    s_waitcnt lgkmcnt(12)
    v_mfma_f32_16x16x32_bf16 v[52:55], v[172:175], v[168:171], v[52:55]
    s_waitcnt lgkmcnt(9)
    v_mfma_f32_16x16x32_bf16 v[52:55], v[180:183], v[176:179], v[52:55]
    s_waitcnt lgkmcnt(6)
    v_mfma_f32_16x16x32_bf16 v[52:55], v[188:191], v[184:187], v[52:55]
    s_waitcnt lgkmcnt(3)
    v_mfma_f32_16x16x32_bf16 v[52:55], v[196:199], v[192:195], v[52:55]
    s_waitcnt lgkmcnt(0)
    v_mfma_f32_16x16x32_bf16 v[52:55], v[204:207], v[200:203], v[52:55]
L_stub8:
    s_cbranch_execz L_s0
    s_and_b32 s58, s70, 1
    s_mul_i32 s58, s58, 3840
    s_add_u32 s58, s58, s71
    s_lshl_b32 s59, s3, 4
    s_add_u32 s58, s58, s59
    s_lshl_b32 s58, s58, 3
    s_add_u32 s58, s58, 131072
    s_nop 0
    v_mov_b32_e64 v53, s50
    buffer_store_dwordx2 v[52:53], v59, s[4:7], s58 offen sc1
    s_sub_u32 s46, s2, 184
    s_cmp_ge_u32 s46, 60
    s_cbranch_scc1 L_sp_b2done
    s_lshl_b32 s46, s46, 1
    s_mul_hi_u32 s40, s46, 429496730
    s_mul_i32 s58, s40, 10
    s_sub_u32 s41, s46, s58
    s_lshl_b32 s40, s40, 2
    s_add_u32 s40, s40, s3
    s_mul_hi_u32 s58, s40, 1431655766
    s_mul_i32 s59, s58, 3
    s_sub_u32 s59, s40, s59
    s_mul_i32 s58, s58, 96
    s_mul_i32 s42, s59, 48
    s_cmp_eq_u32 s59, 2
    s_cselect_b32 s42, 32, s42
    s_cselect_b32 s43, 8, 4
    s_cselect_b32 s44, 48, 16
    s_cselect_b32 s45, 0, 4
    s_mul_i32 s43, s43, 1280
    s_mul_i32 s44, s44, 1280
    s_add_u32 s58, s58, s42
    s_mul_i32 s58, s58, 1280
    s_lshl_b32 s59, s41, 7
    s_add_u32 s42, s58, s59
    s_add_u32 s43, s42, s43
    v_and_b32 v12, s45, v104
    v_add_u32_e64 v12, v12, v104
    v_mul_u32_u24 v12, 1280, v12
    v_add_u32 v13, v12, v106
    v_add_u32 v12, v12, v105
    s_add_u32 m0, s66, 0
    s_nop 0
    buffer_load_dwordx4 v12, s[24:27], s42 offen nt lds
    s_add_u32 m0, s66, 57216
    s_nop 0
    buffer_load_dwordx4 v12, s[24:27], s42 offen offset:128 nt lds
    s_add_u32 m0, s66, 1024
    s_nop 0
    buffer_load_dwordx4 v13, s[24:27], s43 offen nt lds
    s_add_u32 m0, s66, 58240
    s_nop 0
    buffer_load_dwordx4 v13, s[24:27], s43 offen offset:128 nt lds
    s_add_u32 s42, s42, s44
    s_add_u32 s43, s43, s44
    s_add_u32 m0, s66, 2048
    s_nop 0
    buffer_load_dwordx4 v12, s[24:27], s42 offen nt lds
    s_add_u32 m0, s66, 59264
    s_nop 0
    buffer_load_dwordx4 v12, s[24:27], s42 offen offset:128 nt lds
    s_add_u32 m0, s66, 3072
    s_nop 0
    buffer_load_dwordx4 v13, s[24:27], s43 offen nt lds
    s_add_u32 m0, s66, 60288
    s_nop 0
    buffer_load_dwordx4 v13, s[24:27], s43 offen offset:128 nt lds
    s_mul_i32 s58, s41, 192
    s_add_u32 s58, s58, s40
    s_lshl_b32 s58, s58, 10
    s_add_u32 s58, s58, 11665408
    s_waitcnt vmcnt(0)
    ds_read_b64_tr_b16 v[208:209], v112 offset:0
    ds_read_b64_tr_b16 v[210:211], v112 offset:512
    ds_read_b64_tr_b16 v[212:213], v113 offset:0
    ds_read_b64_tr_b16 v[214:215], v113 offset:512
    ds_read_b64_tr_b16 v[216:217], v114 offset:0
    ds_read_b64_tr_b16 v[218:219], v114 offset:512
    ds_read_b64_tr_b16 v[220:221], v115 offset:0
    ds_read_b64_tr_b16 v[222:223], v115 offset:512
    s_waitcnt lgkmcnt(6)
    buffer_store_dwordx4 v[208:211], v3, s[4:7], s58 offen sc1
    s_add_u32 s58, s58, 49152
    s_waitcnt lgkmcnt(4)
    buffer_store_dwordx4 v[212:215], v3, s[4:7], s58 offen sc1
    s_add_u32 s58, s58, 49152
    s_waitcnt lgkmcnt(2)
    buffer_store_dwordx4 v[216:219], v3, s[4:7], s58 offen sc1
    s_add_u32 s58, s58, 49152
    s_waitcnt lgkmcnt(0)
    buffer_store_dwordx4 v[220:223], v3, s[4:7], s58 offen sc1
    s_add_u32 s58, s58, 49152
    ds_read_b64_tr_b16 v[224:225], v112 offset:57344
    ds_read_b64_tr_b16 v[226:227], v112 offset:57856
    ds_read_b64_tr_b16 v[228:229], v113 offset:57344
    ds_read_b64_tr_b16 v[230:231], v113 offset:57856
    ds_read_b64_tr_b16 v[232:233], v114 offset:57344
    ds_read_b64_tr_b16 v[234:235], v114 offset:57856
    ds_read_b64_tr_b16 v[236:237], v115 offset:57344
    ds_read_b64_tr_b16 v[238:239], v115 offset:57856
    s_waitcnt lgkmcnt(6)
    buffer_store_dwordx4 v[224:227], v3, s[4:7], s58 offen sc1
    s_add_u32 s58, s58, 49152
    s_waitcnt lgkmcnt(4)
    buffer_store_dwordx4 v[228:231], v3, s[4:7], s58 offen sc1
    s_add_u32 s58, s58, 49152
    s_waitcnt lgkmcnt(2)
    buffer_store_dwordx4 v[232:235], v3, s[4:7], s58 offen sc1
    s_add_u32 s58, s58, 49152
    s_waitcnt lgkmcnt(0)
    buffer_store_dwordx4 v[236:239], v3, s[4:7], s58 offen sc1
    s_lshl_b32 s58, s46, 6
    s_lshl_b32 s59, s3, 2
    s_add_u32 s65, s58, s59
    s_branch L_sp_b2done
L_sp_a:
    s_sub_u32 s46, s2, 64
    s_lshr_b32 s58, s46, 1
    s_mul_hi_u32 s59, s58, 429496730
    s_mul_i32 s47, s59, 10
    s_sub_u32 s58, s58, s47
    s_lshl_b32 s59, s59, 2
    s_lshr_b32 s59, 0x534210, s59
    s_and_b32 s59, s59, 15
    s_mul_i32 s47, s59, 640
    s_lshl_b32 s58, s58, 6
    s_add_u32 s47, s47, s58
    s_and_b32 s58, s46, 1
    s_mul_i32 s58, s58, 2457600
    s_mul_i32 s59, s3, 614400
    s_add_u32 s72, s58, s59
    s_lshl_b32 s58, s47, 1
    s_add_u32 s72, s72, s58
    s_mul_i32 s73, s3, 10240
    s_add_u32 m0, s73, 122880
    s_nop 0
    s_nop 0
    buffer_load_dwordx4 v110, s[28:31], s72 offen nt lds
    s_add_u32 m0, s73, 123904
    s_add_u32 s72, s72, 61440
    buffer_load_dwordx4 v111, s[28:31], s72 offen nt lds
    s_add_u32 m0, s73, 124928
    s_add_u32 s72, s72, 61440
    buffer_load_dwordx4 v110, s[28:31], s72 offen nt lds
    s_add_u32 m0, s73, 125952
    s_add_u32 s72, s72, 61440
    buffer_load_dwordx4 v111, s[28:31], s72 offen nt lds
    s_add_u32 m0, s73, 126976
    s_add_u32 s72, s72, 61440
    buffer_load_dwordx4 v110, s[28:31], s72 offen nt lds
    s_add_u32 m0, s73, 128000
    s_add_u32 s72, s72, 61440
    buffer_load_dwordx4 v111, s[28:31], s72 offen nt lds
    s_add_u32 m0, s73, 129024
    s_add_u32 s72, s72, 61440
    buffer_load_dwordx4 v110, s[28:31], s72 offen nt lds
    s_add_u32 m0, s73, 130048
    s_add_u32 s72, s72, 61440
    buffer_load_dwordx4 v111, s[28:31], s72 offen nt lds
    s_add_u32 m0, s73, 131072
    s_add_u32 s72, s72, 61440
    buffer_load_dwordx4 v110, s[28:31], s72 offen nt lds
    s_add_u32 m0, s73, 132096
    s_add_u32 s72, s72, 61440
    buffer_load_dwordx4 v111, s[28:31], s72 offen nt lds
    s_and_b32 s58, s70, 1
    s_mul_i32 s58, s58, 640
    v_add_u32 v58, s58, v51
    s_waitcnt vmcnt(10)
    s_waitcnt lgkmcnt(0)
    s_barrier
    s_nop 0
    ds_read_b64_tr_b16 v[128:129], v57 offset:0
    ds_read_b64_tr_b16 v[130:131], v57 offset:512
    ds_read_b128 v[132:135], v58 offset:0
    ds_read_b64_tr_b16 v[136:137], v57 offset:4096
    ds_read_b64_tr_b16 v[138:139], v57 offset:4608
    ds_read_b128 v[140:143], v58 offset:64
    ds_read_b64_tr_b16 v[144:145], v57 offset:8192
    ds_read_b64_tr_b16 v[146:147], v57 offset:8704
    ds_read_b128 v[148:151], v58 offset:128
    ds_read_b64_tr_b16 v[152:153], v57 offset:12288
    ds_read_b64_tr_b16 v[154:155], v57 offset:12800
    ds_read_b128 v[156:159], v58 offset:192
    ds_read_b64_tr_b16 v[160:161], v57 offset:16384
    ds_read_b64_tr_b16 v[162:163], v57 offset:16896
    ds_read_b128 v[164:167], v58 offset:256
    ds_read_b64_tr_b16 v[168:169], v57 offset:20480
    ds_read_b64_tr_b16 v[170:171], v57 offset:20992
    ds_read_b128 v[172:175], v58 offset:320
    ds_read_b64_tr_b16 v[176:177], v57 offset:24576
    ds_read_b64_tr_b16 v[178:179], v57 offset:25088
    ds_read_b128 v[180:183], v58 offset:384
    ds_read_b64_tr_b16 v[184:185], v57 offset:28672
    ds_read_b64_tr_b16 v[186:187], v57 offset:29184
    ds_read_b128 v[188:191], v58 offset:448
    ds_read_b64_tr_b16 v[192:193], v57 offset:32768
    ds_read_b64_tr_b16 v[194:195], v57 offset:33280
    ds_read_b128 v[196:199], v58 offset:512
    ds_read_b64_tr_b16 v[200:201], v57 offset:36864
    ds_read_b64_tr_b16 v[202:203], v57 offset:37376
    ds_read_b128 v[204:207], v58 offset:576
    s_waitcnt lgkmcnt(15)
    v_mfma_f32_16x16x32_bf16 v[52:55], v[132:135], v[128:131], 0
    s_nop 0
    v_mfma_f32_16x16x32_bf16 v[52:55], v[140:143], v[136:139], v[52:55]
    v_mfma_f32_16x16x32_bf16 v[52:55], v[148:151], v[144:147], v[52:55]
    v_mfma_f32_16x16x32_bf16 v[52:55], v[156:159], v[152:155], v[52:55]
    v_mfma_f32_16x16x32_bf16 v[52:55], v[164:167], v[160:163], v[52:55]
    s_waitcnt lgkmcnt(12)
    v_mfma_f32_16x16x32_bf16 v[52:55], v[172:175], v[168:171], v[52:55]
    s_waitcnt lgkmcnt(9)
    v_mfma_f32_16x16x32_bf16 v[52:55], v[180:183], v[176:179], v[52:55]
    s_waitcnt lgkmcnt(6)
    v_mfma_f32_16x16x32_bf16 v[52:55], v[188:191], v[184:187], v[52:55]
    s_waitcnt lgkmcnt(3)
    v_mfma_f32_16x16x32_bf16 v[52:55], v[196:199], v[192:195], v[52:55]
    s_waitcnt lgkmcnt(0)
    v_mfma_f32_16x16x32_bf16 v[52:55], v[204:207], v[200:203], v[52:55]
    s_and_b32 s58, s70, 1
    s_mul_i32 s58, s58, 3840
    s_add_u32 s58, s58, s71
    s_lshl_b32 s59, s3, 4
    s_add_u32 s58, s58, s59
    s_lshl_b32 s58, s58, 3
    s_add_u32 s58, s58, 131072
    s_nop 0
    v_mov_b32 v53, s50
    buffer_store_dwordx2 v[52:53], v59, s[4:7], s58 offen sc1
    s_and_b32 s58, s46, 1
    s_mul_i32 s58, s58, 640
    v_add_u32 v58, s58, v51
    s_waitcnt vmcnt(1)
    s_barrier
    ds_read_b64_tr_b16 v[128:129], v56 offset:0
    ds_read_b64_tr_b16 v[130:131], v56 offset:512
    ds_read_b128 v[132:135], v58 offset:0
    ds_read_b64_tr_b16 v[136:137], v56 offset:4096
    ds_read_b64_tr_b16 v[138:139], v56 offset:4608
    ds_read_b128 v[140:143], v58 offset:64
    ds_read_b64_tr_b16 v[144:145], v56 offset:8192
    ds_read_b64_tr_b16 v[146:147], v56 offset:8704
    ds_read_b128 v[148:151], v58 offset:128
    ds_read_b64_tr_b16 v[152:153], v56 offset:12288
    ds_read_b64_tr_b16 v[154:155], v56 offset:12800
    ds_read_b128 v[156:159], v58 offset:192
    ds_read_b64_tr_b16 v[160:161], v56 offset:16384
    ds_read_b64_tr_b16 v[162:163], v56 offset:16896
    ds_read_b128 v[164:167], v58 offset:256
    ds_read_b64_tr_b16 v[168:169], v56 offset:20480
    ds_read_b64_tr_b16 v[170:171], v56 offset:20992
    ds_read_b128 v[172:175], v58 offset:320
    ds_read_b64_tr_b16 v[176:177], v56 offset:24576
    ds_read_b64_tr_b16 v[178:179], v56 offset:25088
    ds_read_b128 v[180:183], v58 offset:384
    ds_read_b64_tr_b16 v[184:185], v56 offset:28672
    ds_read_b64_tr_b16 v[186:187], v56 offset:29184
    ds_read_b128 v[188:191], v58 offset:448
    ds_read_b64_tr_b16 v[192:193], v56 offset:32768
    ds_read_b64_tr_b16 v[194:195], v56 offset:33280
    ds_read_b128 v[196:199], v58 offset:512
    ds_read_b64_tr_b16 v[200:201], v56 offset:36864
    ds_read_b64_tr_b16 v[202:203], v56 offset:37376
    ds_read_b128 v[204:207], v58 offset:576
    s_waitcnt lgkmcnt(15)
    v_mfma_f32_16x16x32_bf16 v[52:55], v[132:135], v[128:131], 0
    s_nop 0
    v_mfma_f32_16x16x32_bf16 v[52:55], v[140:143], v[136:139], v[52:55]
    v_mfma_f32_16x16x32_bf16 v[52:55], v[148:151], v[144:147], v[52:55]
    v_mfma_f32_16x16x32_bf16 v[52:55], v[156:159], v[152:155], v[52:55]
    v_mfma_f32_16x16x32_bf16 v[52:55], v[164:167], v[160:163], v[52:55]
    s_waitcnt lgkmcnt(12)
    v_mfma_f32_16x16x32_bf16 v[52:55], v[172:175], v[168:171], v[52:55]
    s_waitcnt lgkmcnt(9)
    v_mfma_f32_16x16x32_bf16 v[52:55], v[180:183], v[176:179], v[52:55]
    s_waitcnt lgkmcnt(6)
    v_mfma_f32_16x16x32_bf16 v[52:55], v[188:191], v[184:187], v[52:55]
    s_waitcnt lgkmcnt(3)
    v_mfma_f32_16x16x32_bf16 v[52:55], v[196:199], v[192:195], v[52:55]
    s_waitcnt lgkmcnt(0)
    v_mfma_f32_16x16x32_bf16 v[52:55], v[204:207], v[200:203], v[52:55]
    s_and_b32 s58, s46, 1
    s_mul_i32 s58, s58, 3840
    s_add_u32 s58, s58, s47
    s_lshl_b32 s59, s3, 4
    s_add_u32 s58, s58, s59
    s_lshl_b32 s58, s58, 3
    s_add_u32 s58, s58, 131072
    s_nop 0
    v_mov_b32 v53, s50
    buffer_store_dwordx2 v[52:53], v59, s[4:7], s58 offen sc1
L_sp_b2done:
    s_mov_b64 exec, 0
    s_cmp_eq_u32 s3, 0
    s_cbranch_scc1 L_gp0
    s_cmp_eq_u32 s3, 1
    s_cbranch_scc1 L_gp1
    s_cmp_eq_u32 s3, 2
    s_cbranch_scc1 L_gp2
    s_branch L_gp3
L_sp_t2:
    s_lshr_b32 s58, s3, 1
    s_mul_i32 s58, s58, 3
    s_mul_i32 s59, s53, 6
    s_add_u32 s58, s58, s59
    s_and_b32 s59, s3, 1
    s_lshr_b32 s74, s53, 1
    s_mul_i32 s74, s74, 20
    s_mul_i32 s76, s59, 10
    s_add_u32 s74, s74, s76
    s_and_b32 s76, s51, 1
    s_lshl_b32 s76, s76, 8
    s_add_u32 s74, s74, s76
    v_min_u32 v6, 9, v2
    v_add_u32 v6, s74, v6
    v_mul_u32_u24_e64 v6, 32, v6
    v_add_u32 v6, 20054016, v6
    s_lshl_b32 s74, s59, 7
    v_xor_b32 v5, s74, v3
    s_mul_i32 s58, s58, 40960
    s_mul_i32 s74, s59, 20480
    s_add_u32 s58, s58, s74
    s_add_u32 s58, s58, 7340032
    s_mul_i32 s59, s59, 40960
    s_add_u32 s76, s58, s59
    s_sub_u32 s74, s58, s59
    s_add_u32 s74, s74, 40960
    s_add_u32 s75, s58, 81920
    v_mov_b32 v56, 2130706432
    v_mov_b32 v57, 2130706432
    s_mov_b32 s40, 0
    s_mov_b32 s41, 0
    s_mov_b32 s42, 0
    s_cmp_ge_u32 s51, 4
    s_cbranch_scc1 L_sp_nog
    v_min_u32 v56, 159, v0
    v_lshlrev_b32_e64 v57, 5, v56
    v_add_u32 v57, 146432, v57
    v_add_u32 v58, 5120, v57
    s_mov_b32 s59, 30720
    buffer_load_dwordx4 v[64:67], v58, s[4:7], 0 offen sc1
    buffer_load_dwordx4 v[68:71], v58, s[4:7], 0 offen offset:16 sc1
    buffer_load_dwordx4 v[72:75], v58, s[4:7], s59 offen sc1
    buffer_load_dwordx4 v[76:79], v58, s[4:7], s59 offen offset:16 sc1
    buffer_load_dwordx4 v[80:83], v57, s[4:7], 0 offen sc1
    buffer_load_dwordx4 v[84:87], v57, s[4:7], 0 offen offset:16 sc1
    buffer_load_dwordx4 v[88:91], v57, s[4:7], s59 offen sc1
    buffer_load_dwordx4 v[92:95], v57, s[4:7], s59 offen offset:16 sc1
    s_waitcnt vmcnt(7)
    v_xor_b32 v50, v65, v67
    s_waitcnt vmcnt(6)
    v_sad_u32 v50, v65, v69, v50 clamp
    v_sad_u32 v50, v65, v71, v50 clamp
    s_waitcnt vmcnt(5)
    v_sad_u32 v50, v65, v73, v50 clamp
    v_sad_u32 v50, v65, v75, v50 clamp
    s_waitcnt vmcnt(4)
    v_sad_u32 v50, v65, v77, v50 clamp
    v_sad_u32 v50, v65, v79, v50 clamp
    s_waitcnt vmcnt(3)
    v_sad_u32 v50, v65, v81, v50 clamp
    v_sad_u32 v50, v65, v83, v50 clamp
    s_waitcnt vmcnt(2)
    v_sad_u32 v50, v65, v85, v50 clamp
    v_sad_u32 v50, v65, v87, v50 clamp
    s_waitcnt vmcnt(1)
    v_sad_u32 v50, v65, v89, v50 clamp
    v_sad_u32 v50, v65, v91, v50 clamp
    s_waitcnt vmcnt(0)
    v_sad_u32 v50, v65, v93, v50 clamp
    v_sad_u32 v50, v65, v95, v50 clamp
    v_sad_u32 v50, v65, s50, v50 clamp
    v_cmp_ne_u32 vcc, 0, v50
    s_cbranch_vccnz L_slow18
L_back18:
    v_add_f32 v64, v64, v72
    v_add_f32_e64 v80, v80, v88
    v_cvt_pk_bf16_f32 v64, 0, v64
    v_add_f32 v64, 1.0, v64
    v_add_f32 v66, v66, v74
    v_add_f32_e64 v82, v82, v90
    v_cvt_pk_bf16_f32 v66, 0, v66
    v_add_f32 v66, 1.0, v66
    v_add_f32 v68, v68, v76
    v_add_f32_e64 v84, v84, v92
    v_cvt_pk_bf16_f32 v68, 0, v68
    v_add_f32 v68, 1.0, v68
    v_add_f32 v70, v70, v78
    v_add_f32_e64 v86, v86, v94
    v_cvt_pk_bf16_f32 v70, 0, v70
    v_add_f32_e64 v70, 1.0, v70
    v_cvt_pk_bf16_f32 v72, v64, v66
    v_cvt_pk_bf16_f32 v73, v68, v70
    v_cvt_pk_bf16_f32 v74, v80, v82
    v_cvt_pk_bf16_f32 v75, v84, v86
    v_lshlrev_b32_e64 v56, 3, v56
    v_add_u32 v56, 112640, v56
    ds_write_b64 v56, v[72:73]
    ds_write_b64 v56, v[74:75] offset:1280
    v_and_b32_e64 v57, 1, v2
    v_mul_u32_u24 v57, 1280, v57
    v_lshrrev_b32_e64 v58, 5, v2
    v_lshl_add_u32 v57, v58, 4, v57
    s_and_b32 s59, s3, 1
    s_mul_i32 s58, s59, 640
    s_add_u32 s58, s58, 112640
    v_add_u32 v57, s58, v57
    s_waitcnt lgkmcnt(0)
    s_barrier
    ds_read_b128 v[128:131], v57 offset:0
    ds_read_b128 v[132:135], v57 offset:32
    ds_read_b128 v[136:139], v57 offset:64
    ds_read_b128 v[140:143], v57 offset:96
    ds_read_b128 v[144:147], v57 offset:128
    ds_read_b128 v[148:151], v57 offset:160
    ds_read_b128 v[152:155], v57 offset:192
    ds_read_b128 v[156:159], v57 offset:224
    ds_read_b128 v[160:163], v57 offset:256
    ds_read_b128 v[164:167], v57 offset:288
    ds_read_b128 v[168:171], v57 offset:320
    ds_read_b128 v[172:175], v57 offset:352
    ds_read_b128 v[176:179], v57 offset:384
    ds_read_b128 v[180:183], v57 offset:416
    ds_read_b128 v[184:187], v57 offset:448
    ds_read_b128 v[188:191], v57 offset:480
    ds_read_b128 v[192:195], v57 offset:512
    ds_read_b128 v[196:199], v57 offset:544
    ds_read_b128 v[200:203], v57 offset:576
    ds_read_b128 v[204:207], v57 offset:608
    s_lshr_b32 s58, s3, 1
    s_mul_i32 s58, s58, 3
    s_mul_i32 s43, s53, 6
    s_add_u32 s58, s58, s43
    s_lshl_b32 s58, s58, 10
    s_lshl_b32 s43, s59, 9
    s_add_u32 s58, s58, s43
    s_add_u32 s58, s58, 262144
    s_lshl_b32 s43, s59, 10
    s_add_u32 s42, s58, s43
    s_sub_u32 s40, s58, s43
    s_add_u32 s40, s40, 1024
    s_add_u32 s41, s58, 2048
    v_mov_b32 v58, 2130706432
    v_cmp_gt_u32 vcc, 32, v2
    s_nop 1
    v_cndmask_b32 v56, v58, v3, vcc
    v_cndmask_b32 v57, v58, v5, vcc
L_sp_nog:
    buffer_load_dword v4, v6, s[4:7], 0 offen sc1
    s_waitcnt vmcnt(0)
    v_cmp_ne_u32 vcc, s50, v4
    s_cbranch_vccnz L_slow19
L_back19:
    s_cmp_eq_u32 s65, -1
    s_cbranch_scc1 L_sp_nw2
    s_atomic_swap s50, s[4:5], s65 offset:65536
L_sp_nw2:
    s_cmp_lt_u32 s52, 24
    s_cbranch_scc1 L_sp_p0
    s_cmp_lt_u32 s52, 28
    s_cbranch_scc1 L_sp_p1
    s_add_u32 s69, s76, 0
    buffer_load_dwordx4 a[8:11], v3, s[4:7], s69 offen offset:0 sc1
    buffer_load_dwordx4 a[20:23], v3, s[4:7], s69 offen offset:1024 sc1
    buffer_load_dwordx4 a[32:35], v3, s[4:7], s69 offen offset:2048 sc1
    buffer_load_dwordx4 a[44:47], v3, s[4:7], s69 offen offset:3072 sc1
    s_add_u32 s69, s76, 4096
    buffer_load_dwordx4 a[56:59], v3, s[4:7], s69 offen offset:0 sc1
    buffer_load_dwordx4 a[68:71], v3, s[4:7], s69 offen offset:1024 sc1
    buffer_load_dwordx4 a[80:83], v3, s[4:7], s69 offen offset:2048 sc1
    buffer_load_dwordx4 a[92:95], v3, s[4:7], s69 offen offset:3072 sc1
    s_add_u32 s69, s76, 8192
    buffer_load_dwordx4 a[104:107], v3, s[4:7], s69 offen offset:0 sc1
    buffer_load_dwordx4 a[116:119], v3, s[4:7], s69 offen offset:1024 sc1
    s_waitcnt vmcnt(9) lgkmcnt(15)
    v_mfma_f32_32x32x16_bf16 v[64:79], v[128:131], a[8:11], 0
    buffer_load_dwordx4 a[128:131], v3, s[4:7], s69 offen offset:2048 sc1
    s_waitcnt vmcnt(9)
    v_mfma_f32_32x32x16_bf16 v[64:79], v[132:135], a[20:23], v[64:79]
    buffer_load_dwordx4 a[140:143], v3, s[4:7], s69 offen offset:3072 sc1
    s_waitcnt vmcnt(9)
    v_mfma_f32_32x32x16_bf16 v[64:79], v[136:139], a[32:35], v[64:79]
    s_add_u32 s69, s76, 12288
    buffer_load_dwordx4 a[152:155], v3, s[4:7], s69 offen offset:0 sc1
    s_waitcnt vmcnt(9)
    v_mfma_f32_32x32x16_bf16 v[64:79], v[140:143], a[44:47], v[64:79]
    buffer_load_dwordx4 a[164:167], v3, s[4:7], s69 offen offset:1024 sc1
    s_waitcnt vmcnt(9)
    v_mfma_f32_32x32x16_bf16 v[64:79], v[144:147], a[56:59], v[64:79]
    buffer_load_dwordx4 a[176:179], v3, s[4:7], s69 offen offset:2048 sc1
    s_waitcnt vmcnt(9) lgkmcnt(14)
    v_mfma_f32_32x32x16_bf16 v[64:79], v[148:151], a[68:71], v[64:79]
    buffer_load_dwordx4 a[188:191], v3, s[4:7], s69 offen offset:3072 sc1
    s_waitcnt vmcnt(9) lgkmcnt(13)
    v_mfma_f32_32x32x16_bf16 v[64:79], v[152:155], a[80:83], v[64:79]
    s_add_u32 s69, s76, 16384
    buffer_load_dwordx4 a[200:203], v3, s[4:7], s69 offen offset:0 sc1
    s_waitcnt vmcnt(9) lgkmcnt(12)
    v_mfma_f32_32x32x16_bf16 v[64:79], v[156:159], a[92:95], v[64:79]
    buffer_load_dwordx4 a[212:215], v3, s[4:7], s69 offen offset:1024 sc1
    s_waitcnt vmcnt(9) lgkmcnt(11)
    v_mfma_f32_32x32x16_bf16 v[64:79], v[160:163], a[104:107], v[64:79]
    buffer_load_dwordx4 a[224:227], v3, s[4:7], s69 offen offset:2048 sc1
    s_waitcnt vmcnt(9) lgkmcnt(10)
    v_mfma_f32_32x32x16_bf16 v[64:79], v[164:167], a[116:119], v[64:79]
    buffer_load_dwordx4 a[236:239], v3, s[4:7], s69 offen offset:3072 sc1
    s_waitcnt vmcnt(9) lgkmcnt(9)
    v_mfma_f32_32x32x16_bf16 v[64:79], v[168:171], a[128:131], v[64:79]
    s_add_u32 s67, s74, 0
    buffer_load_dwordx4 a[0:3], v3, s[4:7], s67 offen offset:0 sc1
    s_waitcnt vmcnt(9) lgkmcnt(8)
    v_mfma_f32_32x32x16_bf16 v[64:79], v[172:175], a[140:143], v[64:79]
    s_add_u32 s68, s75, 0
    buffer_load_dwordx4 a[4:7], v5, s[4:7], s68 offen offset:0 sc1
    s_waitcnt vmcnt(9) lgkmcnt(7)
    v_mfma_f32_32x32x16_bf16 v[64:79], v[176:179], a[152:155], v[64:79]
    buffer_load_dwordx4 a[12:15], v3, s[4:7], s67 offen offset:1024 sc1
    s_waitcnt vmcnt(9) lgkmcnt(6)
    v_mfma_f32_32x32x16_bf16 v[64:79], v[180:183], a[164:167], v[64:79]
    buffer_load_dwordx4 a[16:19], v5, s[4:7], s68 offen offset:1024 sc1
    s_waitcnt vmcnt(9) lgkmcnt(5)
    v_mfma_f32_32x32x16_bf16 v[64:79], v[184:187], a[176:179], v[64:79]
    buffer_load_dwordx4 a[24:27], v3, s[4:7], s67 offen offset:2048 sc1
    s_waitcnt vmcnt(9) lgkmcnt(4)
    v_mfma_f32_32x32x16_bf16 v[64:79], v[188:191], a[188:191], v[64:79]
    buffer_load_dwordx4 a[28:31], v5, s[4:7], s68 offen offset:2048 sc1
    s_waitcnt vmcnt(9) lgkmcnt(3)
    v_mfma_f32_32x32x16_bf16 v[64:79], v[192:195], a[200:203], v[64:79]
    buffer_load_dwordx4 a[36:39], v3, s[4:7], s67 offen offset:3072 sc1
    s_waitcnt vmcnt(9) lgkmcnt(2)
    v_mfma_f32_32x32x16_bf16 v[64:79], v[196:199], a[212:215], v[64:79]
    buffer_load_dwordx4 a[40:43], v5, s[4:7], s68 offen offset:3072 sc1
    s_waitcnt vmcnt(9) lgkmcnt(1)
    v_mfma_f32_32x32x16_bf16 v[64:79], v[200:203], a[224:227], v[64:79]
    s_add_u32 s67, s74, 4096
    buffer_load_dwordx4 a[48:51], v3, s[4:7], s67 offen offset:0 sc1
    ds_read_b32 v1, v3
    s_waitcnt vmcnt(9) lgkmcnt(1)
    v_mfma_f32_32x32x16_bf16 v[64:79], v[204:207], a[236:239], v[64:79]
    s_add_u32 s68, s75, 4096
    buffer_load_dwordx4 a[52:55], v5, s[4:7], s68 offen offset:0 sc1
    buffer_load_dwordx4 a[60:63], v3, s[4:7], s67 offen offset:1024 sc1
    buffer_load_dwordx4 a[64:67], v5, s[4:7], s68 offen offset:1024 sc1
    buffer_load_dwordx4 a[72:75], v3, s[4:7], s67 offen offset:2048 sc1
    buffer_load_dwordx4 a[76:79], v5, s[4:7], s68 offen offset:2048 sc1
    buffer_load_dwordx4 a[84:87], v3, s[4:7], s67 offen offset:3072 sc1
    buffer_load_dwordx4 a[88:91], v5, s[4:7], s68 offen offset:3072 sc1
    s_add_u32 s67, s74, 8192
    buffer_load_dwordx4 a[96:99], v3, s[4:7], s67 offen offset:0 sc1
    s_add_u32 s68, s75, 8192
    buffer_load_dwordx4 a[100:103], v5, s[4:7], s68 offen offset:0 sc1
    buffer_load_dwordx4 a[108:111], v3, s[4:7], s67 offen offset:1024 sc1
    buffer_load_dwordx4 a[112:115], v5, s[4:7], s68 offen offset:1024 sc1
    buffer_load_dwordx4 a[120:123], v3, s[4:7], s67 offen offset:2048 sc1
    buffer_load_dwordx4 a[124:127], v5, s[4:7], s68 offen offset:2048 sc1
    buffer_load_dwordx4 a[132:135], v3, s[4:7], s67 offen offset:3072 sc1
    buffer_load_dwordx4 a[136:139], v5, s[4:7], s68 offen offset:3072 sc1
    s_add_u32 s67, s74, 12288
    buffer_load_dwordx4 a[144:147], v3, s[4:7], s67 offen offset:0 sc1
    s_add_u32 s68, s75, 12288
    buffer_load_dwordx4 a[148:151], v5, s[4:7], s68 offen offset:0 sc1
    buffer_load_dwordx4 a[156:159], v3, s[4:7], s67 offen offset:1024 sc1
    buffer_load_dwordx4 a[160:163], v5, s[4:7], s68 offen offset:1024 sc1
    buffer_load_dwordx4 a[168:171], v3, s[4:7], s67 offen offset:2048 sc1
    buffer_load_dwordx4 a[172:175], v5, s[4:7], s68 offen offset:2048 sc1
    buffer_load_dwordx4 a[180:183], v3, s[4:7], s67 offen offset:3072 sc1
    buffer_load_dwordx4 a[184:187], v5, s[4:7], s68 offen offset:3072 sc1
    s_add_u32 s67, s74, 16384
    buffer_load_dwordx4 a[192:195], v3, s[4:7], s67 offen offset:0 sc1
    v_cvt_pk_bf16_f32 v66, 0, v64
    v_cvt_pk_bf16_f32 v67, 0, v65
    v_sub_f32 v64, v64, v66
    v_sub_f32 v65, v65, v67
    v_cvt_pk_bf16_f32 v64, -v66, -v64
    v_cvt_pk_bf16_f32 v65, v67, v65
    v_mov_b32 v66, 0
    v_mov_b32 v67, s50
    buffer_store_dwordx4 v[64:67], v56, s[4:7], s42 offen sc1
    s_branch L_sp_pj
L_sp_p0:
    s_add_u32 s67, s74, 0
    buffer_load_dwordx4 a[0:3], v3, s[4:7], s67 offen offset:0 sc1
    buffer_load_dwordx4 a[12:15], v3, s[4:7], s67 offen offset:1024 sc1
    buffer_load_dwordx4 a[24:27], v3, s[4:7], s67 offen offset:2048 sc1
    buffer_load_dwordx4 a[36:39], v3, s[4:7], s67 offen offset:3072 sc1
    s_add_u32 s67, s74, 4096
    buffer_load_dwordx4 a[48:51], v3, s[4:7], s67 offen offset:0 sc1
    buffer_load_dwordx4 a[60:63], v3, s[4:7], s67 offen offset:1024 sc1
    buffer_load_dwordx4 a[72:75], v3, s[4:7], s67 offen offset:2048 sc1
    buffer_load_dwordx4 a[84:87], v3, s[4:7], s67 offen offset:3072 sc1
    s_add_u32 s67, s74, 8192
    buffer_load_dwordx4 a[96:99], v3, s[4:7], s67 offen offset:0 sc1
    buffer_load_dwordx4 a[108:111], v3, s[4:7], s67 offen offset:1024 sc1
    s_waitcnt vmcnt(9) lgkmcnt(15)
    v_mfma_f32_32x32x16_bf16 v[64:79], v[128:131], a[0:3], 0
    buffer_load_dwordx4 a[120:123], v3, s[4:7], s67 offen offset:2048 sc1
    s_waitcnt vmcnt(9)
    v_mfma_f32_32x32x16_bf16 v[64:79], v[132:135], a[12:15], v[64:79]
    buffer_load_dwordx4 a[132:135], v3, s[4:7], s67 offen offset:3072 sc1
    s_waitcnt vmcnt(9)
    v_mfma_f32_32x32x16_bf16 v[64:79], v[136:139], a[24:27], v[64:79]
    s_add_u32 s67, s74, 12288
    buffer_load_dwordx4 a[144:147], v3, s[4:7], s67 offen offset:0 sc1
    s_waitcnt vmcnt(9)
    v_mfma_f32_32x32x16_bf16 v[64:79], v[140:143], a[36:39], v[64:79]
    buffer_load_dwordx4 a[156:159], v3, s[4:7], s67 offen offset:1024 sc1
    s_waitcnt vmcnt(9)
    v_mfma_f32_32x32x16_bf16 v[64:79], v[144:147], a[48:51], v[64:79]
    buffer_load_dwordx4 a[168:171], v3, s[4:7], s67 offen offset:2048 sc1
    s_waitcnt vmcnt(9) lgkmcnt(14)
    v_mfma_f32_32x32x16_bf16 v[64:79], v[148:151], a[60:63], v[64:79]
    buffer_load_dwordx4 a[180:183], v3, s[4:7], s67 offen offset:3072 sc1
    s_waitcnt vmcnt(9) lgkmcnt(13)
    v_mfma_f32_32x32x16_bf16 v[64:79], v[152:155], a[72:75], v[64:79]
    s_add_u32 s67, s74, 16384
    buffer_load_dwordx4 a[192:195], v3, s[4:7], s67 offen offset:0 sc1
    s_waitcnt vmcnt(9) lgkmcnt(12)
    v_mfma_f32_32x32x16_bf16 v[64:79], v[156:159], a[84:87], v[64:79]
    buffer_load_dwordx4 a[204:207], v3, s[4:7], s67 offen offset:1024 sc1
    s_waitcnt vmcnt(9) lgkmcnt(11)
    v_mfma_f32_32x32x16_bf16 v[64:79], v[160:163], a[96:99], v[64:79]
    buffer_load_dwordx4 a[216:219], v3, s[4:7], s67 offen offset:2048 sc1
    s_waitcnt vmcnt(9) lgkmcnt(10)
    v_mfma_f32_32x32x16_bf16 v[64:79], v[164:167], a[108:111], v[64:79]
    buffer_load_dwordx4 a[228:231], v3, s[4:7], s67 offen offset:3072 sc1
    s_waitcnt vmcnt(9) lgkmcnt(9)
    v_mfma_f32_32x32x16_bf16 v[64:79], v[168:171], a[120:123], v[64:79]
    s_add_u32 s68, s75, 0
    buffer_load_dwordx4 a[4:7], v5, s[4:7], s68 offen offset:0 sc1
    s_waitcnt vmcnt(9) lgkmcnt(8)
    v_mfma_f32_32x32x16_bf16 v[64:79], v[172:175], a[132:135], v[64:79]
    s_add_u32 s69, s76, 0
L_stub9:
    s_cbranch_execz L_s0
    buffer_load_dwordx4 a[8:11], v3, s[4:7], s69 offen offset:0 sc1
    s_waitcnt vmcnt(9) lgkmcnt(7)
    v_mfma_f32_32x32x16_bf16 v[64:79], v[176:179], a[144:147], v[64:79]
    buffer_load_dwordx4 a[16:19], v5, s[4:7], s68 offen offset:1024 sc1
    s_waitcnt vmcnt(9) lgkmcnt(6)
    v_mfma_f32_32x32x16_bf16 v[64:79], v[180:183], a[156:159], v[64:79]
    buffer_load_dwordx4 a[20:23], v3, s[4:7], s69 offen offset:1024 sc1
    s_waitcnt vmcnt(9) lgkmcnt(5)
    v_mfma_f32_32x32x16_bf16 v[64:79], v[184:187], a[168:171], v[64:79]
    buffer_load_dwordx4 a[28:31], v5, s[4:7], s68 offen offset:2048 sc1
    s_waitcnt vmcnt(9) lgkmcnt(4)
    v_mfma_f32_32x32x16_bf16 v[64:79], v[188:191], a[180:183], v[64:79]
    buffer_load_dwordx4 a[32:35], v3, s[4:7], s69 offen offset:2048 sc1
    s_waitcnt vmcnt(9) lgkmcnt(3)
    v_mfma_f32_32x32x16_bf16 v[64:79], v[192:195], a[192:195], v[64:79]
    buffer_load_dwordx4 a[40:43], v5, s[4:7], s68 offen offset:3072 sc1
    s_waitcnt vmcnt(9) lgkmcnt(2)
    v_mfma_f32_32x32x16_bf16 v[64:79], v[196:199], a[204:207], v[64:79]
    buffer_load_dwordx4 a[44:47], v3, s[4:7], s69 offen offset:3072 sc1
    s_waitcnt vmcnt(9) lgkmcnt(1)
    v_mfma_f32_32x32x16_bf16 v[64:79], v[200:203], a[216:219], v[64:79]
    s_add_u32 s68, s75, 4096
    buffer_load_dwordx4 a[52:55], v5, s[4:7], s68 offen offset:0 sc1
    s_waitcnt vmcnt(9) lgkmcnt(0)
    v_mfma_f32_32x32x16_bf16 v[64:79], v[204:207], a[228:231], v[64:79]
    s_nop 0
    s_add_u32 s69, s76, 4096
    buffer_load_dwordx4 a[56:59], v3, s[4:7], s69 offen offset:0 sc1
    buffer_load_dwordx4 a[64:67], v5, s[4:7], s68 offen offset:1024 sc1
    buffer_load_dwordx4 a[68:71], v3, s[4:7], s69 offen offset:1024 sc1
    buffer_load_dwordx4 a[76:79], v5, s[4:7], s68 offen offset:2048 sc1
    buffer_load_dwordx4 a[80:83], v3, s[4:7], s69 offen offset:2048 sc1
    buffer_load_dwordx4 a[88:91], v5, s[4:7], s68 offen offset:3072 sc1
    buffer_load_dwordx4 a[92:95], v3, s[4:7], s69 offen offset:3072 sc1
    s_add_u32 s68, s75, 8192
    buffer_load_dwordx4 a[100:103], v5, s[4:7], s68 offen offset:0 sc1
    s_add_u32 s69, s76, 8192
    buffer_load_dwordx4 a[104:107], v3, s[4:7], s69 offen offset:0 sc1
    buffer_load_dwordx4 a[112:115], v5, s[4:7], s68 offen offset:1024 sc1
    buffer_load_dwordx4 a[116:119], v3, s[4:7], s69 offen offset:1024 sc1
    buffer_load_dwordx4 a[124:127], v5, s[4:7], s68 offen offset:2048 sc1
    buffer_load_dwordx4 a[128:131], v3, s[4:7], s69 offen offset:2048 sc1
    buffer_load_dwordx4 a[136:139], v5, s[4:7], s68 offen offset:3072 sc1
    buffer_load_dwordx4 a[140:143], v3, s[4:7], s69 offen offset:3072 sc1
    s_add_u32 s68, s75, 12288
    buffer_load_dwordx4 a[148:151], v5, s[4:7], s68 offen offset:0 sc1
    s_add_u32 s69, s76, 12288
    buffer_load_dwordx4 a[152:155], v3, s[4:7], s69 offen offset:0 sc1
    buffer_load_dwordx4 a[160:163], v5, s[4:7], s68 offen offset:1024 sc1
    buffer_load_dwordx4 a[164:167], v3, s[4:7], s69 offen offset:1024 sc1
    buffer_load_dwordx4 a[172:175], v5, s[4:7], s68 offen offset:2048 sc1
    buffer_load_dwordx4 a[176:179], v3, s[4:7], s69 offen offset:2048 sc1
    buffer_load_dwordx4 a[184:187], v5, s[4:7], s68 offen offset:3072 sc1
    buffer_load_dwordx4 a[188:191], v3, s[4:7], s69 offen offset:3072 sc1
    v_cvt_pk_bf16_f32 v66, 0, v64
    v_cvt_pk_bf16_f32 v67, 0, v65
    v_sub_f32 v64, v64, v66
    v_sub_f32 v65, v65, v67
    v_cvt_pk_bf16_f32 v64, -v66, -v64
    v_cvt_pk_bf16_f32 v65, v67, v65
    v_mov_b32 v66, 0
    v_mov_b32 v67, s50
    buffer_store_dwordx4 v[64:67], v56, s[4:7], s40 offen sc1
    s_branch L_sp_pj
L_sp_p1:
    s_add_u32 s68, s75, 0
    buffer_load_dwordx4 a[4:7], v5, s[4:7], s68 offen offset:0 sc1
    buffer_load_dwordx4 a[16:19], v5, s[4:7], s68 offen offset:1024 sc1
    buffer_load_dwordx4 a[28:31], v5, s[4:7], s68 offen offset:2048 sc1
    buffer_load_dwordx4 a[40:43], v5, s[4:7], s68 offen offset:3072 sc1
    s_add_u32 s68, s75, 4096
    buffer_load_dwordx4 a[52:55], v5, s[4:7], s68 offen offset:0 sc1
    buffer_load_dwordx4 a[64:67], v5, s[4:7], s68 offen offset:1024 sc1
    buffer_load_dwordx4 a[76:79], v5, s[4:7], s68 offen offset:2048 sc1
    buffer_load_dwordx4 a[88:91], v5, s[4:7], s68 offen offset:3072 sc1
    s_add_u32 s68, s75, 8192
    buffer_load_dwordx4 a[100:103], v5, s[4:7], s68 offen offset:0 sc1
    buffer_load_dwordx4 a[112:115], v5, s[4:7], s68 offen offset:1024 sc1
    s_waitcnt vmcnt(9) lgkmcnt(15)
    v_mfma_f32_32x32x16_bf16 v[64:79], v[128:131], a[4:7], 0
    buffer_load_dwordx4 a[124:127], v5, s[4:7], s68 offen offset:2048 sc1
    s_waitcnt vmcnt(9)
    v_mfma_f32_32x32x16_bf16 v[64:79], v[132:135], a[16:19], v[64:79]
    buffer_load_dwordx4 a[136:139], v5, s[4:7], s68 offen offset:3072 sc1
    s_waitcnt vmcnt(9)
    v_mfma_f32_32x32x16_bf16 v[64:79], v[136:139], a[28:31], v[64:79]
    s_add_u32 s68, s75, 12288
    buffer_load_dwordx4 a[148:151], v5, s[4:7], s68 offen offset:0 sc1
    s_waitcnt vmcnt(9)
    v_mfma_f32_32x32x16_bf16 v[64:79], v[140:143], a[40:43], v[64:79]
    buffer_load_dwordx4 a[160:163], v5, s[4:7], s68 offen offset:1024 sc1
    s_waitcnt vmcnt(9)
    v_mfma_f32_32x32x16_bf16 v[64:79], v[144:147], a[52:55], v[64:79]
    buffer_load_dwordx4 a[172:175], v5, s[4:7], s68 offen offset:2048 sc1
    s_waitcnt vmcnt(9) lgkmcnt(14)
    v_mfma_f32_32x32x16_bf16 v[64:79], v[148:151], a[64:67], v[64:79]
    buffer_load_dwordx4 a[184:187], v5, s[4:7], s68 offen offset:3072 sc1
    s_waitcnt vmcnt(9) lgkmcnt(13)
    v_mfma_f32_32x32x16_bf16 v[64:79], v[152:155], a[76:79], v[64:79]
    s_add_u32 s68, s75, 16384
    buffer_load_dwordx4 a[196:199], v5, s[4:7], s68 offen offset:0 sc1
    s_waitcnt vmcnt(9) lgkmcnt(12)
    v_mfma_f32_32x32x16_bf16 v[64:79], v[156:159], a[88:91], v[64:79]
    buffer_load_dwordx4 a[208:211], v5, s[4:7], s68 offen offset:1024 sc1
    s_waitcnt vmcnt(9) lgkmcnt(11)
    v_mfma_f32_32x32x16_bf16 v[64:79], v[160:163], a[100:103], v[64:79]
    buffer_load_dwordx4 a[220:223], v5, s[4:7], s68 offen offset:2048 sc1
    s_waitcnt vmcnt(9) lgkmcnt(10)
    v_mfma_f32_32x32x16_bf16 v[64:79], v[164:167], a[112:115], v[64:79]
    buffer_load_dwordx4 a[232:235], v5, s[4:7], s68 offen offset:3072 sc1
    s_waitcnt vmcnt(9) lgkmcnt(9)
    v_mfma_f32_32x32x16_bf16 v[64:79], v[168:171], a[124:127], v[64:79]
    s_add_u32 s67, s74, 0
    buffer_load_dwordx4 a[0:3], v3, s[4:7], s67 offen offset:0 sc1
    s_waitcnt vmcnt(9) lgkmcnt(8)
    v_mfma_f32_32x32x16_bf16 v[64:79], v[172:175], a[136:139], v[64:79]
    s_add_u32 s69, s76, 0
    buffer_load_dwordx4 a[8:11], v3, s[4:7], s69 offen offset:0 sc1
    s_waitcnt vmcnt(9) lgkmcnt(7)
    v_mfma_f32_32x32x16_bf16 v[64:79], v[176:179], a[148:151], v[64:79]
    buffer_load_dwordx4 a[12:15], v3, s[4:7], s67 offen offset:1024 sc1
    s_waitcnt vmcnt(9) lgkmcnt(6)
    v_mfma_f32_32x32x16_bf16 v[64:79], v[180:183], a[160:163], v[64:79]
    buffer_load_dwordx4 a[20:23], v3, s[4:7], s69 offen offset:1024 sc1
    s_waitcnt vmcnt(9) lgkmcnt(5)
    v_mfma_f32_32x32x16_bf16 v[64:79], v[184:187], a[172:175], v[64:79]
    buffer_load_dwordx4 a[24:27], v3, s[4:7], s67 offen offset:2048 sc1
    s_waitcnt vmcnt(9) lgkmcnt(4)
    v_mfma_f32_32x32x16_bf16 v[64:79], v[188:191], a[184:187], v[64:79]
    buffer_load_dwordx4 a[32:35], v3, s[4:7], s69 offen offset:2048 sc1
    s_waitcnt vmcnt(9) lgkmcnt(3)
    v_mfma_f32_32x32x16_bf16 v[64:79], v[192:195], a[196:199], v[64:79]
    buffer_load_dwordx4 a[36:39], v3, s[4:7], s67 offen offset:3072 sc1
    s_waitcnt vmcnt(9) lgkmcnt(2)
    v_mfma_f32_32x32x16_bf16 v[64:79], v[196:199], a[208:211], v[64:79]
    buffer_load_dwordx4 a[44:47], v3, s[4:7], s69 offen offset:3072 sc1
    s_waitcnt vmcnt(9) lgkmcnt(1)
    v_mfma_f32_32x32x16_bf16 v[64:79], v[200:203], a[220:223], v[64:79]
    s_add_u32 s67, s74, 4096
    buffer_load_dwordx4 a[48:51], v3, s[4:7], s67 offen offset:0 sc1
    s_waitcnt vmcnt(9) lgkmcnt(0)
    v_mfma_f32_32x32x16_bf16 v[64:79], v[204:207], a[232:235], v[64:79]
    s_add_u32 s69, s76, 4096
    buffer_load_dwordx4 a[56:59], v3, s[4:7], s69 offen offset:0 sc1
    buffer_load_dwordx4 a[60:63], v3, s[4:7], s67 offen offset:1024 sc1
    buffer_load_dwordx4 a[68:71], v3, s[4:7], s69 offen offset:1024 sc1
    buffer_load_dwordx4 a[72:75], v3, s[4:7], s67 offen offset:2048 sc1
    buffer_load_dwordx4 a[80:83], v3, s[4:7], s69 offen offset:2048 sc1
    buffer_load_dwordx4 a[84:87], v3, s[4:7], s67 offen offset:3072 sc1
    buffer_load_dwordx4 a[92:95], v3, s[4:7], s69 offen offset:3072 sc1
    s_add_u32 s67, s74, 8192
    buffer_load_dwordx4 a[96:99], v3, s[4:7], s67 offen offset:0 sc1
    s_add_u32 s69, s76, 8192
    buffer_load_dwordx4 a[104:107], v3, s[4:7], s69 offen offset:0 sc1
    buffer_load_dwordx4 a[108:111], v3, s[4:7], s67 offen offset:1024 sc1
    buffer_load_dwordx4 a[116:119], v3, s[4:7], s69 offen offset:1024 sc1
    buffer_load_dwordx4 a[120:123], v3, s[4:7], s67 offen offset:2048 sc1
    buffer_load_dwordx4 a[128:131], v3, s[4:7], s69 offen offset:2048 sc1
    buffer_load_dwordx4 a[132:135], v3, s[4:7], s67 offen offset:3072 sc1
    buffer_load_dwordx4 a[140:143], v3, s[4:7], s69 offen offset:3072 sc1
    s_add_u32 s67, s74, 12288
    buffer_load_dwordx4 a[144:147], v3, s[4:7], s67 offen offset:0 sc1
    s_add_u32 s69, s76, 12288
    buffer_load_dwordx4 a[152:155], v3, s[4:7], s69 offen offset:0 sc1
    buffer_load_dwordx4 a[156:159], v3, s[4:7], s67 offen offset:1024 sc1
    buffer_load_dwordx4 a[164:167], v3, s[4:7], s69 offen offset:1024 sc1
    buffer_load_dwordx4 a[168:171], v3, s[4:7], s67 offen offset:2048 sc1
    buffer_load_dwordx4 a[176:179], v3, s[4:7], s69 offen offset:2048 sc1
    buffer_load_dwordx4 a[180:183], v3, s[4:7], s67 offen offset:3072 sc1
    buffer_load_dwordx4 a[188:191], v3, s[4:7], s69 offen offset:3072 sc1
    s_add_u32 s67, s74, 16384
    buffer_load_dwordx4 a[192:195], v3, s[4:7], s67 offen offset:0 sc1
    v_cvt_pk_bf16_f32 v66, 0, v64
    v_cvt_pk_bf16_f32 v67, 0, v65
    v_sub_f32 v64, v64, v66
    v_sub_f32 v65, v65, v67
    v_cvt_pk_bf16_f32 v64, -v66, -v64
    v_cvt_pk_bf16_f32 v65, v67, v65
    v_mov_b32 v66, 0
    v_mov_b32 v67, s50
    buffer_store_dwordx4 v[64:67], v57, s[4:7], s41 offen sc1
L_sp_pj:
    v_bfe_u32 v4, v2, 3, 1
    v_lshrrev_b32_e64 v6, 5, v2
    v_lshl_or_b32 v4, v6, 1, v4
    v_lshlrev_b32 v4, 4, v4
    v_xor_b32 v6, v4, v3
    s_mul_i32 s58, s3, 40
    s_and_b32 s59, s51, 3
    s_mul_i32 s59, s59, 160
    s_add_u32 s58, s58, s59
    v_min_u32 v4, 39, v2
    v_add_u32 v4, s58, v4
    v_mul_u32_u24 v4, 32, v4
    v_add_u32 v4, 20185088, v4
    s_mul_i32 s61, s3, 10240
    s_mul_i32 s60, s54, 40960
    s_add_u32 s60, s60, s61
    s_add_u32 s60, s60, 4194304
    s_mov_b32 s63, 0
    buffer_load_dword v128, v4, s[4:7], s63 offen sc1
    v_mov_b32 v15, 2130706432
    s_mov_b32 s47, 0
    s_mov_b32 s48, 0
    s_and_b32 s33, s3, 1
    s_lshr_b32 s32, s3, 1
    s_lshl_b32 s37, s54, 14
    s_add_u32 s37, s37, 20709376
    s_and_b32 s58, s53, 3
    s_lshl_b32 s41, s58, 2
    s_lshl_b32 s58, s58, 8
    s_lshl_b32 s59, s33, 7
    s_add_u32 s38, s58, s59
    s_lshr_b32 s58, s53, 2
    s_lshl_b32 s59, s58, 7
    s_add_u32 s41, s41, s59
    s_lshl_b32 s58, s58, 5
    s_add_u32 s38, s38, s58
    s_add_u32 s38, s38, s37
    s_lshl_b32 s58, s54, 9
    s_add_u32 s41, s41, s58
    s_add_u32 s41, s41, 393216
    s_mul_i32 s40, s54, 98304
    s_mul_i32 s58, s53, 3072
    s_add_u32 s40, s40, s58
    s_add_u32 s40, s40, 13631488
    s_mov_b32 s42, 0x01000100
    s_mov_b32 s43, 0x03020302
    s_lshr_b32 s34, s53, 3
    s_lshl_b32 s34, s34, 2
    s_and_b32 s58, s53, 3
    s_add_u32 s34, s34, s58
    s_mov_b32 s35, s54
    s_bfe_u32 s36, s53, 0x10002
    s_lshl_b32 s39, s35, 2
    s_add_u32 s39, s39, s3
    s_lshl_b32 s39, s39, 7
    s_add_u32 s39, s39, 393216
    s_mul_i32 s44, s34, 245760
    s_mul_i32 s58, s3, 12288
    s_add_u32 s44, s44, s58
    s_add_u32 s44, s44, 11665408
    s_lshl_b32 s45, s35, 1
    s_add_u32 s45, s45, s36
    s_mul_i32 s45, s45, 49152
    s_add_u32 s45, s45, s58
    s_add_u32 s45, s45, 13631488
    s_mul_i32 s58, s32, 3
    s_mul_i32 s59, s53, 6
    s_add_u32 s58, s58, s59
    s_lshl_b32 s58, s58, 10
    s_add_u32 s49, s58, 264192
    s_lshl_b32 s59, s33, 10
    s_add_u32 s77, s58, s59
    s_add_u32 s77, s77, 262144
    s_mov_b32 s8, s50
    s_mov_b32 s9, s50
    v_bfe_u32 v12, v2, 2, 2
    v_lshrrev_b32 v7, 5, v2
    v_lshl_add_u32 v8, v7, 3, v12
    v_lshrrev_b32_e64 v12, 1, v12
    v_lshl_or_b32 v12, v7, 1, v12
    v_bfe_u32 v7, v2, 4, 1
    v_bfe_u32 v10, v2, 1, 1
    v_lshl_or_b32 v10, v7, 1, v10
    v_xor_b32 v12, v12, v10
    v_lshlrev_b32 v12, 4, v12
    v_lshl_add_u32 v12, v8, 6, v12
    v_and_b32_e64 v10, 1, v2
    v_lshl_add_u32 v12, v10, 3, v12
    s_mul_i32 s58, s33, 20480
    v_add_u32 v12, s58, v12
    v_and_b32 v0, 7, v2
    v_mul_u32_u24 v0, 20, v0
    v_lshrrev_b32 v10, 3, v2
    v_add_lshl_u32 v0, v0, v10, 2
    v_and_or_b32 v0, v2, 3, v0
    v_bfe_u32 v30, v2, 1, 3
    v_mul_u32_u24 v8, 20, v30
    v_lshrrev_b32 v10, 4, v2
    v_add_lshl_u32 v8, v8, v10, 2
    v_lshlrev_b32 v10, 1, v2
    v_xor_b32 v30, v30, v10
    v_and_or_b32 v30, v30, 3, v8
    s_lshl_b32 s58, s53, 1
    s_add_u32 s58, s58, s33
    s_lshr_b32 s59, s58, 3
    s_and_b32 s58, s58, 7
    s_lshl_b32 s58, s58, 1
    v_bfe_u32 v10, v0, 1, 1
    v_lshrrev_b32 v8, 2, v0
    v_and_or_b32 v10, v8, 2, v10
    v_xor_b32_e64 v10, s59, v10
    v_lshl_add_u32 v10, v10, 4, s58
    v_lshl_add_u32 v0, v0, 6, v10
    v_bfe_u32 v10, v30, 1, 1
    v_lshrrev_b32_e64 v8, 2, v30
    v_and_or_b32 v10, v8, 2, v10
    v_xor_b32_e64 v10, s59, v10
    v_lshl_add_u32 v10, v10, 4, s58
    v_lshl_add_u32 v30, v30, 6, v10
    v_add_u32 v13, 81920, v12
    s_mul_i32 s58, s3, 6144
    s_add_u32 s58, s58, 122880
    v_add_u32 v14, s58, v3
    s_xor_b32 s59, s3, 1
    s_mul_i32 s59, s59, 6144
    s_add_u32 s59, s59, 122880
    v_add_u32_e64 v16, s59, v3
    v_mul_u32_u24 v17, 49152, v7
    v_and_b32_e64 v18, 15, v2
    v_lshl_add_u32 v18, v18, 4, v17
    v_lshrrev_b32_e64 v19, 5, v2
    v_lshl_add_u32 v17, v19, 8, v18
    s_lshl_b32 s58, s3, 9
    v_add_u32 v17, s58, v17
    s_lshl_b32 s58, s3, 8
    s_add_u32 s58, s58, 2048
    v_add_u32 v18, s58, v18
    v_mul_u32_u24 v19, 0x7f, v19
    v_lshl_or_b32 v18, v19, 24, v18
    v_and_b32 v19, 7, v2
    v_lshlrev_b32 v19, 7, v19
    v_bfe_u32 v10, v2, 3, 2
    v_lshl_add_u32 v19, v10, 5, v19
    v_lshrrev_b32 v8, 4, v2
    v_min_u32 v8, 2, v8
    s_mul_i32 s58, s3, 3
    v_add_u32 v8, s58, v8
    v_min_u32 v8, 9, v8
    v_xor_b32 v10, s36, v8
    v_lshrrev_b32 v7, 2, v2
    v_xor_b32 v7, v7, v2
    v_bfe_u32 v7, v7, 1, 1
    v_lshl_or_b32 v10, v10, 1, v7
    v_and_b32_e64 v10, 3, v10
    v_bfe_u32 v7, v2, 2, 2
    v_lshl_add_u32 v8, v8, 3, v7
    v_lshl_add_u32 v8, v8, 2, v10
    v_and_b32_e64 v10, 1, v2
    v_lshl_add_u32 v8, v8, 1, v10
    s_mul_i32 s58, s34, 5120
    v_lshl_add_u32 v31, v8, 3, s58
    s_barrier
    s_waitcnt vmcnt(0)
    v_cmp_ne_u32 vcc, s50, v128
    s_cbranch_vccnz L_slow20
L_back20:
    s_add_u32 s67, s74, 16384
    s_add_u32 s68, s75, 12288
    s_add_u32 s69, s76, 12288
    s_add_u32 m0, s61, 0
    s_add_u32 s62, s60, 0
    buffer_load_dwordx4 v6, s[4:7], s62 offen offset:0 sc1 lds
    s_add_u32 s68, s75, 16384
    buffer_load_dwordx4 v6, s[4:7], s62 offen offset:1024 sc1 lds
    buffer_load_dwordx4 v6, s[4:7], s62 offen offset:2048 sc1 lds
    buffer_load_dwordx4 v6, s[4:7], s62 offen offset:3072 sc1 lds
    s_add_u32 m0, s61, 4096
    s_add_u32 s62, s60, 4096
    buffer_load_dwordx4 v6, s[4:7], s62 offen offset:0 sc1 lds
    buffer_store_dwordx4 v[32:35], v15, s[4:7], s47 offen sc1
    buffer_load_dwordx4 v6, s[4:7], s62 offen offset:1024 sc1 lds
    buffer_load_dwordx4 v6, s[4:7], s62 offen offset:2048 sc1 lds
    buffer_load_dwordx4 v6, s[4:7], s62 offen offset:3072 sc1 lds
    s_add_u32 m0, s61, 8192
    s_add_u32 s62, s60, 8192
    buffer_load_dwordx4 v6, s[4:7], s62 offen offset:0 sc1 lds
    buffer_load_dwordx4 v6, s[4:7], s62 offen offset:1024 sc1 lds
    s_barrier
    s_mov_b32 s62, 122880
    v_lshlrev_b32 v28, 3, v2
    buffer_load_dwordx4 v[20:23], v3, s[4:7], s62 offen sc1
    buffer_load_dwordx4 v[24:27], v3, s[4:7], s62 offen offset:1024 sc1
    s_mov_b32 s63, 20480
    buffer_load_dword v192, v4, s[4:7], s63 offen sc1
    buffer_load_dwordx2 v[28:29], v28, s[4:7], s62 offen offset:2048 sc1
    buffer_load_dwordx4 a[196:199], v5, s[4:7], s68 offen offset:0 sc1
    s_add_u32 s69, s76, 16384
    buffer_load_dwordx4 a[200:203], v3, s[4:7], s69 offen offset:0 sc1
    buffer_load_dwordx4 a[204:207], v3, s[4:7], s67 offen offset:1024 sc1
    buffer_load_dwordx4 a[208:211], v5, s[4:7], s68 offen offset:1024 sc1
    buffer_load_dwordx4 a[212:215], v3, s[4:7], s69 offen offset:1024 sc1
    s_branch L_g1
L_slow18:
    s_sub_u32 s55, s55, 1
    s_cbranch_scc1 L_giveup18
    s_sleep 8
    buffer_load_dwordx4 v[64:67], v58, s[4:7], 0 offen sc1
    buffer_load_dwordx4 v[68:71], v58, s[4:7], 0 offen offset:16 sc1
    buffer_load_dwordx4 v[72:75], v58, s[4:7], s59 offen sc1
    buffer_load_dwordx4 v[76:79], v58, s[4:7], s59 offen offset:16 sc1
    buffer_load_dwordx4 v[80:83], v57, s[4:7], 0 offen sc1
    buffer_load_dwordx4 v[84:87], v57, s[4:7], 0 offen offset:16 sc1
    buffer_load_dwordx4 v[88:91], v57, s[4:7], s59 offen sc1
    buffer_load_dwordx4 v[92:95], v57, s[4:7], s59 offen offset:16 sc1
    s_waitcnt vmcnt(0)
    v_xor_b32 v50, v65, v67
    v_sad_u32 v50, v65, v69, v50 clamp
    v_sad_u32 v50, v65, v71, v50 clamp
    v_sad_u32 v50, v65, v73, v50 clamp
    v_sad_u32 v50, v65, v75, v50 clamp
    v_sad_u32 v50, v65, v77, v50 clamp
    v_sad_u32 v50, v65, v79, v50 clamp
    v_sad_u32 v50, v65, v81, v50 clamp
    v_sad_u32 v50, v65, v83, v50 clamp
    v_sad_u32 v50, v65, v85, v50 clamp
    v_sad_u32 v50, v65, v87, v50 clamp
    v_sad_u32 v50, v65, v89, v50 clamp
    v_sad_u32 v50, v65, v91, v50 clamp
    v_sad_u32 v50, v65, v93, v50 clamp
    v_sad_u32 v50, v65, v95, v50 clamp
    v_sad_u32 v50, v65, s50, v50 clamp
    v_cmp_ne_u32 vcc, 0, v50
    s_cbranch_vccnz L_slow18
    s_branch L_back18
L_giveup18:
    s_mov_b32 s55, 0
    s_branch L_back18
L_slow19:
    s_sub_u32 s55, s55, 1
    s_cbranch_scc1 L_giveup19
    s_sleep 8
    buffer_load_dword v4, v6, s[4:7], 0 offen sc1
    s_waitcnt vmcnt(0)
    v_cmp_ne_u32 vcc, s50, v4
    s_cbranch_vccnz L_slow19
    s_branch L_back19
L_giveup19:
    s_mov_b32 s55, 0
    s_branch L_back19
L_slow20:
    s_sub_u32 s55, s55, 1
    s_cbranch_scc1 L_giveup20
    s_sleep 9
    s_mov_b32 s63, 0
    buffer_load_dword v128, v4, s[4:7], s63 offen sc1
    s_waitcnt vmcnt(0)
    v_cmp_ne_u32 vcc, s50, v128
    s_cbranch_vccnz L_slow20
    s_branch L_back20
L_giveup20:
    s_mov_b32 s55, 0
    s_branch L_back20
.set L_gp0, L_stub4
.set L_gp1, L_stub5
.set L_gp2, L_stub6
.set L_gp3, L_stub7
.set L_s1, L_stub8
.set L_s2, L_stub9
.set L_s3, L_s0
.section .rodata,"a"
.p2align 6
.amdhsa_kernel adaLN_cond__ssm_conv_s4__glu_gated_geglu__prompt_kernel
  .amdhsa_next_free_vgpr 512
  .amdhsa_next_free_sgpr 102
  .amdhsa_accum_offset 256
  .amdhsa_group_segment_fixed_size 0
  .amdhsa_kernarg_size 144
  .amdhsa_user_sgpr_count 2
  .amdhsa_user_sgpr_kernarg_segment_ptr 1
  .amdhsa_system_sgpr_workgroup_id_x 1
  .amdhsa_float_denorm_mode_32 3
.end_amdhsa_kernel
```
